```python
import torch

def _softmax(x, axis=-1):
    return torch.softmax(x, dim=axis)

def _gelu(x):
    return torch.nn.functional.gelu(x, approximate='tanh')

def _silu(x):
    return torch.nn.functional.silu(x)

def _sigmoid(x):
    return torch.sigmoid(x)

def _layernorm(x, axis=-1, eps=1e-05):
    m = x.mean(dim=axis, keepdim=True)
    v = x.var(dim=axis, keepdim=True, unbiased=False)
    return (x - m) / torch.sqrt(v + eps)

def _scatter_add(tgt, idx, src, axis=0):
    return tgt.clone().index_add_(axis, idx, src)

def _segment_sum(src, seg, n):
    out = torch.zeros((n,) + src.shape[1:], dtype=src.dtype)
    return out.index_add_(0, seg, src)

def _pad(x, pw):
    flat = tuple((v for pair in reversed(pw) for v in pair))
    return torch.nn.functional.pad(x, flat)
kernel_name = 'parallel_sum__spectral_fnet__mixer_gmlp__prompt'

def setup_inputs():

    _w = lambda a: (lambda t: t.to(torch.bfloat16) if t.is_floating_point() else t)(torch.as_tensor(a))

    def _A_setup():
        B, S, D = (1, 2048, 640)
        ns = torch.arange(S)[:, None] * torch.arange(S)[None, :]
        nd = torch.arange(D)[:, None] * torch.arange(D)[None, :]
        Ws_re = torch.cos(-2.0 * torch.pi * ns / S).to(float)
        Ws_im = torch.sin(-2.0 * torch.pi * ns / S).to(float)
        Wd_re = torch.cos(-2.0 * torch.pi * nd / D).to(float)
        Wd_im = torch.sin(-2.0 * torch.pi * nd / D).to(float)
        return {'x': _w((lambda *s: torch.randn(*s, dtype=torch.bfloat16) * 0.05)(B, S, D)), 'dft_seq_re': _w(Ws_re), 'dft_seq_im': _w(Ws_im), 'dft_hid_re': _w(Wd_re), 'dft_hid_im': _w(Wd_im)}
    _A_in = _A_setup()

    def _B_setup():
        B, S, D, F = (1, 2048, 640, 1728)
        Fh = F // 2
        return {'x': _w((lambda *s: torch.randn(*s, dtype=torch.bfloat16) * 0.05)(B, S, D)), 'w_in': _w((lambda *s: torch.randn(*s, dtype=torch.bfloat16) * 0.8)(D, 2 * Fh)), 'w_sp': _w(0.01 * (lambda *s: torch.randn(*s, dtype=torch.bfloat16) * 0.8)(S, S)), 'b_sp': _w(1.0 + 0.01 * (lambda *s: torch.randn(*s, dtype=torch.bfloat16) * 0.8)(S)), 'w_out': _w((lambda *s: torch.randn(*s, dtype=torch.bfloat16) * 0.8)(Fh, D))}
    _B_in = _B_setup()
    return {'A_x': _A_in['x'], 'A_dft_seq_re': _A_in['dft_seq_re'], 'A_dft_seq_im': _A_in['dft_seq_im'], 'A_dft_hid_re': _A_in['dft_hid_re'], 'A_dft_hid_im': _A_in['dft_hid_im'], 'B_x': _B_in['x'], 'B_w_in': _B_in['w_in'], 'B_w_sp': _B_in['w_sp'], 'B_b_sp': _B_in['b_sp'], 'B_w_out': _B_in['w_out']}

def reference(A_x, A_dft_seq_re, A_dft_seq_im, A_dft_hid_re, A_dft_hid_im, B_x, B_w_in, B_w_sp, B_b_sp, B_w_out):

    def _A_ref(x, dft_seq_re, dft_seq_im, dft_hid_re, dft_hid_im):
        a = torch.einsum('bsd,ed->bse', x, dft_hid_re)
        b = torch.einsum('bsd,ed->bse', x, dft_hid_im)
        y = torch.einsum('ts,bse->bte', dft_seq_re, a) - torch.einsum('ts,bse->bte', dft_seq_im, b)
        return y

    def _B_ref(x, w_in, w_sp, b_sp, w_out):
        B, S, D = x.shape
        F = w_in.shape[-1]
        Fh = F // 2
        z = _gelu(torch.einsum('bsd,df->bsf', x, w_in))
        z1 = z[..., :Fh].clone()
        z2 = _layernorm(z[..., Fh:], axis=-1)
        g = torch.einsum('ts,bsf->btf', w_sp, z2) + b_sp[None, :, None]
        return torch.einsum('bsf,fd->bsd', z1 * g, w_out)
    x = A_x
    xn = _layernorm(x, axis=-1)
    return x + _A_ref(xn, A_dft_seq_re, A_dft_seq_im, A_dft_hid_re, A_dft_hid_im) + _B_ref(xn, B_w_in, B_w_sp, B_b_sp, B_w_out)
```

```asm
; @launch grid=(256,1,1) block=(1024,1,1) lds=159744
.amdgcn_target "amdgcn-amd-amdhsa--gfx950"
.text
.globl parallel_sum__spectral_fnet__mixer_gmlp__prompt_kernel
.p2align 8
.type parallel_sum__spectral_fnet__mixer_gmlp__prompt_kernel,@function
parallel_sum__spectral_fnet__mixer_gmlp__prompt_kernel:
KSTART:
    s_cmp_ge_u32 s2, 256
    s_cbranch_scc1 K3_exit
    s_load_dwordx2 s[4:5], s[0:1], 0
    s_load_dwordx4 s[8:11], s[0:1], 24
    s_load_dwordx2 s[12:13], s[0:1], 48
    s_load_dwordx2 s[14:15], s[0:1], 88
    s_load_dwordx2 s[6:7], s[0:1], 96
    v_lshrrev_b32 v1, 6, v0
    v_and_b32 v0, 63, v0
    s_nop 0
    v_readfirstlane_b32 s32, v1
    s_and_b32 s33, s2, 7
    s_lshr_b32 s34, s2, 3
    s_lshr_b32 s35, s33, 1
    s_and_b32 s36, s33, 1
    s_cmp_ge_u32 s34, 24
    s_cbranch_scc1 K1A_entry
    s_mul_i32 s48, s34, 43
    s_lshr_b32 s48, s48, 8
    s_mul_i32 s49, s48, 6
    s_sub_u32 s49, s34, s49
    s_and_b32 s53, s49, 1
    s_lshr_b32 s49, s49, 1
    s_mul_i32 s38, s36, 3
    s_add_u32 s38, s38, s49
    s_lshl_b32 s49, s35, 1
    s_add_u32 s50, s49, s48
    s_sub_u32 s51, s48, s49
    s_add_u32 s51, s51, 12
    s_cmp_lt_u32 s48, 2
    s_cselect_b32 s37, s50, s51
    s_cmp_ge_u32 s32, 12
    s_cbranch_scc1 K1Z_work
    s_cmp_ge_u32 s32, 8
    s_cbranch_scc1 K1Z_prod
    s_and_b32 s39, s32, 3
    s_lshr_b32 s40, s32, 2
    v_and_b32 v1, 15, v0
    v_lshrrev_b32 v2, 4, v0
    v_and_b32 v3, 7, v0
    v_xor_b32 v3, v3, v2
    v_lshlrev_b32 v3, 4, v3
    v_lshl_add_u32 v3, v1, 7, v3
    s_lshl_b32 s48, s39, 12
    v_add_u32 v112, s48, v3
    v_xor_b32 v113, 64, v112
    v_lshrrev_b32 v3, 2, v1
    v_lshl_add_u32 v3, v2, 2, v3
    v_mul_u32_u24 v3, 288, v3
    v_and_b32 v4, 3, v1
    v_lshl_add_u32 v3, v4, 3, v3
    s_mul_i32 s48, s40, 160
    v_add_u32 v116, s48, v3
    s_lshl_b32 s48, s2, 3
    s_add_u32 s48, s48, s32
    s_mul_i32 s49, s48, 1280
    v_lshlrev_b32 v56, 4, v0
    v_mov_b32 v57, 0x3f803f80
    v_mov_b32 v68, 0
    v_mov_b32 v69, 0
    v_mov_b32 v70, 0
    v_mov_b32 v71, 0
    s_waitcnt lgkmcnt(0)
    s_add_u32 s50, s4, s49
    s_addc_u32 s51, s5, 0
    s_mov_b32 s24, s50
    s_mov_b32 s25, s51
    s_mov_b32 s26, 0x500
    s_mov_b32 s27, 0x00020000
    buffer_load_dwordx4 v[60:63], v56, s[24:27], 0 offen
    buffer_load_dwordx4 v[64:67], v56, s[24:27], 0 offen offset:1024
    s_add_u32 s50, s6, 0x8c8000
    s_addc_u32 s51, s7, 0
    s_mov_b32 s28, s50
    s_mov_b32 s29, s51
    s_mov_b32 s30, 0x4000
    s_mov_b32 s31, 0x00020000
    s_lshl_b32 s47, s48, 3
    v_mov_b32 v16, 0
    v_mov_b32 v17, 0
    v_mov_b32 v18, 0
    v_mov_b32 v19, 0
    v_mov_b32 v20, 0
    v_mov_b32 v21, 0
    v_mov_b32 v22, 0
    v_mov_b32 v23, 0
    v_mov_b32 v24, 0
    v_mov_b32 v25, 0
    v_mov_b32 v26, 0
    v_mov_b32 v27, 0
    v_mov_b32 v28, 0
    v_mov_b32 v29, 0
    v_mov_b32 v30, 0
    v_mov_b32 v31, 0
    v_mov_b32 v32, 0
    v_mov_b32 v33, 0
    v_mov_b32 v34, 0
    v_mov_b32 v35, 0
    v_mov_b32 v36, 0
    v_mov_b32 v37, 0
    v_mov_b32 v38, 0
    v_mov_b32 v39, 0
    v_mov_b32 v40, 0
    v_mov_b32 v41, 0
    v_mov_b32 v42, 0
    v_mov_b32 v43, 0
    v_mov_b32 v44, 0
    v_mov_b32 v45, 0
    v_mov_b32 v46, 0
    v_mov_b32 v47, 0
    v_mov_b32 v48, 0
    v_mov_b32 v49, 0
    v_mov_b32 v50, 0
    v_mov_b32 v51, 0
    v_mov_b32 v52, 0
    v_mov_b32 v53, 0
    v_mov_b32 v54, 0
    v_mov_b32 v55, 0
    s_waitcnt vmcnt(0)
    v_dot2_f32_bf16 v68, v60, v60, v68
    v_dot2_f32_bf16 v70, v60, v57, v70
    v_dot2_f32_bf16 v69, v61, v61, v69
    v_dot2_f32_bf16 v71, v61, v57, v71
    v_dot2_f32_bf16 v68, v62, v62, v68
    v_dot2_f32_bf16 v70, v62, v57, v70
    v_dot2_f32_bf16 v69, v63, v63, v69
    v_dot2_f32_bf16 v71, v63, v57, v71
    v_dot2_f32_bf16 v68, v64, v64, v68
    v_dot2_f32_bf16 v70, v64, v57, v70
    v_dot2_f32_bf16 v69, v65, v65, v69
    v_dot2_f32_bf16 v71, v65, v57, v71
    v_dot2_f32_bf16 v68, v66, v66, v68
    v_dot2_f32_bf16 v70, v66, v57, v70
    v_dot2_f32_bf16 v69, v67, v67, v69
    v_dot2_f32_bf16 v71, v67, v57, v71
    s_nop 3
    v_add_f32 v68, v68, v69
    v_add_f32 v70, v70, v71
    s_nop 1
    v_add_f32_dpp v68, v68, v68 quad_perm:[1,0,3,2] row_mask:0xf bank_mask:0xf
    v_add_f32_dpp v70, v70, v70 quad_perm:[1,0,3,2] row_mask:0xf bank_mask:0xf
    s_nop 0
    v_add_f32_dpp v68, v68, v68 quad_perm:[2,3,0,1] row_mask:0xf bank_mask:0xf
    v_add_f32_dpp v70, v70, v70 quad_perm:[2,3,0,1] row_mask:0xf bank_mask:0xf
    s_nop 0
    v_add_f32_dpp v68, v68, v68 row_half_mirror row_mask:0xf bank_mask:0xf
    v_add_f32_dpp v70, v70, v70 row_half_mirror row_mask:0xf bank_mask:0xf
    s_nop 0
    v_add_f32_dpp v68, v68, v68 row_mirror row_mask:0xf bank_mask:0xf
    v_add_f32_dpp v70, v70, v70 row_mirror row_mask:0xf bank_mask:0xf
    s_nop 0
    v_mov_b32 v69, v68
    v_mov_b32 v71, v70
    s_nop 1
    v_permlane16_swap_b32 v68, v69
    v_permlane16_swap_b32 v70, v71
    s_nop 1
    v_add_f32 v68, v68, v69
    v_add_f32 v70, v70, v71
    v_mov_b32 v69, v68
    v_mov_b32 v71, v70
    s_nop 1
    v_permlane32_swap_b32 v68, v69
    v_permlane32_swap_b32 v70, v71
    s_nop 1
    v_add_f32 v68, v68, v69
    v_add_f32 v70, v70, v71
    v_mul_f32 v70, 0x3acccccd, v70
    v_mul_f32 v68, 0x3acccccd, v68
    v_fma_f32 v68, -v70, v70, v68
    v_max_f32 v68, 0, v68
    v_add_f32 v68, 0x3727c5ac, v68
    v_rsq_f32 v72, v68
    s_nop 0
    v_mul_f32 v73, v70, v72
    v_sub_f32 v73, 0, v73
    v_mov_b32 v74, 0
    v_cmp_eq_u32 vcc, 0, v0
    s_and_saveexec_b64 s[54:55], vcc
    buffer_store_dwordx2 v[72:73], v74, s[28:31], s47 offen sc1
    s_mov_b64 exec, s[54:55]
    s_cmp_eq_u32 s40, s53
    s_cselect_b32 s48, 0, 2
    s_add_u32 s48, s48, s40
    s_cmp_eq_u32 s48, 1
    s_cbranch_scc1 K1c_z2_1
    s_cmp_eq_u32 s48, 2
    s_cbranch_scc1 K1c_z1_0
    s_cmp_eq_u32 s48, 3
    s_cbranch_scc1 K1c_z1_1
K1c_z2_0:
    s_mov_b32 s41, 0
    s_mov_b32 s43, 0
    s_barrier
    ds_read_b128 v[56:59], v112 offset:0
    ds_read_b128 v[60:63], v112 offset:2048
    ds_read_b64_tr_b16 v[64:65], v116 offset:16384
    ds_read_b64_tr_b16 v[66:67], v116 offset:20992
    ds_read_b64_tr_b16 v[68:69], v116 offset:16416
    ds_read_b64_tr_b16 v[70:71], v116 offset:21024
    ds_read_b64_tr_b16 v[72:73], v116 offset:16448
    ds_read_b64_tr_b16 v[74:75], v116 offset:21056
    ds_read_b64_tr_b16 v[76:77], v116 offset:16480
    ds_read_b64_tr_b16 v[78:79], v116 offset:21088
    ds_read_b64_tr_b16 v[80:81], v116 offset:16512
    ds_read_b64_tr_b16 v[82:83], v116 offset:21120
    ds_read_b128 v[84:87], v113 offset:0
    ds_read_b128 v[88:91], v113 offset:2048
    ds_read_b64_tr_b16 v[92:93], v116 offset:25600
    ds_read_b64_tr_b16 v[94:95], v116 offset:30208
    ds_read_b64_tr_b16 v[96:97], v116 offset:25632
    ds_read_b64_tr_b16 v[98:99], v116 offset:30240
    ds_read_b64_tr_b16 v[100:101], v116 offset:25664
    ds_read_b64_tr_b16 v[102:103], v116 offset:30272
    ds_read_b64_tr_b16 v[104:105], v116 offset:25696
    ds_read_b64_tr_b16 v[106:107], v116 offset:30304
    ds_read_b64_tr_b16 v[108:109], v116 offset:25728
    ds_read_b64_tr_b16 v[110:111], v116 offset:30336
    s_mov_b32 s48, s43
    s_add_u32 s43, s43, 34816
    s_cmp_eq_u32 s43, 139264
    s_cselect_b32 s43, 0, s43
    s_sub_u32 s48, s43, s48
    s_add_u32 s41, s41, 1
    v_add_u32 v112, s48, v112
    v_add_u32 v113, s48, v113
    v_add_u32 v116, s48, v116
    s_waitcnt lgkmcnt(0)
K1c_z2_0L_loop:
    s_barrier
    v_mfma_f32_16x16x32_bf16 v[16:19], v[56:59], v[64:67], v[16:19]
    v_mfma_f32_16x16x32_bf16 v[20:23], v[60:63], v[64:67], v[20:23]
    v_mfma_f32_16x16x32_bf16 v[24:27], v[56:59], v[68:71], v[24:27]
    v_mfma_f32_16x16x32_bf16 v[28:31], v[60:63], v[68:71], v[28:31]
    v_mfma_f32_16x16x32_bf16 v[32:35], v[56:59], v[72:75], v[32:35]
    v_mfma_f32_16x16x32_bf16 v[36:39], v[60:63], v[72:75], v[36:39]
    v_mfma_f32_16x16x32_bf16 v[40:43], v[56:59], v[76:79], v[40:43]
    v_mfma_f32_16x16x32_bf16 v[44:47], v[60:63], v[76:79], v[44:47]
    v_mfma_f32_16x16x32_bf16 v[48:51], v[56:59], v[80:83], v[48:51]
    v_mfma_f32_16x16x32_bf16 v[52:55], v[60:63], v[80:83], v[52:55]
    v_mfma_f32_16x16x32_bf16 v[16:19], v[84:87], v[92:95], v[16:19]
    v_mfma_f32_16x16x32_bf16 v[20:23], v[88:91], v[92:95], v[20:23]
    ds_read_b128 v[56:59], v112 offset:0
    ds_read_b128 v[60:63], v112 offset:2048
    v_mfma_f32_16x16x32_bf16 v[24:27], v[84:87], v[96:99], v[24:27]
    ds_read_b64_tr_b16 v[64:65], v116 offset:16384
    ds_read_b64_tr_b16 v[66:67], v116 offset:20992
    v_mfma_f32_16x16x32_bf16 v[28:31], v[88:91], v[96:99], v[28:31]
    ds_read_b64_tr_b16 v[68:69], v116 offset:16416
    ds_read_b64_tr_b16 v[70:71], v116 offset:21024
    v_mfma_f32_16x16x32_bf16 v[32:35], v[84:87], v[100:103], v[32:35]
    ds_read_b64_tr_b16 v[72:73], v116 offset:16448
    ds_read_b64_tr_b16 v[74:75], v116 offset:21056
    v_mfma_f32_16x16x32_bf16 v[36:39], v[88:91], v[100:103], v[36:39]
    ds_read_b64_tr_b16 v[76:77], v116 offset:16480
    ds_read_b64_tr_b16 v[78:79], v116 offset:21088
    v_mfma_f32_16x16x32_bf16 v[40:43], v[84:87], v[104:107], v[40:43]
    ds_read_b64_tr_b16 v[80:81], v116 offset:16512
    ds_read_b64_tr_b16 v[82:83], v116 offset:21120
    v_mfma_f32_16x16x32_bf16 v[44:47], v[88:91], v[104:107], v[44:47]
    v_mfma_f32_16x16x32_bf16 v[48:51], v[84:87], v[108:111], v[48:51]
    v_mfma_f32_16x16x32_bf16 v[52:55], v[88:91], v[108:111], v[52:55]
    ds_read_b128 v[84:87], v113 offset:0
    ds_read_b128 v[88:91], v113 offset:2048
    ds_read_b64_tr_b16 v[92:93], v116 offset:25600
    ds_read_b64_tr_b16 v[94:95], v116 offset:30208
    ds_read_b64_tr_b16 v[96:97], v116 offset:25632
    ds_read_b64_tr_b16 v[98:99], v116 offset:30240
    ds_read_b64_tr_b16 v[100:101], v116 offset:25664
    ds_read_b64_tr_b16 v[102:103], v116 offset:30272
    ds_read_b64_tr_b16 v[104:105], v116 offset:25696
    ds_read_b64_tr_b16 v[106:107], v116 offset:30304
    ds_read_b64_tr_b16 v[108:109], v116 offset:25728
    ds_read_b64_tr_b16 v[110:111], v116 offset:30336
    s_mov_b32 s48, s43
    s_add_u32 s43, s43, 34816
    s_cmp_eq_u32 s43, 139264
    s_cselect_b32 s43, 0, s43
    s_sub_u32 s48, s43, s48
    s_add_u32 s41, s41, 1
    v_add_u32 v112, s48, v112
    v_add_u32 v113, s48, v113
    v_add_u32 v116, s48, v116
    s_cmp_eq_u32 s41, 2
    s_cbranch_scc0 K1c_z2_0L_nh0
    s_waitcnt vmcnt(0)
K1c_z2_0L_nh0:
    s_waitcnt lgkmcnt(0)
    s_cmp_lt_u32 s41, 10
    s_cbranch_scc1 K1c_z2_0L_loop
    v_mfma_f32_16x16x32_bf16 v[16:19], v[56:59], v[64:67], v[16:19]
    v_mfma_f32_16x16x32_bf16 v[20:23], v[60:63], v[64:67], v[20:23]
    v_mfma_f32_16x16x32_bf16 v[24:27], v[56:59], v[68:71], v[24:27]
    v_mfma_f32_16x16x32_bf16 v[28:31], v[60:63], v[68:71], v[28:31]
    v_mfma_f32_16x16x32_bf16 v[32:35], v[56:59], v[72:75], v[32:35]
    v_mfma_f32_16x16x32_bf16 v[36:39], v[60:63], v[72:75], v[36:39]
    v_mfma_f32_16x16x32_bf16 v[40:43], v[56:59], v[76:79], v[40:43]
    v_mfma_f32_16x16x32_bf16 v[44:47], v[60:63], v[76:79], v[44:47]
    v_mfma_f32_16x16x32_bf16 v[48:51], v[56:59], v[80:83], v[48:51]
    v_mfma_f32_16x16x32_bf16 v[52:55], v[60:63], v[80:83], v[52:55]
    v_mfma_f32_16x16x32_bf16 v[16:19], v[84:87], v[92:95], v[16:19]
    v_mfma_f32_16x16x32_bf16 v[20:23], v[88:91], v[92:95], v[20:23]
    v_mfma_f32_16x16x32_bf16 v[24:27], v[84:87], v[96:99], v[24:27]
    v_mfma_f32_16x16x32_bf16 v[28:31], v[88:91], v[96:99], v[28:31]
    v_mfma_f32_16x16x32_bf16 v[32:35], v[84:87], v[100:103], v[32:35]
    v_mfma_f32_16x16x32_bf16 v[36:39], v[88:91], v[100:103], v[36:39]
    v_mfma_f32_16x16x32_bf16 v[40:43], v[84:87], v[104:107], v[40:43]
    v_mfma_f32_16x16x32_bf16 v[44:47], v[88:91], v[104:107], v[44:47]
    v_mfma_f32_16x16x32_bf16 v[48:51], v[84:87], v[108:111], v[48:51]
    v_mfma_f32_16x16x32_bf16 v[52:55], v[88:91], v[108:111], v[52:55]
    s_barrier
    v_mov_b32 v112, 0xc0135761
    v_mov_b32 v113, 0xc0135761
    v_mov_b32 v114, 0xbdd2d3e8
    v_mov_b32 v115, 0xbdd2d3e8
    v_mov_b32 v116, 1.0
    v_mov_b32 v117, 1.0
    s_setprio 3
    s_lshl_b32 s48, s39, 7
    v_lshlrev_b32 v3, 4, v2
    v_add_u32 v3, s48, v3
    v_add_u32 v3, 147456, v3
    ds_read_b128 v[64:67], v3 offset:0
    ds_read_b128 v[72:75], v3 offset:512
    ds_read_b128 v[68:71], v3 offset:64
    ds_read_b128 v[76:79], v3 offset:576
    v_lshlrev_b32 v4, 2, v1
    v_add_u32 v4, 148480, v4
    ds_read_b32 v80, v4 offset:0
    ds_read_b32 v86, v4 offset:640
    ds_read_b32 v81, v4 offset:64
    ds_read_b32 v87, v4 offset:704
    ds_read_b32 v82, v4 offset:128
    ds_read_b32 v88, v4 offset:768
    ds_read_b32 v83, v4 offset:192
    ds_read_b32 v89, v4 offset:832
    ds_read_b32 v84, v4 offset:256
    ds_read_b32 v90, v4 offset:896
    v_mov_b32 v92, 0
    v_mov_b32 v100, 0
    v_mov_b32 v93, 0
    v_mov_b32 v101, 0
    v_mov_b32 v94, 0
    v_mov_b32 v102, 0
    v_mov_b32 v95, 0
    v_mov_b32 v103, 0
    v_mov_b32 v96, 0
    v_mov_b32 v104, 0
    v_mov_b32 v97, 0
    v_mov_b32 v105, 0
    v_mov_b32 v98, 0
    v_mov_b32 v106, 0
    v_mov_b32 v99, 0
    v_mov_b32 v107, 0
    s_add_u32 s50, s6, 0x8d0000
    s_addc_u32 s51, s7, 0
    s_mov_b32 s56, s50
    s_mov_b32 s57, s51
    s_mov_b32 s58, 0x30000
    s_mov_b32 s59, 0x00020000
    s_mul_i32 s47, s37, 12288
    s_lshl_b32 s48, s38, 1
    s_add_u32 s48, s48, 0
    s_lshl_b32 s48, s48, 10
    s_lshl_b32 s49, s39, 8
    s_add_u32 s48, s48, s49
    s_add_u32 s52, s47, s48
    s_waitcnt lgkmcnt(0)
    v_add_f32 v80, v80, v86
    v_add_f32 v81, v81, v87
    v_add_f32 v82, v82, v88
    v_add_f32 v83, v83, v89
    v_add_f32 v84, v84, v90
    v_pk_mul_f32 v[56:57], v[72:73], v[80:81] op_sel:[0,0] op_sel_hi:[1,0]
    v_pk_mul_f32 v[58:59], v[74:75], v[80:81] op_sel:[0,0] op_sel_hi:[1,0]
    v_pk_mul_f32 v[60:61], v[76:77], v[80:81] op_sel:[0,0] op_sel_hi:[1,0]
    v_pk_mul_f32 v[62:63], v[78:79], v[80:81] op_sel:[0,0] op_sel_hi:[1,0]
    v_pk_fma_f32 v[16:17], v[16:17], v[64:65], v[56:57]
    v_pk_fma_f32 v[18:19], v[18:19], v[66:67], v[58:59]
    v_pk_fma_f32 v[20:21], v[20:21], v[68:69], v[60:61]
    v_pk_fma_f32 v[22:23], v[22:23], v[70:71], v[62:63]
    v_pk_mul_f32 v[56:57], v[16:17], v[16:17]
    v_pk_mul_f32 v[58:59], v[18:19], v[18:19]
    v_pk_mul_f32 v[60:61], v[20:21], v[20:21]
    v_pk_mul_f32 v[62:63], v[22:23], v[22:23]
    v_pk_fma_f32 v[56:57], v[56:57], v[114:115], v[112:113]
    v_pk_fma_f32 v[58:59], v[58:59], v[114:115], v[112:113]
    v_pk_fma_f32 v[60:61], v[60:61], v[114:115], v[112:113]
    v_pk_fma_f32 v[62:63], v[62:63], v[114:115], v[112:113]
    v_pk_mul_f32 v[56:57], v[56:57], v[16:17]
    v_pk_mul_f32 v[58:59], v[58:59], v[18:19]
    v_pk_mul_f32 v[60:61], v[60:61], v[20:21]
    v_pk_mul_f32 v[62:63], v[62:63], v[22:23]
    v_exp_f32 v56, v56
    v_exp_f32 v57, v57
    v_exp_f32 v58, v58
    v_exp_f32 v59, v59
    v_exp_f32 v60, v60
    v_exp_f32 v61, v61
    v_exp_f32 v62, v62
    v_exp_f32 v63, v63
    v_pk_add_f32 v[56:57], v[56:57], v[116:117]
    v_pk_add_f32 v[58:59], v[58:59], v[116:117]
    v_pk_add_f32 v[60:61], v[60:61], v[116:117]
    v_pk_add_f32 v[62:63], v[62:63], v[116:117]
    v_rcp_f32 v56, v56
    v_rcp_f32 v57, v57
    v_rcp_f32 v58, v58
    v_rcp_f32 v59, v59
    v_rcp_f32 v60, v60
    v_rcp_f32 v61, v61
    v_rcp_f32 v62, v62
    v_rcp_f32 v63, v63
    v_pk_mul_f32 v[16:17], v[16:17], v[56:57]
    v_pk_mul_f32 v[18:19], v[18:19], v[58:59]
    v_pk_mul_f32 v[20:21], v[20:21], v[60:61]
    v_pk_mul_f32 v[22:23], v[22:23], v[62:63]
    v_pk_add_f32 v[92:93], v[92:93], v[16:17]
    v_pk_fma_f32 v[100:101], v[16:17], v[16:17], v[100:101]
    v_pk_add_f32 v[94:95], v[94:95], v[18:19]
    v_pk_fma_f32 v[102:103], v[18:19], v[18:19], v[102:103]
    v_pk_add_f32 v[96:97], v[96:97], v[20:21]
    v_pk_fma_f32 v[104:105], v[20:21], v[20:21], v[104:105]
    v_pk_add_f32 v[98:99], v[98:99], v[22:23]
    v_pk_fma_f32 v[106:107], v[22:23], v[22:23], v[106:107]
    v_pk_mul_f32 v[56:57], v[72:73], v[80:81] op_sel:[0,1] op_sel_hi:[1,1]
    v_pk_mul_f32 v[58:59], v[74:75], v[80:81] op_sel:[0,1] op_sel_hi:[1,1]
    v_pk_mul_f32 v[60:61], v[76:77], v[80:81] op_sel:[0,1] op_sel_hi:[1,1]
    v_pk_mul_f32 v[62:63], v[78:79], v[80:81] op_sel:[0,1] op_sel_hi:[1,1]
    v_pk_fma_f32 v[24:25], v[24:25], v[64:65], v[56:57]
    v_pk_fma_f32 v[26:27], v[26:27], v[66:67], v[58:59]
    v_pk_fma_f32 v[28:29], v[28:29], v[68:69], v[60:61]
    v_pk_fma_f32 v[30:31], v[30:31], v[70:71], v[62:63]
    v_pk_mul_f32 v[56:57], v[24:25], v[24:25]
    v_pk_mul_f32 v[58:59], v[26:27], v[26:27]
    v_pk_mul_f32 v[60:61], v[28:29], v[28:29]
    v_pk_mul_f32 v[62:63], v[30:31], v[30:31]
    v_pk_fma_f32 v[56:57], v[56:57], v[114:115], v[112:113]
    v_pk_fma_f32 v[58:59], v[58:59], v[114:115], v[112:113]
    v_pk_fma_f32 v[60:61], v[60:61], v[114:115], v[112:113]
    v_pk_fma_f32 v[62:63], v[62:63], v[114:115], v[112:113]
    v_pk_mul_f32 v[56:57], v[56:57], v[24:25]
    v_pk_mul_f32 v[58:59], v[58:59], v[26:27]
    v_pk_mul_f32 v[60:61], v[60:61], v[28:29]
    v_pk_mul_f32 v[62:63], v[62:63], v[30:31]
    v_exp_f32 v56, v56
    v_exp_f32 v57, v57
    v_exp_f32 v58, v58
    v_exp_f32 v59, v59
    v_exp_f32 v60, v60
    v_exp_f32 v61, v61
    v_exp_f32 v62, v62
    v_exp_f32 v63, v63
    v_pk_add_f32 v[56:57], v[56:57], v[116:117]
    v_pk_add_f32 v[58:59], v[58:59], v[116:117]
    v_pk_add_f32 v[60:61], v[60:61], v[116:117]
    v_pk_add_f32 v[62:63], v[62:63], v[116:117]
    v_rcp_f32 v56, v56
    v_rcp_f32 v57, v57
    v_rcp_f32 v58, v58
    v_rcp_f32 v59, v59
    v_rcp_f32 v60, v60
    v_rcp_f32 v61, v61
    v_rcp_f32 v62, v62
    v_rcp_f32 v63, v63
    v_pk_mul_f32 v[24:25], v[24:25], v[56:57]
    v_pk_mul_f32 v[26:27], v[26:27], v[58:59]
    v_pk_mul_f32 v[28:29], v[28:29], v[60:61]
    v_pk_mul_f32 v[30:31], v[30:31], v[62:63]
    v_pk_add_f32 v[92:93], v[92:93], v[24:25]
    v_pk_fma_f32 v[100:101], v[24:25], v[24:25], v[100:101]
    v_pk_add_f32 v[94:95], v[94:95], v[26:27]
    v_pk_fma_f32 v[102:103], v[26:27], v[26:27], v[102:103]
    v_pk_add_f32 v[96:97], v[96:97], v[28:29]
    v_pk_fma_f32 v[104:105], v[28:29], v[28:29], v[104:105]
    v_pk_add_f32 v[98:99], v[98:99], v[30:31]
    v_pk_fma_f32 v[106:107], v[30:31], v[30:31], v[106:107]
    v_pk_mul_f32 v[56:57], v[72:73], v[82:83] op_sel:[0,0] op_sel_hi:[1,0]
    v_pk_mul_f32 v[58:59], v[74:75], v[82:83] op_sel:[0,0] op_sel_hi:[1,0]
    v_pk_mul_f32 v[60:61], v[76:77], v[82:83] op_sel:[0,0] op_sel_hi:[1,0]
    v_pk_mul_f32 v[62:63], v[78:79], v[82:83] op_sel:[0,0] op_sel_hi:[1,0]
    v_pk_fma_f32 v[32:33], v[32:33], v[64:65], v[56:57]
    v_pk_fma_f32 v[34:35], v[34:35], v[66:67], v[58:59]
    v_pk_fma_f32 v[36:37], v[36:37], v[68:69], v[60:61]
    v_pk_fma_f32 v[38:39], v[38:39], v[70:71], v[62:63]
    v_pk_mul_f32 v[56:57], v[32:33], v[32:33]
    v_pk_mul_f32 v[58:59], v[34:35], v[34:35]
    v_pk_mul_f32 v[60:61], v[36:37], v[36:37]
    v_pk_mul_f32 v[62:63], v[38:39], v[38:39]
    v_pk_fma_f32 v[56:57], v[56:57], v[114:115], v[112:113]
    v_pk_fma_f32 v[58:59], v[58:59], v[114:115], v[112:113]
    v_pk_fma_f32 v[60:61], v[60:61], v[114:115], v[112:113]
    v_pk_fma_f32 v[62:63], v[62:63], v[114:115], v[112:113]
    v_pk_mul_f32 v[56:57], v[56:57], v[32:33]
    v_pk_mul_f32 v[58:59], v[58:59], v[34:35]
    v_pk_mul_f32 v[60:61], v[60:61], v[36:37]
    v_pk_mul_f32 v[62:63], v[62:63], v[38:39]
    v_exp_f32 v56, v56
    v_exp_f32 v57, v57
    v_exp_f32 v58, v58
    v_exp_f32 v59, v59
    v_exp_f32 v60, v60
    v_exp_f32 v61, v61
    v_exp_f32 v62, v62
    v_exp_f32 v63, v63
    v_pk_add_f32 v[56:57], v[56:57], v[116:117]
    v_pk_add_f32 v[58:59], v[58:59], v[116:117]
    v_pk_add_f32 v[60:61], v[60:61], v[116:117]
    v_pk_add_f32 v[62:63], v[62:63], v[116:117]
    v_rcp_f32 v56, v56
    v_rcp_f32 v57, v57
    v_rcp_f32 v58, v58
    v_rcp_f32 v59, v59
    v_rcp_f32 v60, v60
    v_rcp_f32 v61, v61
    v_rcp_f32 v62, v62
    v_rcp_f32 v63, v63
    v_pk_mul_f32 v[32:33], v[32:33], v[56:57]
    v_pk_mul_f32 v[34:35], v[34:35], v[58:59]
    v_pk_mul_f32 v[36:37], v[36:37], v[60:61]
    v_pk_mul_f32 v[38:39], v[38:39], v[62:63]
    v_pk_add_f32 v[92:93], v[92:93], v[32:33]
    v_pk_fma_f32 v[100:101], v[32:33], v[32:33], v[100:101]
    v_pk_add_f32 v[94:95], v[94:95], v[34:35]
    v_pk_fma_f32 v[102:103], v[34:35], v[34:35], v[102:103]
    v_pk_add_f32 v[96:97], v[96:97], v[36:37]
    v_pk_fma_f32 v[104:105], v[36:37], v[36:37], v[104:105]
    v_pk_add_f32 v[98:99], v[98:99], v[38:39]
    v_pk_fma_f32 v[106:107], v[38:39], v[38:39], v[106:107]
    v_pk_mul_f32 v[56:57], v[72:73], v[82:83] op_sel:[0,1] op_sel_hi:[1,1]
    v_pk_mul_f32 v[58:59], v[74:75], v[82:83] op_sel:[0,1] op_sel_hi:[1,1]
    v_pk_mul_f32 v[60:61], v[76:77], v[82:83] op_sel:[0,1] op_sel_hi:[1,1]
    v_pk_mul_f32 v[62:63], v[78:79], v[82:83] op_sel:[0,1] op_sel_hi:[1,1]
    v_pk_fma_f32 v[40:41], v[40:41], v[64:65], v[56:57]
    v_pk_fma_f32 v[42:43], v[42:43], v[66:67], v[58:59]
    v_pk_fma_f32 v[44:45], v[44:45], v[68:69], v[60:61]
    v_pk_fma_f32 v[46:47], v[46:47], v[70:71], v[62:63]
    v_pk_mul_f32 v[56:57], v[40:41], v[40:41]
    v_pk_mul_f32 v[58:59], v[42:43], v[42:43]
    v_pk_mul_f32 v[60:61], v[44:45], v[44:45]
    v_pk_mul_f32 v[62:63], v[46:47], v[46:47]
    v_pk_fma_f32 v[56:57], v[56:57], v[114:115], v[112:113]
    v_pk_fma_f32 v[58:59], v[58:59], v[114:115], v[112:113]
    v_pk_fma_f32 v[60:61], v[60:61], v[114:115], v[112:113]
    v_pk_fma_f32 v[62:63], v[62:63], v[114:115], v[112:113]
    v_pk_mul_f32 v[56:57], v[56:57], v[40:41]
    v_pk_mul_f32 v[58:59], v[58:59], v[42:43]
    v_pk_mul_f32 v[60:61], v[60:61], v[44:45]
    v_pk_mul_f32 v[62:63], v[62:63], v[46:47]
    v_exp_f32 v56, v56
    v_exp_f32 v57, v57
    v_exp_f32 v58, v58
    v_exp_f32 v59, v59
    v_exp_f32 v60, v60
    v_exp_f32 v61, v61
    v_exp_f32 v62, v62
    v_exp_f32 v63, v63
    v_pk_add_f32 v[56:57], v[56:57], v[116:117]
    v_pk_add_f32 v[58:59], v[58:59], v[116:117]
    v_pk_add_f32 v[60:61], v[60:61], v[116:117]
    v_pk_add_f32 v[62:63], v[62:63], v[116:117]
    v_rcp_f32 v56, v56
    v_rcp_f32 v57, v57
    v_rcp_f32 v58, v58
    v_rcp_f32 v59, v59
    v_rcp_f32 v60, v60
    v_rcp_f32 v61, v61
    v_rcp_f32 v62, v62
    v_rcp_f32 v63, v63
    v_pk_mul_f32 v[40:41], v[40:41], v[56:57]
    v_pk_mul_f32 v[42:43], v[42:43], v[58:59]
    v_pk_mul_f32 v[44:45], v[44:45], v[60:61]
    v_pk_mul_f32 v[46:47], v[46:47], v[62:63]
    v_pk_add_f32 v[92:93], v[92:93], v[40:41]
    v_pk_fma_f32 v[100:101], v[40:41], v[40:41], v[100:101]
    v_pk_add_f32 v[94:95], v[94:95], v[42:43]
    v_pk_fma_f32 v[102:103], v[42:43], v[42:43], v[102:103]
    v_pk_add_f32 v[96:97], v[96:97], v[44:45]
    v_pk_fma_f32 v[104:105], v[44:45], v[44:45], v[104:105]
    v_pk_add_f32 v[98:99], v[98:99], v[46:47]
    v_pk_fma_f32 v[106:107], v[46:47], v[46:47], v[106:107]
    v_pk_mul_f32 v[56:57], v[72:73], v[84:85] op_sel:[0,0] op_sel_hi:[1,0]
    v_pk_mul_f32 v[58:59], v[74:75], v[84:85] op_sel:[0,0] op_sel_hi:[1,0]
    v_pk_mul_f32 v[60:61], v[76:77], v[84:85] op_sel:[0,0] op_sel_hi:[1,0]
    v_pk_mul_f32 v[62:63], v[78:79], v[84:85] op_sel:[0,0] op_sel_hi:[1,0]
    v_pk_fma_f32 v[48:49], v[48:49], v[64:65], v[56:57]
    v_pk_fma_f32 v[50:51], v[50:51], v[66:67], v[58:59]
    v_pk_fma_f32 v[52:53], v[52:53], v[68:69], v[60:61]
    v_pk_fma_f32 v[54:55], v[54:55], v[70:71], v[62:63]
    v_pk_mul_f32 v[56:57], v[48:49], v[48:49]
    v_pk_mul_f32 v[58:59], v[50:51], v[50:51]
    v_pk_mul_f32 v[60:61], v[52:53], v[52:53]
    v_pk_mul_f32 v[62:63], v[54:55], v[54:55]
    v_pk_fma_f32 v[56:57], v[56:57], v[114:115], v[112:113]
    v_pk_fma_f32 v[58:59], v[58:59], v[114:115], v[112:113]
    v_pk_fma_f32 v[60:61], v[60:61], v[114:115], v[112:113]
    v_pk_fma_f32 v[62:63], v[62:63], v[114:115], v[112:113]
    v_pk_mul_f32 v[56:57], v[56:57], v[48:49]
    v_pk_mul_f32 v[58:59], v[58:59], v[50:51]
    v_pk_mul_f32 v[60:61], v[60:61], v[52:53]
    v_pk_mul_f32 v[62:63], v[62:63], v[54:55]
    v_exp_f32 v56, v56
    v_exp_f32 v57, v57
    v_exp_f32 v58, v58
    v_exp_f32 v59, v59
    v_exp_f32 v60, v60
    v_exp_f32 v61, v61
    v_exp_f32 v62, v62
    v_exp_f32 v63, v63
    v_pk_add_f32 v[56:57], v[56:57], v[116:117]
    v_pk_add_f32 v[58:59], v[58:59], v[116:117]
    v_pk_add_f32 v[60:61], v[60:61], v[116:117]
    v_pk_add_f32 v[62:63], v[62:63], v[116:117]
    v_rcp_f32 v56, v56
    v_rcp_f32 v57, v57
    v_rcp_f32 v58, v58
    v_rcp_f32 v59, v59
    v_rcp_f32 v60, v60
    v_rcp_f32 v61, v61
    v_rcp_f32 v62, v62
    v_rcp_f32 v63, v63
    v_pk_mul_f32 v[48:49], v[48:49], v[56:57]
    v_pk_mul_f32 v[50:51], v[50:51], v[58:59]
    v_pk_mul_f32 v[52:53], v[52:53], v[60:61]
    v_pk_mul_f32 v[54:55], v[54:55], v[62:63]
    v_pk_add_f32 v[92:93], v[92:93], v[48:49]
    v_pk_fma_f32 v[100:101], v[48:49], v[48:49], v[100:101]
    v_pk_add_f32 v[94:95], v[94:95], v[50:51]
    v_pk_fma_f32 v[102:103], v[50:51], v[50:51], v[102:103]
    v_pk_add_f32 v[96:97], v[96:97], v[52:53]
    v_pk_fma_f32 v[104:105], v[52:53], v[52:53], v[104:105]
    v_pk_add_f32 v[98:99], v[98:99], v[54:55]
    v_pk_fma_f32 v[106:107], v[54:55], v[54:55], v[106:107]
    v_add_f32_dpp v92, v92, v92 row_ror:8 row_mask:0xf bank_mask:0xf
    v_add_f32_dpp v93, v93, v93 row_ror:8 row_mask:0xf bank_mask:0xf
    v_add_f32_dpp v94, v94, v94 row_ror:8 row_mask:0xf bank_mask:0xf
    v_add_f32_dpp v95, v95, v95 row_ror:8 row_mask:0xf bank_mask:0xf
    v_add_f32_dpp v96, v96, v96 row_ror:8 row_mask:0xf bank_mask:0xf
    v_add_f32_dpp v97, v97, v97 row_ror:8 row_mask:0xf bank_mask:0xf
    v_add_f32_dpp v98, v98, v98 row_ror:8 row_mask:0xf bank_mask:0xf
    v_add_f32_dpp v99, v99, v99 row_ror:8 row_mask:0xf bank_mask:0xf
    v_add_f32_dpp v100, v100, v100 row_ror:8 row_mask:0xf bank_mask:0xf
    v_add_f32_dpp v101, v101, v101 row_ror:8 row_mask:0xf bank_mask:0xf
    v_add_f32_dpp v102, v102, v102 row_ror:8 row_mask:0xf bank_mask:0xf
    v_add_f32_dpp v103, v103, v103 row_ror:8 row_mask:0xf bank_mask:0xf
    v_add_f32_dpp v104, v104, v104 row_ror:8 row_mask:0xf bank_mask:0xf
    v_add_f32_dpp v105, v105, v105 row_ror:8 row_mask:0xf bank_mask:0xf
    v_add_f32_dpp v106, v106, v106 row_ror:8 row_mask:0xf bank_mask:0xf
    v_add_f32_dpp v107, v107, v107 row_ror:8 row_mask:0xf bank_mask:0xf
    v_add_f32_dpp v92, v92, v92 row_ror:4 row_mask:0xf bank_mask:0xf
    v_add_f32_dpp v93, v93, v93 row_ror:4 row_mask:0xf bank_mask:0xf
    v_add_f32_dpp v94, v94, v94 row_ror:4 row_mask:0xf bank_mask:0xf
    v_add_f32_dpp v95, v95, v95 row_ror:4 row_mask:0xf bank_mask:0xf
    v_add_f32_dpp v96, v96, v96 row_ror:4 row_mask:0xf bank_mask:0xf
    v_add_f32_dpp v97, v97, v97 row_ror:4 row_mask:0xf bank_mask:0xf
    v_add_f32_dpp v98, v98, v98 row_ror:4 row_mask:0xf bank_mask:0xf
    v_add_f32_dpp v99, v99, v99 row_ror:4 row_mask:0xf bank_mask:0xf
    v_add_f32_dpp v100, v100, v100 row_ror:4 row_mask:0xf bank_mask:0xf
    v_add_f32_dpp v101, v101, v101 row_ror:4 row_mask:0xf bank_mask:0xf
    v_add_f32_dpp v102, v102, v102 row_ror:4 row_mask:0xf bank_mask:0xf
    v_add_f32_dpp v103, v103, v103 row_ror:4 row_mask:0xf bank_mask:0xf
    v_add_f32_dpp v104, v104, v104 row_ror:4 row_mask:0xf bank_mask:0xf
    v_add_f32_dpp v105, v105, v105 row_ror:4 row_mask:0xf bank_mask:0xf
    v_add_f32_dpp v106, v106, v106 row_ror:4 row_mask:0xf bank_mask:0xf
    v_add_f32_dpp v107, v107, v107 row_ror:4 row_mask:0xf bank_mask:0xf
    v_add_f32_dpp v92, v92, v92 row_ror:2 row_mask:0xf bank_mask:0xf
    v_add_f32_dpp v93, v93, v93 row_ror:2 row_mask:0xf bank_mask:0xf
    v_add_f32_dpp v94, v94, v94 row_ror:2 row_mask:0xf bank_mask:0xf
    v_add_f32_dpp v95, v95, v95 row_ror:2 row_mask:0xf bank_mask:0xf
    v_add_f32_dpp v96, v96, v96 row_ror:2 row_mask:0xf bank_mask:0xf
    v_add_f32_dpp v97, v97, v97 row_ror:2 row_mask:0xf bank_mask:0xf
    v_add_f32_dpp v98, v98, v98 row_ror:2 row_mask:0xf bank_mask:0xf
    v_add_f32_dpp v99, v99, v99 row_ror:2 row_mask:0xf bank_mask:0xf
    v_add_f32_dpp v100, v100, v100 row_ror:2 row_mask:0xf bank_mask:0xf
    v_add_f32_dpp v101, v101, v101 row_ror:2 row_mask:0xf bank_mask:0xf
    v_add_f32_dpp v102, v102, v102 row_ror:2 row_mask:0xf bank_mask:0xf
    v_add_f32_dpp v103, v103, v103 row_ror:2 row_mask:0xf bank_mask:0xf
    v_add_f32_dpp v104, v104, v104 row_ror:2 row_mask:0xf bank_mask:0xf
    v_add_f32_dpp v105, v105, v105 row_ror:2 row_mask:0xf bank_mask:0xf
    v_add_f32_dpp v106, v106, v106 row_ror:2 row_mask:0xf bank_mask:0xf
    v_add_f32_dpp v107, v107, v107 row_ror:2 row_mask:0xf bank_mask:0xf
    v_add_f32_dpp v56, v92, v92 row_ror:1 row_mask:0xf bank_mask:0xf
    v_add_f32_dpp v58, v93, v93 row_ror:1 row_mask:0xf bank_mask:0xf
    v_add_f32_dpp v60, v94, v94 row_ror:1 row_mask:0xf bank_mask:0xf
    v_add_f32_dpp v62, v95, v95 row_ror:1 row_mask:0xf bank_mask:0xf
    v_add_f32_dpp v64, v96, v96 row_ror:1 row_mask:0xf bank_mask:0xf
    v_add_f32_dpp v66, v97, v97 row_ror:1 row_mask:0xf bank_mask:0xf
    v_add_f32_dpp v68, v98, v98 row_ror:1 row_mask:0xf bank_mask:0xf
    v_add_f32_dpp v70, v99, v99 row_ror:1 row_mask:0xf bank_mask:0xf
    v_add_f32_dpp v57, v100, v100 row_ror:1 row_mask:0xf bank_mask:0xf
    v_add_f32_dpp v59, v101, v101 row_ror:1 row_mask:0xf bank_mask:0xf
    v_add_f32_dpp v61, v102, v102 row_ror:1 row_mask:0xf bank_mask:0xf
    v_add_f32_dpp v63, v103, v103 row_ror:1 row_mask:0xf bank_mask:0xf
    v_add_f32_dpp v65, v104, v104 row_ror:1 row_mask:0xf bank_mask:0xf
    v_add_f32_dpp v67, v105, v105 row_ror:1 row_mask:0xf bank_mask:0xf
    v_add_f32_dpp v69, v106, v106 row_ror:1 row_mask:0xf bank_mask:0xf
    v_add_f32_dpp v71, v107, v107 row_ror:1 row_mask:0xf bank_mask:0xf
    v_lshlrev_b32 v3, 5, v2
    v_cmp_eq_u32 vcc, 0, v1
    s_and_saveexec_b64 s[54:55], vcc
    buffer_store_dwordx4 v[56:59], v3, s[56:59], s52 offen offset:0 sc1
    buffer_store_dwordx4 v[60:63], v3, s[56:59], s52 offen offset:16 sc1
    buffer_store_dwordx4 v[64:67], v3, s[56:59], s52 offen offset:128 sc1
    buffer_store_dwordx4 v[68:71], v3, s[56:59], s52 offen offset:144 sc1
    s_mov_b64 exec, s[54:55]
    v_and_b32 v4, 31, v0
    v_lshrrev_b32 v5, 5, v0
    v_mul_u32_u24 v5, 6144, v5
    v_lshl_add_u32 v4, v4, 3, v5
    s_lshl_b32 s49, s39, 8
    v_add_u32 v4, s49, v4
    v_add_u32 v5, 4096, v4
    s_mov_b32 s41, 0
K1c_z2_0_poll:
    buffer_load_dwordx2 v[72:73], v4, s[56:59], s47 offen offset:0 sc1
    buffer_load_dwordx2 v[74:75], v4, s[56:59], s47 offen offset:1024 sc1
    buffer_load_dwordx2 v[76:77], v4, s[56:59], s47 offen offset:2048 sc1
    buffer_load_dwordx2 v[78:79], v4, s[56:59], s47 offen offset:3072 sc1
    buffer_load_dwordx2 v[80:81], v5, s[56:59], s47 offen offset:0 sc1
    buffer_load_dwordx2 v[82:83], v5, s[56:59], s47 offen offset:1024 sc1
    s_waitcnt vmcnt(0)
    v_max3_u32 v6, v72, v73, v74
    v_max3_u32 v6, v6, v75, v76
    v_max3_u32 v6, v6, v77, v78
    v_max3_u32 v6, v6, v79, v80
    v_max3_u32 v6, v6, v81, v82
    v_max_u32 v6, v6, v83
    v_cmp_eq_u32 s[54:55], -1, v6
    s_nop 1
    s_cmp_eq_u64 s[54:55], 0
    s_cbranch_scc1 K1c_z2_0_rdy
    s_add_u32 s41, s41, 1
    s_cmp_lt_u32 s41, 4000
    s_cbranch_scc1 K1c_z2_0_poll
K1c_z2_0_rdy:
    v_pk_add_f32 v[72:73], v[72:73], v[74:75]
    v_pk_add_f32 v[76:77], v[76:77], v[78:79]
    v_pk_add_f32 v[80:81], v[80:81], v[82:83]
    v_pk_add_f32 v[72:73], v[72:73], v[76:77]
    v_pk_add_f32 v[72:73], v[72:73], v[80:81]
    v_mov_b32 v74, v72
    v_mov_b32 v75, v73
    s_nop 1
    v_permlane32_swap_b32 v72, v74
    v_permlane32_swap_b32 v73, v75
    s_nop 1
    v_pk_add_f32 v[72:73], v[72:73], v[74:75]
    v_mul_f32 v72, 0x3a97b426, v72
    v_mul_f32 v73, 0x3a97b426, v73
    v_fma_f32 v73, -v72, v72, v73
    v_max_f32 v73, 0, v73
    v_add_f32 v73, 0x3727c5ac, v73
    v_rsq_f32 v74, v73
    s_nop 0
    v_mul_f32 v75, v72, v74
    v_sub_f32 v75, 0, v75
    s_lshl_b32 s48, s32, 8
    s_add_u32 s48, s48, 149760
    v_and_b32 v4, 31, v0
    v_lshlrev_b32 v4, 2, v4
    v_add_u32 v4, s48, v4
    ds_write_b32 v4, v74
    ds_write_b32 v4, v75 offset:128
    v_lshlrev_b32 v5, 4, v2
    v_add_u32 v5, s48, v5
    s_waitcnt lgkmcnt(0)
    ds_read_b128 v[64:67], v5 offset:0
    ds_read_b128 v[84:87], v5 offset:128
    ds_read_b128 v[68:71], v5 offset:64
    ds_read_b128 v[88:91], v5 offset:192
    s_mul_i32 s48, s38, 589824
    s_lshl_b32 s49, s37, 1
    s_lshr_b32 s50, s39, 1
    s_add_u32 s49, s49, s50
    s_mul_i32 s49, s49, 18432
    s_add_u32 s48, s48, s49
    s_and_b32 s49, s39, 1
    s_mul_i32 s49, s49, 9216
    s_add_u32 s48, s48, s49
    s_add_u32 s47, s48, 0
    s_mov_b32 s24, s6
    s_mov_b32 s25, s7
    s_mov_b32 s26, 0x360000
    s_mov_b32 s27, 0x00020000
    v_lshlrev_b32 v118, 4, v0
    s_waitcnt lgkmcnt(0)
    v_pk_fma_f32 v[16:17], v[16:17], v[64:65], v[84:85]
    v_pk_fma_f32 v[18:19], v[18:19], v[66:67], v[86:87]
    v_pk_fma_f32 v[20:21], v[20:21], v[68:69], v[88:89]
    v_pk_fma_f32 v[22:23], v[22:23], v[70:71], v[90:91]
    v_cvt_pk_bf16_f32 v108, v16, v17
    v_cvt_pk_bf16_f32 v109, v18, v19
    v_cvt_pk_bf16_f32 v110, v20, v21
    v_cvt_pk_bf16_f32 v111, v22, v23
    s_nop 1
    v_permlane32_swap_b32 v108, v110
    v_permlane32_swap_b32 v109, v111
    s_nop 1
    v_permlane16_swap_b32 v108, v110
    v_permlane16_swap_b32 v109, v111
    buffer_store_dwordx4 v[108:111], v118, s[24:27], s47 offen offset:0 sc1
    v_pk_fma_f32 v[24:25], v[24:25], v[64:65], v[84:85]
    v_pk_fma_f32 v[26:27], v[26:27], v[66:67], v[86:87]
    v_pk_fma_f32 v[28:29], v[28:29], v[68:69], v[88:89]
    v_pk_fma_f32 v[30:31], v[30:31], v[70:71], v[90:91]
    v_cvt_pk_bf16_f32 v112, v24, v25
    v_cvt_pk_bf16_f32 v113, v26, v27
    v_cvt_pk_bf16_f32 v114, v28, v29
    v_cvt_pk_bf16_f32 v115, v30, v31
    s_nop 1
    v_permlane32_swap_b32 v112, v114
    v_permlane32_swap_b32 v113, v115
    s_nop 1
    v_permlane16_swap_b32 v112, v114
    v_permlane16_swap_b32 v113, v115
    buffer_store_dwordx4 v[112:115], v118, s[24:27], s47 offen offset:1024 sc1
    v_pk_fma_f32 v[32:33], v[32:33], v[64:65], v[84:85]
    v_pk_fma_f32 v[34:35], v[34:35], v[66:67], v[86:87]
    v_pk_fma_f32 v[36:37], v[36:37], v[68:69], v[88:89]
    v_pk_fma_f32 v[38:39], v[38:39], v[70:71], v[90:91]
    v_cvt_pk_bf16_f32 v108, v32, v33
    v_cvt_pk_bf16_f32 v109, v34, v35
    v_cvt_pk_bf16_f32 v110, v36, v37
    v_cvt_pk_bf16_f32 v111, v38, v39
    s_nop 1
    v_permlane32_swap_b32 v108, v110
    v_permlane32_swap_b32 v109, v111
    s_nop 1
    v_permlane16_swap_b32 v108, v110
    v_permlane16_swap_b32 v109, v111
    buffer_store_dwordx4 v[108:111], v118, s[24:27], s47 offen offset:2048 sc1
    v_pk_fma_f32 v[40:41], v[40:41], v[64:65], v[84:85]
    v_pk_fma_f32 v[42:43], v[42:43], v[66:67], v[86:87]
    v_pk_fma_f32 v[44:45], v[44:45], v[68:69], v[88:89]
    v_pk_fma_f32 v[46:47], v[46:47], v[70:71], v[90:91]
    v_cvt_pk_bf16_f32 v112, v40, v41
    v_cvt_pk_bf16_f32 v113, v42, v43
    v_cvt_pk_bf16_f32 v114, v44, v45
    v_cvt_pk_bf16_f32 v115, v46, v47
    s_nop 1
    v_permlane32_swap_b32 v112, v114
    v_permlane32_swap_b32 v113, v115
    s_nop 1
    v_permlane16_swap_b32 v112, v114
    v_permlane16_swap_b32 v113, v115
    buffer_store_dwordx4 v[112:115], v118, s[24:27], s47 offen offset:3072 sc1
    v_pk_fma_f32 v[48:49], v[48:49], v[64:65], v[84:85]
    v_pk_fma_f32 v[50:51], v[50:51], v[66:67], v[86:87]
    v_pk_fma_f32 v[52:53], v[52:53], v[68:69], v[88:89]
    v_pk_fma_f32 v[54:55], v[54:55], v[70:71], v[90:91]
    v_cvt_pk_bf16_f32 v108, v48, v49
    v_cvt_pk_bf16_f32 v109, v50, v51
    v_cvt_pk_bf16_f32 v110, v52, v53
    v_cvt_pk_bf16_f32 v111, v54, v55
    s_nop 1
    v_permlane32_swap_b32 v108, v110
    v_permlane32_swap_b32 v109, v111
    s_nop 1
    v_permlane16_swap_b32 v108, v110
    v_permlane16_swap_b32 v109, v111
    s_add_u32 s47, s47, 4096
    buffer_store_dwordx4 v[108:111], v118, s[24:27], s47 offen sc1
    s_branch K1_end
K1c_z2_1:
    s_mov_b32 s41, 0
    s_mov_b32 s43, 0
    s_barrier
K1c_z2_1L_loop:
    s_setprio 1
    ds_read_b128 v[56:59], v112 offset:0
    ds_read_b128 v[60:63], v112 offset:2048
    ds_read_b64_tr_b16 v[64:65], v116 offset:16384
    ds_read_b64_tr_b16 v[66:67], v116 offset:20992
    ds_read_b64_tr_b16 v[68:69], v116 offset:16416
    ds_read_b64_tr_b16 v[70:71], v116 offset:21024
    ds_read_b64_tr_b16 v[72:73], v116 offset:16448
    ds_read_b64_tr_b16 v[74:75], v116 offset:21056
    ds_read_b64_tr_b16 v[76:77], v116 offset:16480
    ds_read_b64_tr_b16 v[78:79], v116 offset:21088
    ds_read_b128 v[84:87], v113 offset:0
    ds_read_b128 v[88:91], v113 offset:2048
    ds_read_b64_tr_b16 v[92:93], v116 offset:25600
    ds_read_b64_tr_b16 v[94:95], v116 offset:30208
    ds_read_b64_tr_b16 v[96:97], v116 offset:25632
    ds_read_b64_tr_b16 v[98:99], v116 offset:30240
    ds_read_b64_tr_b16 v[100:101], v116 offset:25664
    ds_read_b64_tr_b16 v[102:103], v116 offset:30272
    ds_read_b64_tr_b16 v[104:105], v116 offset:25696
    ds_read_b64_tr_b16 v[106:107], v116 offset:30304
    s_setprio 0
    s_mov_b32 s48, s43
    s_add_u32 s43, s43, 34816
    s_cmp_eq_u32 s43, 139264
    s_cselect_b32 s43, 0, s43
    s_sub_u32 s48, s43, s48
    s_add_u32 s41, s41, 1
    v_add_u32 v112, s48, v112
    v_add_u32 v113, s48, v113
    v_add_u32 v116, s48, v116
    s_cmp_eq_u32 s41, 2
    s_cbranch_scc0 K1c_z2_1L_nh0
    s_waitcnt vmcnt(0)
K1c_z2_1L_nh0:
    s_waitcnt lgkmcnt(10)
    v_mfma_f32_16x16x32_bf16 v[16:19], v[56:59], v[64:67], v[16:19]
    v_mfma_f32_16x16x32_bf16 v[20:23], v[60:63], v[64:67], v[20:23]
    v_mfma_f32_16x16x32_bf16 v[24:27], v[56:59], v[68:71], v[24:27]
    v_mfma_f32_16x16x32_bf16 v[28:31], v[60:63], v[68:71], v[28:31]
    v_mfma_f32_16x16x32_bf16 v[32:35], v[56:59], v[72:75], v[32:35]
    v_mfma_f32_16x16x32_bf16 v[36:39], v[60:63], v[72:75], v[36:39]
    v_mfma_f32_16x16x32_bf16 v[40:43], v[56:59], v[76:79], v[40:43]
    v_mfma_f32_16x16x32_bf16 v[44:47], v[60:63], v[76:79], v[44:47]
    s_waitcnt lgkmcnt(0)
    v_mfma_f32_16x16x32_bf16 v[16:19], v[84:87], v[92:95], v[16:19]
    v_mfma_f32_16x16x32_bf16 v[20:23], v[88:91], v[92:95], v[20:23]
    v_mfma_f32_16x16x32_bf16 v[24:27], v[84:87], v[96:99], v[24:27]
    v_mfma_f32_16x16x32_bf16 v[28:31], v[88:91], v[96:99], v[28:31]
    v_mfma_f32_16x16x32_bf16 v[32:35], v[84:87], v[100:103], v[32:35]
    v_mfma_f32_16x16x32_bf16 v[36:39], v[88:91], v[100:103], v[36:39]
    v_mfma_f32_16x16x32_bf16 v[40:43], v[84:87], v[104:107], v[40:43]
    v_mfma_f32_16x16x32_bf16 v[44:47], v[88:91], v[104:107], v[44:47]
    s_cmp_lt_u32 s41, 10
    s_cbranch_scc0 K1c_z2_1L_done
    s_barrier
    s_branch K1c_z2_1L_loop
K1c_z2_1L_done:
    s_barrier
    v_mov_b32 v112, 0xc0135761
    v_mov_b32 v113, 0xc0135761
    v_mov_b32 v114, 0xbdd2d3e8
    v_mov_b32 v115, 0xbdd2d3e8
    v_mov_b32 v116, 1.0
    v_mov_b32 v117, 1.0
    s_setprio 3
    s_lshl_b32 s48, s39, 7
    v_lshlrev_b32 v3, 4, v2
    v_add_u32 v3, s48, v3
    v_add_u32 v3, 147456, v3
    ds_read_b128 v[64:67], v3 offset:0
    ds_read_b128 v[72:75], v3 offset:512
    ds_read_b128 v[68:71], v3 offset:64
    ds_read_b128 v[76:79], v3 offset:576
    v_lshlrev_b32 v4, 2, v1
    v_add_u32 v4, 148800, v4
    ds_read_b32 v80, v4 offset:0
    ds_read_b32 v86, v4 offset:640
    ds_read_b32 v81, v4 offset:64
    ds_read_b32 v87, v4 offset:704
    ds_read_b32 v82, v4 offset:128
    ds_read_b32 v88, v4 offset:768
    ds_read_b32 v83, v4 offset:192
    ds_read_b32 v89, v4 offset:832
    v_mov_b32 v92, 0
    v_mov_b32 v100, 0
    v_mov_b32 v93, 0
    v_mov_b32 v101, 0
    v_mov_b32 v94, 0
    v_mov_b32 v102, 0
    v_mov_b32 v95, 0
    v_mov_b32 v103, 0
    v_mov_b32 v96, 0
    v_mov_b32 v104, 0
    v_mov_b32 v97, 0
    v_mov_b32 v105, 0
    v_mov_b32 v98, 0
    v_mov_b32 v106, 0
    v_mov_b32 v99, 0
    v_mov_b32 v107, 0
    s_add_u32 s50, s6, 0x8d0000
    s_addc_u32 s51, s7, 0
    s_mov_b32 s56, s50
    s_mov_b32 s57, s51
    s_mov_b32 s58, 0x30000
    s_mov_b32 s59, 0x00020000
    s_mul_i32 s47, s37, 12288
    s_lshl_b32 s48, s38, 1
    s_add_u32 s48, s48, 1
    s_lshl_b32 s48, s48, 10
    s_lshl_b32 s49, s39, 8
    s_add_u32 s48, s48, s49
    s_add_u32 s52, s47, s48
    s_waitcnt lgkmcnt(0)
    v_add_f32 v80, v80, v86
    v_add_f32 v81, v81, v87
    v_add_f32 v82, v82, v88
    v_add_f32 v83, v83, v89
    v_pk_mul_f32 v[56:57], v[72:73], v[80:81] op_sel:[0,0] op_sel_hi:[1,0]
    v_pk_mul_f32 v[58:59], v[74:75], v[80:81] op_sel:[0,0] op_sel_hi:[1,0]
    v_pk_mul_f32 v[60:61], v[76:77], v[80:81] op_sel:[0,0] op_sel_hi:[1,0]
    v_pk_mul_f32 v[62:63], v[78:79], v[80:81] op_sel:[0,0] op_sel_hi:[1,0]
    v_pk_fma_f32 v[16:17], v[16:17], v[64:65], v[56:57]
    v_pk_fma_f32 v[18:19], v[18:19], v[66:67], v[58:59]
    v_pk_fma_f32 v[20:21], v[20:21], v[68:69], v[60:61]
    v_pk_fma_f32 v[22:23], v[22:23], v[70:71], v[62:63]
    v_pk_mul_f32 v[56:57], v[16:17], v[16:17]
    v_pk_mul_f32 v[58:59], v[18:19], v[18:19]
    v_pk_mul_f32 v[60:61], v[20:21], v[20:21]
    v_pk_mul_f32 v[62:63], v[22:23], v[22:23]
    v_pk_fma_f32 v[56:57], v[56:57], v[114:115], v[112:113]
    v_pk_fma_f32 v[58:59], v[58:59], v[114:115], v[112:113]
    v_pk_fma_f32 v[60:61], v[60:61], v[114:115], v[112:113]
    v_pk_fma_f32 v[62:63], v[62:63], v[114:115], v[112:113]
    v_pk_mul_f32 v[56:57], v[56:57], v[16:17]
    v_pk_mul_f32 v[58:59], v[58:59], v[18:19]
    v_pk_mul_f32 v[60:61], v[60:61], v[20:21]
    v_pk_mul_f32 v[62:63], v[62:63], v[22:23]
    v_exp_f32 v56, v56
    v_exp_f32 v57, v57
    v_exp_f32 v58, v58
    v_exp_f32 v59, v59
    v_exp_f32 v60, v60
    v_exp_f32 v61, v61
    v_exp_f32 v62, v62
    v_exp_f32 v63, v63
    v_pk_add_f32 v[56:57], v[56:57], v[116:117]
    v_pk_add_f32 v[58:59], v[58:59], v[116:117]
    v_pk_add_f32 v[60:61], v[60:61], v[116:117]
    v_pk_add_f32 v[62:63], v[62:63], v[116:117]
    v_rcp_f32 v56, v56
    v_rcp_f32 v57, v57
    v_rcp_f32 v58, v58
    v_rcp_f32 v59, v59
    v_rcp_f32 v60, v60
    v_rcp_f32 v61, v61
    v_rcp_f32 v62, v62
    v_rcp_f32 v63, v63
    v_pk_mul_f32 v[16:17], v[16:17], v[56:57]
    v_pk_mul_f32 v[18:19], v[18:19], v[58:59]
    v_pk_mul_f32 v[20:21], v[20:21], v[60:61]
    v_pk_mul_f32 v[22:23], v[22:23], v[62:63]
    v_pk_add_f32 v[92:93], v[92:93], v[16:17]
    v_pk_fma_f32 v[100:101], v[16:17], v[16:17], v[100:101]
    v_pk_add_f32 v[94:95], v[94:95], v[18:19]
    v_pk_fma_f32 v[102:103], v[18:19], v[18:19], v[102:103]
    v_pk_add_f32 v[96:97], v[96:97], v[20:21]
    v_pk_fma_f32 v[104:105], v[20:21], v[20:21], v[104:105]
    v_pk_add_f32 v[98:99], v[98:99], v[22:23]
    v_pk_fma_f32 v[106:107], v[22:23], v[22:23], v[106:107]
    v_pk_mul_f32 v[56:57], v[72:73], v[80:81] op_sel:[0,1] op_sel_hi:[1,1]
    v_pk_mul_f32 v[58:59], v[74:75], v[80:81] op_sel:[0,1] op_sel_hi:[1,1]
    v_pk_mul_f32 v[60:61], v[76:77], v[80:81] op_sel:[0,1] op_sel_hi:[1,1]
    v_pk_mul_f32 v[62:63], v[78:79], v[80:81] op_sel:[0,1] op_sel_hi:[1,1]
    v_pk_fma_f32 v[24:25], v[24:25], v[64:65], v[56:57]
    v_pk_fma_f32 v[26:27], v[26:27], v[66:67], v[58:59]
    v_pk_fma_f32 v[28:29], v[28:29], v[68:69], v[60:61]
    v_pk_fma_f32 v[30:31], v[30:31], v[70:71], v[62:63]
    v_pk_mul_f32 v[56:57], v[24:25], v[24:25]
    v_pk_mul_f32 v[58:59], v[26:27], v[26:27]
    v_pk_mul_f32 v[60:61], v[28:29], v[28:29]
    v_pk_mul_f32 v[62:63], v[30:31], v[30:31]
    v_pk_fma_f32 v[56:57], v[56:57], v[114:115], v[112:113]
    v_pk_fma_f32 v[58:59], v[58:59], v[114:115], v[112:113]
    v_pk_fma_f32 v[60:61], v[60:61], v[114:115], v[112:113]
    v_pk_fma_f32 v[62:63], v[62:63], v[114:115], v[112:113]
    v_pk_mul_f32 v[56:57], v[56:57], v[24:25]
    v_pk_mul_f32 v[58:59], v[58:59], v[26:27]
    v_pk_mul_f32 v[60:61], v[60:61], v[28:29]
    v_pk_mul_f32 v[62:63], v[62:63], v[30:31]
    v_exp_f32 v56, v56
    v_exp_f32 v57, v57
    v_exp_f32 v58, v58
    v_exp_f32 v59, v59
    v_exp_f32 v60, v60
    v_exp_f32 v61, v61
    v_exp_f32 v62, v62
    v_exp_f32 v63, v63
    v_pk_add_f32 v[56:57], v[56:57], v[116:117]
    v_pk_add_f32 v[58:59], v[58:59], v[116:117]
    v_pk_add_f32 v[60:61], v[60:61], v[116:117]
    v_pk_add_f32 v[62:63], v[62:63], v[116:117]
    v_rcp_f32 v56, v56
    v_rcp_f32 v57, v57
    v_rcp_f32 v58, v58
    v_rcp_f32 v59, v59
    v_rcp_f32 v60, v60
    v_rcp_f32 v61, v61
    v_rcp_f32 v62, v62
    v_rcp_f32 v63, v63
    v_pk_mul_f32 v[24:25], v[24:25], v[56:57]
    v_pk_mul_f32 v[26:27], v[26:27], v[58:59]
    v_pk_mul_f32 v[28:29], v[28:29], v[60:61]
    v_pk_mul_f32 v[30:31], v[30:31], v[62:63]
    v_pk_add_f32 v[92:93], v[92:93], v[24:25]
    v_pk_fma_f32 v[100:101], v[24:25], v[24:25], v[100:101]
    v_pk_add_f32 v[94:95], v[94:95], v[26:27]
    v_pk_fma_f32 v[102:103], v[26:27], v[26:27], v[102:103]
    v_pk_add_f32 v[96:97], v[96:97], v[28:29]
    v_pk_fma_f32 v[104:105], v[28:29], v[28:29], v[104:105]
    v_pk_add_f32 v[98:99], v[98:99], v[30:31]
    v_pk_fma_f32 v[106:107], v[30:31], v[30:31], v[106:107]
    v_pk_mul_f32 v[56:57], v[72:73], v[82:83] op_sel:[0,0] op_sel_hi:[1,0]
    v_pk_mul_f32 v[58:59], v[74:75], v[82:83] op_sel:[0,0] op_sel_hi:[1,0]
    v_pk_mul_f32 v[60:61], v[76:77], v[82:83] op_sel:[0,0] op_sel_hi:[1,0]
    v_pk_mul_f32 v[62:63], v[78:79], v[82:83] op_sel:[0,0] op_sel_hi:[1,0]
    v_pk_fma_f32 v[32:33], v[32:33], v[64:65], v[56:57]
    v_pk_fma_f32 v[34:35], v[34:35], v[66:67], v[58:59]
    v_pk_fma_f32 v[36:37], v[36:37], v[68:69], v[60:61]
    v_pk_fma_f32 v[38:39], v[38:39], v[70:71], v[62:63]
    v_pk_mul_f32 v[56:57], v[32:33], v[32:33]
    v_pk_mul_f32 v[58:59], v[34:35], v[34:35]
    v_pk_mul_f32 v[60:61], v[36:37], v[36:37]
    v_pk_mul_f32 v[62:63], v[38:39], v[38:39]
    v_pk_fma_f32 v[56:57], v[56:57], v[114:115], v[112:113]
    v_pk_fma_f32 v[58:59], v[58:59], v[114:115], v[112:113]
    v_pk_fma_f32 v[60:61], v[60:61], v[114:115], v[112:113]
    v_pk_fma_f32 v[62:63], v[62:63], v[114:115], v[112:113]
    v_pk_mul_f32 v[56:57], v[56:57], v[32:33]
    v_pk_mul_f32 v[58:59], v[58:59], v[34:35]
    v_pk_mul_f32 v[60:61], v[60:61], v[36:37]
    v_pk_mul_f32 v[62:63], v[62:63], v[38:39]
    v_exp_f32 v56, v56
    v_exp_f32 v57, v57
    v_exp_f32 v58, v58
    v_exp_f32 v59, v59
    v_exp_f32 v60, v60
    v_exp_f32 v61, v61
    v_exp_f32 v62, v62
    v_exp_f32 v63, v63
    v_pk_add_f32 v[56:57], v[56:57], v[116:117]
    v_pk_add_f32 v[58:59], v[58:59], v[116:117]
    v_pk_add_f32 v[60:61], v[60:61], v[116:117]
    v_pk_add_f32 v[62:63], v[62:63], v[116:117]
    v_rcp_f32 v56, v56
    v_rcp_f32 v57, v57
    v_rcp_f32 v58, v58
    v_rcp_f32 v59, v59
    v_rcp_f32 v60, v60
    v_rcp_f32 v61, v61
    v_rcp_f32 v62, v62
    v_rcp_f32 v63, v63
    v_pk_mul_f32 v[32:33], v[32:33], v[56:57]
    v_pk_mul_f32 v[34:35], v[34:35], v[58:59]
    v_pk_mul_f32 v[36:37], v[36:37], v[60:61]
    v_pk_mul_f32 v[38:39], v[38:39], v[62:63]
    v_pk_add_f32 v[92:93], v[92:93], v[32:33]
    v_pk_fma_f32 v[100:101], v[32:33], v[32:33], v[100:101]
    v_pk_add_f32 v[94:95], v[94:95], v[34:35]
    v_pk_fma_f32 v[102:103], v[34:35], v[34:35], v[102:103]
    v_pk_add_f32 v[96:97], v[96:97], v[36:37]
    v_pk_fma_f32 v[104:105], v[36:37], v[36:37], v[104:105]
    v_pk_add_f32 v[98:99], v[98:99], v[38:39]
    v_pk_fma_f32 v[106:107], v[38:39], v[38:39], v[106:107]
    v_pk_mul_f32 v[56:57], v[72:73], v[82:83] op_sel:[0,1] op_sel_hi:[1,1]
    v_pk_mul_f32 v[58:59], v[74:75], v[82:83] op_sel:[0,1] op_sel_hi:[1,1]
    v_pk_mul_f32 v[60:61], v[76:77], v[82:83] op_sel:[0,1] op_sel_hi:[1,1]
    v_pk_mul_f32 v[62:63], v[78:79], v[82:83] op_sel:[0,1] op_sel_hi:[1,1]
    v_pk_fma_f32 v[40:41], v[40:41], v[64:65], v[56:57]
    v_pk_fma_f32 v[42:43], v[42:43], v[66:67], v[58:59]
    v_pk_fma_f32 v[44:45], v[44:45], v[68:69], v[60:61]
    v_pk_fma_f32 v[46:47], v[46:47], v[70:71], v[62:63]
    v_pk_mul_f32 v[56:57], v[40:41], v[40:41]
    v_pk_mul_f32 v[58:59], v[42:43], v[42:43]
    v_pk_mul_f32 v[60:61], v[44:45], v[44:45]
    v_pk_mul_f32 v[62:63], v[46:47], v[46:47]
    v_pk_fma_f32 v[56:57], v[56:57], v[114:115], v[112:113]
    v_pk_fma_f32 v[58:59], v[58:59], v[114:115], v[112:113]
    v_pk_fma_f32 v[60:61], v[60:61], v[114:115], v[112:113]
    v_pk_fma_f32 v[62:63], v[62:63], v[114:115], v[112:113]
    v_pk_mul_f32 v[56:57], v[56:57], v[40:41]
    v_pk_mul_f32 v[58:59], v[58:59], v[42:43]
    v_pk_mul_f32 v[60:61], v[60:61], v[44:45]
    v_pk_mul_f32 v[62:63], v[62:63], v[46:47]
    v_exp_f32 v56, v56
    v_exp_f32 v57, v57
    v_exp_f32 v58, v58
    v_exp_f32 v59, v59
    v_exp_f32 v60, v60
    v_exp_f32 v61, v61
    v_exp_f32 v62, v62
    v_exp_f32 v63, v63
    v_pk_add_f32 v[56:57], v[56:57], v[116:117]
    v_pk_add_f32 v[58:59], v[58:59], v[116:117]
    v_pk_add_f32 v[60:61], v[60:61], v[116:117]
    v_pk_add_f32 v[62:63], v[62:63], v[116:117]
    v_rcp_f32 v56, v56
    v_rcp_f32 v57, v57
    v_rcp_f32 v58, v58
    v_rcp_f32 v59, v59
    v_rcp_f32 v60, v60
    v_rcp_f32 v61, v61
    v_rcp_f32 v62, v62
    v_rcp_f32 v63, v63
    v_pk_mul_f32 v[40:41], v[40:41], v[56:57]
    v_pk_mul_f32 v[42:43], v[42:43], v[58:59]
    v_pk_mul_f32 v[44:45], v[44:45], v[60:61]
    v_pk_mul_f32 v[46:47], v[46:47], v[62:63]
    v_pk_add_f32 v[92:93], v[92:93], v[40:41]
    v_pk_fma_f32 v[100:101], v[40:41], v[40:41], v[100:101]
    v_pk_add_f32 v[94:95], v[94:95], v[42:43]
    v_pk_fma_f32 v[102:103], v[42:43], v[42:43], v[102:103]
    v_pk_add_f32 v[96:97], v[96:97], v[44:45]
    v_pk_fma_f32 v[104:105], v[44:45], v[44:45], v[104:105]
    v_pk_add_f32 v[98:99], v[98:99], v[46:47]
    v_pk_fma_f32 v[106:107], v[46:47], v[46:47], v[106:107]
    v_add_f32_dpp v92, v92, v92 row_ror:8 row_mask:0xf bank_mask:0xf
    v_add_f32_dpp v93, v93, v93 row_ror:8 row_mask:0xf bank_mask:0xf
    v_add_f32_dpp v94, v94, v94 row_ror:8 row_mask:0xf bank_mask:0xf
    v_add_f32_dpp v95, v95, v95 row_ror:8 row_mask:0xf bank_mask:0xf
    v_add_f32_dpp v96, v96, v96 row_ror:8 row_mask:0xf bank_mask:0xf
    v_add_f32_dpp v97, v97, v97 row_ror:8 row_mask:0xf bank_mask:0xf
    v_add_f32_dpp v98, v98, v98 row_ror:8 row_mask:0xf bank_mask:0xf
    v_add_f32_dpp v99, v99, v99 row_ror:8 row_mask:0xf bank_mask:0xf
    v_add_f32_dpp v100, v100, v100 row_ror:8 row_mask:0xf bank_mask:0xf
    v_add_f32_dpp v101, v101, v101 row_ror:8 row_mask:0xf bank_mask:0xf
    v_add_f32_dpp v102, v102, v102 row_ror:8 row_mask:0xf bank_mask:0xf
    v_add_f32_dpp v103, v103, v103 row_ror:8 row_mask:0xf bank_mask:0xf
    v_add_f32_dpp v104, v104, v104 row_ror:8 row_mask:0xf bank_mask:0xf
    v_add_f32_dpp v105, v105, v105 row_ror:8 row_mask:0xf bank_mask:0xf
    v_add_f32_dpp v106, v106, v106 row_ror:8 row_mask:0xf bank_mask:0xf
    v_add_f32_dpp v107, v107, v107 row_ror:8 row_mask:0xf bank_mask:0xf
    v_add_f32_dpp v92, v92, v92 row_ror:4 row_mask:0xf bank_mask:0xf
    v_add_f32_dpp v93, v93, v93 row_ror:4 row_mask:0xf bank_mask:0xf
    v_add_f32_dpp v94, v94, v94 row_ror:4 row_mask:0xf bank_mask:0xf
    v_add_f32_dpp v95, v95, v95 row_ror:4 row_mask:0xf bank_mask:0xf
    v_add_f32_dpp v96, v96, v96 row_ror:4 row_mask:0xf bank_mask:0xf
    v_add_f32_dpp v97, v97, v97 row_ror:4 row_mask:0xf bank_mask:0xf
    v_add_f32_dpp v98, v98, v98 row_ror:4 row_mask:0xf bank_mask:0xf
    v_add_f32_dpp v99, v99, v99 row_ror:4 row_mask:0xf bank_mask:0xf
    v_add_f32_dpp v100, v100, v100 row_ror:4 row_mask:0xf bank_mask:0xf
    v_add_f32_dpp v101, v101, v101 row_ror:4 row_mask:0xf bank_mask:0xf
    v_add_f32_dpp v102, v102, v102 row_ror:4 row_mask:0xf bank_mask:0xf
    v_add_f32_dpp v103, v103, v103 row_ror:4 row_mask:0xf bank_mask:0xf
    v_add_f32_dpp v104, v104, v104 row_ror:4 row_mask:0xf bank_mask:0xf
    v_add_f32_dpp v105, v105, v105 row_ror:4 row_mask:0xf bank_mask:0xf
    v_add_f32_dpp v106, v106, v106 row_ror:4 row_mask:0xf bank_mask:0xf
    v_add_f32_dpp v107, v107, v107 row_ror:4 row_mask:0xf bank_mask:0xf
    v_add_f32_dpp v92, v92, v92 row_ror:2 row_mask:0xf bank_mask:0xf
    v_add_f32_dpp v93, v93, v93 row_ror:2 row_mask:0xf bank_mask:0xf
    v_add_f32_dpp v94, v94, v94 row_ror:2 row_mask:0xf bank_mask:0xf
    v_add_f32_dpp v95, v95, v95 row_ror:2 row_mask:0xf bank_mask:0xf
    v_add_f32_dpp v96, v96, v96 row_ror:2 row_mask:0xf bank_mask:0xf
    v_add_f32_dpp v97, v97, v97 row_ror:2 row_mask:0xf bank_mask:0xf
    v_add_f32_dpp v98, v98, v98 row_ror:2 row_mask:0xf bank_mask:0xf
    v_add_f32_dpp v99, v99, v99 row_ror:2 row_mask:0xf bank_mask:0xf
    v_add_f32_dpp v100, v100, v100 row_ror:2 row_mask:0xf bank_mask:0xf
    v_add_f32_dpp v101, v101, v101 row_ror:2 row_mask:0xf bank_mask:0xf
    v_add_f32_dpp v102, v102, v102 row_ror:2 row_mask:0xf bank_mask:0xf
    v_add_f32_dpp v103, v103, v103 row_ror:2 row_mask:0xf bank_mask:0xf
    v_add_f32_dpp v104, v104, v104 row_ror:2 row_mask:0xf bank_mask:0xf
    v_add_f32_dpp v105, v105, v105 row_ror:2 row_mask:0xf bank_mask:0xf
    v_add_f32_dpp v106, v106, v106 row_ror:2 row_mask:0xf bank_mask:0xf
    v_add_f32_dpp v107, v107, v107 row_ror:2 row_mask:0xf bank_mask:0xf
    v_add_f32_dpp v56, v92, v92 row_ror:1 row_mask:0xf bank_mask:0xf
    v_add_f32_dpp v58, v93, v93 row_ror:1 row_mask:0xf bank_mask:0xf
    v_add_f32_dpp v60, v94, v94 row_ror:1 row_mask:0xf bank_mask:0xf
    v_add_f32_dpp v62, v95, v95 row_ror:1 row_mask:0xf bank_mask:0xf
    v_add_f32_dpp v64, v96, v96 row_ror:1 row_mask:0xf bank_mask:0xf
    v_add_f32_dpp v66, v97, v97 row_ror:1 row_mask:0xf bank_mask:0xf
    v_add_f32_dpp v68, v98, v98 row_ror:1 row_mask:0xf bank_mask:0xf
    v_add_f32_dpp v70, v99, v99 row_ror:1 row_mask:0xf bank_mask:0xf
    v_add_f32_dpp v57, v100, v100 row_ror:1 row_mask:0xf bank_mask:0xf
    v_add_f32_dpp v59, v101, v101 row_ror:1 row_mask:0xf bank_mask:0xf
    v_add_f32_dpp v61, v102, v102 row_ror:1 row_mask:0xf bank_mask:0xf
    v_add_f32_dpp v63, v103, v103 row_ror:1 row_mask:0xf bank_mask:0xf
    v_add_f32_dpp v65, v104, v104 row_ror:1 row_mask:0xf bank_mask:0xf
    v_add_f32_dpp v67, v105, v105 row_ror:1 row_mask:0xf bank_mask:0xf
    v_add_f32_dpp v69, v106, v106 row_ror:1 row_mask:0xf bank_mask:0xf
    v_add_f32_dpp v71, v107, v107 row_ror:1 row_mask:0xf bank_mask:0xf
    v_lshlrev_b32 v3, 5, v2
    v_cmp_eq_u32 vcc, 0, v1
    s_and_saveexec_b64 s[54:55], vcc
    buffer_store_dwordx4 v[56:59], v3, s[56:59], s52 offen offset:0 sc1
    buffer_store_dwordx4 v[60:63], v3, s[56:59], s52 offen offset:16 sc1
    buffer_store_dwordx4 v[64:67], v3, s[56:59], s52 offen offset:128 sc1
    buffer_store_dwordx4 v[68:71], v3, s[56:59], s52 offen offset:144 sc1
    s_mov_b64 exec, s[54:55]
    v_and_b32 v4, 31, v0
    v_lshrrev_b32 v5, 5, v0
    v_mul_u32_u24 v5, 6144, v5
    v_lshl_add_u32 v4, v4, 3, v5
    s_lshl_b32 s49, s39, 8
    v_add_u32 v4, s49, v4
    v_add_u32 v5, 4096, v4
    s_mov_b32 s41, 0
K1c_z2_1_poll:
    buffer_load_dwordx2 v[72:73], v4, s[56:59], s47 offen offset:0 sc1
    buffer_load_dwordx2 v[74:75], v4, s[56:59], s47 offen offset:1024 sc1
    buffer_load_dwordx2 v[76:77], v4, s[56:59], s47 offen offset:2048 sc1
    buffer_load_dwordx2 v[78:79], v4, s[56:59], s47 offen offset:3072 sc1
    buffer_load_dwordx2 v[80:81], v5, s[56:59], s47 offen offset:0 sc1
    buffer_load_dwordx2 v[82:83], v5, s[56:59], s47 offen offset:1024 sc1
    s_waitcnt vmcnt(0)
    v_max3_u32 v6, v72, v73, v74
    v_max3_u32 v6, v6, v75, v76
    v_max3_u32 v6, v6, v77, v78
    v_max3_u32 v6, v6, v79, v80
    v_max3_u32 v6, v6, v81, v82
    v_max_u32 v6, v6, v83
    v_cmp_eq_u32 s[54:55], -1, v6
    s_nop 1
    s_cmp_eq_u64 s[54:55], 0
    s_cbranch_scc1 K1c_z2_1_rdy
    s_add_u32 s41, s41, 1
    s_cmp_lt_u32 s41, 4000
    s_cbranch_scc1 K1c_z2_1_poll
K1c_z2_1_rdy:
    v_pk_add_f32 v[72:73], v[72:73], v[74:75]
    v_pk_add_f32 v[76:77], v[76:77], v[78:79]
    v_pk_add_f32 v[80:81], v[80:81], v[82:83]
    v_pk_add_f32 v[72:73], v[72:73], v[76:77]
    v_pk_add_f32 v[72:73], v[72:73], v[80:81]
    v_mov_b32 v74, v72
    v_mov_b32 v75, v73
    s_nop 1
    v_permlane32_swap_b32 v72, v74
    v_permlane32_swap_b32 v73, v75
    s_nop 1
    v_pk_add_f32 v[72:73], v[72:73], v[74:75]
    v_mul_f32 v72, 0x3a97b426, v72
    v_mul_f32 v73, 0x3a97b426, v73
    v_fma_f32 v73, -v72, v72, v73
    v_max_f32 v73, 0, v73
    v_add_f32 v73, 0x3727c5ac, v73
    v_rsq_f32 v74, v73
    s_nop 0
    v_mul_f32 v75, v72, v74
    v_sub_f32 v75, 0, v75
    s_lshl_b32 s48, s32, 8
    s_add_u32 s48, s48, 149760
    v_and_b32 v4, 31, v0
    v_lshlrev_b32 v4, 2, v4
    v_add_u32 v4, s48, v4
    ds_write_b32 v4, v74
    ds_write_b32 v4, v75 offset:128
    v_lshlrev_b32 v5, 4, v2
    v_add_u32 v5, s48, v5
    s_waitcnt lgkmcnt(0)
    ds_read_b128 v[64:67], v5 offset:0
    ds_read_b128 v[84:87], v5 offset:128
    ds_read_b128 v[68:71], v5 offset:64
    ds_read_b128 v[88:91], v5 offset:192
    s_mul_i32 s48, s38, 589824
    s_lshl_b32 s49, s37, 1
    s_lshr_b32 s50, s39, 1
    s_add_u32 s49, s49, s50
    s_mul_i32 s49, s49, 18432
    s_add_u32 s48, s48, s49
    s_and_b32 s49, s39, 1
    s_mul_i32 s49, s49, 9216
    s_add_u32 s48, s48, s49
    s_add_u32 s47, s48, 5120
    s_mov_b32 s24, s6
    s_mov_b32 s25, s7
    s_mov_b32 s26, 0x360000
    s_mov_b32 s27, 0x00020000
    v_lshlrev_b32 v118, 4, v0
    s_waitcnt lgkmcnt(0)
    v_pk_fma_f32 v[16:17], v[16:17], v[64:65], v[84:85]
    v_pk_fma_f32 v[18:19], v[18:19], v[66:67], v[86:87]
    v_pk_fma_f32 v[20:21], v[20:21], v[68:69], v[88:89]
    v_pk_fma_f32 v[22:23], v[22:23], v[70:71], v[90:91]
    v_cvt_pk_bf16_f32 v108, v16, v17
    v_cvt_pk_bf16_f32 v109, v18, v19
    v_cvt_pk_bf16_f32 v110, v20, v21
    v_cvt_pk_bf16_f32 v111, v22, v23
    s_nop 1
    v_permlane32_swap_b32 v108, v110
    v_permlane32_swap_b32 v109, v111
    s_nop 1
    v_permlane16_swap_b32 v108, v110
    v_permlane16_swap_b32 v109, v111
    buffer_store_dwordx4 v[108:111], v118, s[24:27], s47 offen offset:0 sc1
    v_pk_fma_f32 v[24:25], v[24:25], v[64:65], v[84:85]
    v_pk_fma_f32 v[26:27], v[26:27], v[66:67], v[86:87]
    v_pk_fma_f32 v[28:29], v[28:29], v[68:69], v[88:89]
    v_pk_fma_f32 v[30:31], v[30:31], v[70:71], v[90:91]
    v_cvt_pk_bf16_f32 v112, v24, v25
    v_cvt_pk_bf16_f32 v113, v26, v27
    v_cvt_pk_bf16_f32 v114, v28, v29
    v_cvt_pk_bf16_f32 v115, v30, v31
    s_nop 1
    v_permlane32_swap_b32 v112, v114
    v_permlane32_swap_b32 v113, v115
    s_nop 1
    v_permlane16_swap_b32 v112, v114
    v_permlane16_swap_b32 v113, v115
    buffer_store_dwordx4 v[112:115], v118, s[24:27], s47 offen offset:1024 sc1
    v_pk_fma_f32 v[32:33], v[32:33], v[64:65], v[84:85]
    v_pk_fma_f32 v[34:35], v[34:35], v[66:67], v[86:87]
    v_pk_fma_f32 v[36:37], v[36:37], v[68:69], v[88:89]
    v_pk_fma_f32 v[38:39], v[38:39], v[70:71], v[90:91]
    v_cvt_pk_bf16_f32 v108, v32, v33
    v_cvt_pk_bf16_f32 v109, v34, v35
    v_cvt_pk_bf16_f32 v110, v36, v37
    v_cvt_pk_bf16_f32 v111, v38, v39
    s_nop 1
    v_permlane32_swap_b32 v108, v110
    v_permlane32_swap_b32 v109, v111
    s_nop 1
    v_permlane16_swap_b32 v108, v110
    v_permlane16_swap_b32 v109, v111
    buffer_store_dwordx4 v[108:111], v118, s[24:27], s47 offen offset:2048 sc1
    v_pk_fma_f32 v[40:41], v[40:41], v[64:65], v[84:85]
    v_pk_fma_f32 v[42:43], v[42:43], v[66:67], v[86:87]
    v_pk_fma_f32 v[44:45], v[44:45], v[68:69], v[88:89]
    v_pk_fma_f32 v[46:47], v[46:47], v[70:71], v[90:91]
    v_cvt_pk_bf16_f32 v112, v40, v41
    v_cvt_pk_bf16_f32 v113, v42, v43
    v_cvt_pk_bf16_f32 v114, v44, v45
    v_cvt_pk_bf16_f32 v115, v46, v47
    s_nop 1
    v_permlane32_swap_b32 v112, v114
    v_permlane32_swap_b32 v113, v115
    s_nop 1
    v_permlane16_swap_b32 v112, v114
    v_permlane16_swap_b32 v113, v115
    buffer_store_dwordx4 v[112:115], v118, s[24:27], s47 offen offset:3072 sc1
    s_branch K1_end
K1c_z1_0:
    s_mov_b32 s41, 0
    s_mov_b32 s43, 0
    s_barrier
    ds_read_b128 v[56:59], v112 offset:0
    ds_read_b128 v[60:63], v112 offset:2048
    ds_read_b64_tr_b16 v[64:65], v116 offset:16384
    ds_read_b64_tr_b16 v[66:67], v116 offset:20992
    ds_read_b64_tr_b16 v[68:69], v116 offset:16416
    ds_read_b64_tr_b16 v[70:71], v116 offset:21024
    ds_read_b64_tr_b16 v[72:73], v116 offset:16448
    ds_read_b64_tr_b16 v[74:75], v116 offset:21056
    ds_read_b64_tr_b16 v[76:77], v116 offset:16480
    ds_read_b64_tr_b16 v[78:79], v116 offset:21088
    ds_read_b64_tr_b16 v[80:81], v116 offset:16512
    ds_read_b64_tr_b16 v[82:83], v116 offset:21120
    ds_read_b128 v[84:87], v113 offset:0
    ds_read_b128 v[88:91], v113 offset:2048
    ds_read_b64_tr_b16 v[92:93], v116 offset:25600
    ds_read_b64_tr_b16 v[94:95], v116 offset:30208
    ds_read_b64_tr_b16 v[96:97], v116 offset:25632
    ds_read_b64_tr_b16 v[98:99], v116 offset:30240
    ds_read_b64_tr_b16 v[100:101], v116 offset:25664
    ds_read_b64_tr_b16 v[102:103], v116 offset:30272
    ds_read_b64_tr_b16 v[104:105], v116 offset:25696
    ds_read_b64_tr_b16 v[106:107], v116 offset:30304
    ds_read_b64_tr_b16 v[108:109], v116 offset:25728
    ds_read_b64_tr_b16 v[110:111], v116 offset:30336
    s_mov_b32 s48, s43
    s_add_u32 s43, s43, 34816
    s_cmp_eq_u32 s43, 139264
    s_cselect_b32 s43, 0, s43
    s_sub_u32 s48, s43, s48
    s_add_u32 s41, s41, 1
    v_add_u32 v112, s48, v112
    v_add_u32 v113, s48, v113
    v_add_u32 v116, s48, v116
    s_waitcnt lgkmcnt(0)
K1c_z1_0L_loop:
    s_barrier
    v_mfma_f32_16x16x32_bf16 v[16:19], v[64:67], v[56:59], v[16:19]
    v_mfma_f32_16x16x32_bf16 v[20:23], v[64:67], v[60:63], v[20:23]
    v_mfma_f32_16x16x32_bf16 v[24:27], v[68:71], v[56:59], v[24:27]
    v_mfma_f32_16x16x32_bf16 v[28:31], v[68:71], v[60:63], v[28:31]
    v_mfma_f32_16x16x32_bf16 v[32:35], v[72:75], v[56:59], v[32:35]
    v_mfma_f32_16x16x32_bf16 v[36:39], v[72:75], v[60:63], v[36:39]
    v_mfma_f32_16x16x32_bf16 v[40:43], v[76:79], v[56:59], v[40:43]
    v_mfma_f32_16x16x32_bf16 v[44:47], v[76:79], v[60:63], v[44:47]
    v_mfma_f32_16x16x32_bf16 v[48:51], v[80:83], v[56:59], v[48:51]
    v_mfma_f32_16x16x32_bf16 v[52:55], v[80:83], v[60:63], v[52:55]
    v_mfma_f32_16x16x32_bf16 v[16:19], v[92:95], v[84:87], v[16:19]
    v_mfma_f32_16x16x32_bf16 v[20:23], v[92:95], v[88:91], v[20:23]
    ds_read_b128 v[56:59], v112 offset:0
    ds_read_b128 v[60:63], v112 offset:2048
    v_mfma_f32_16x16x32_bf16 v[24:27], v[96:99], v[84:87], v[24:27]
    ds_read_b64_tr_b16 v[64:65], v116 offset:16384
    ds_read_b64_tr_b16 v[66:67], v116 offset:20992
    v_mfma_f32_16x16x32_bf16 v[28:31], v[96:99], v[88:91], v[28:31]
    ds_read_b64_tr_b16 v[68:69], v116 offset:16416
    ds_read_b64_tr_b16 v[70:71], v116 offset:21024
    v_mfma_f32_16x16x32_bf16 v[32:35], v[100:103], v[84:87], v[32:35]
    ds_read_b64_tr_b16 v[72:73], v116 offset:16448
    ds_read_b64_tr_b16 v[74:75], v116 offset:21056
    v_mfma_f32_16x16x32_bf16 v[36:39], v[100:103], v[88:91], v[36:39]
    ds_read_b64_tr_b16 v[76:77], v116 offset:16480
    ds_read_b64_tr_b16 v[78:79], v116 offset:21088
    v_mfma_f32_16x16x32_bf16 v[40:43], v[104:107], v[84:87], v[40:43]
    ds_read_b64_tr_b16 v[80:81], v116 offset:16512
    ds_read_b64_tr_b16 v[82:83], v116 offset:21120
    v_mfma_f32_16x16x32_bf16 v[44:47], v[104:107], v[88:91], v[44:47]
    v_mfma_f32_16x16x32_bf16 v[48:51], v[108:111], v[84:87], v[48:51]
    v_mfma_f32_16x16x32_bf16 v[52:55], v[108:111], v[88:91], v[52:55]
    ds_read_b128 v[84:87], v113 offset:0
    ds_read_b128 v[88:91], v113 offset:2048
    ds_read_b64_tr_b16 v[92:93], v116 offset:25600
    ds_read_b64_tr_b16 v[94:95], v116 offset:30208
    ds_read_b64_tr_b16 v[96:97], v116 offset:25632
    ds_read_b64_tr_b16 v[98:99], v116 offset:30240
    ds_read_b64_tr_b16 v[100:101], v116 offset:25664
    ds_read_b64_tr_b16 v[102:103], v116 offset:30272
    ds_read_b64_tr_b16 v[104:105], v116 offset:25696
    ds_read_b64_tr_b16 v[106:107], v116 offset:30304
    ds_read_b64_tr_b16 v[108:109], v116 offset:25728
    ds_read_b64_tr_b16 v[110:111], v116 offset:30336
    s_mov_b32 s48, s43
    s_add_u32 s43, s43, 34816
    s_cmp_eq_u32 s43, 139264
    s_cselect_b32 s43, 0, s43
    s_sub_u32 s48, s43, s48
    s_add_u32 s41, s41, 1
    v_add_u32 v112, s48, v112
    v_add_u32 v113, s48, v113
    v_add_u32 v116, s48, v116
    s_cmp_eq_u32 s41, 2
    s_cbranch_scc0 K1c_z1_0L_nh0
    s_waitcnt vmcnt(0)
K1c_z1_0L_nh0:
    s_waitcnt lgkmcnt(0)
    s_cmp_lt_u32 s41, 10
    s_cbranch_scc1 K1c_z1_0L_loop
    v_mfma_f32_16x16x32_bf16 v[16:19], v[64:67], v[56:59], v[16:19]
    v_mfma_f32_16x16x32_bf16 v[20:23], v[64:67], v[60:63], v[20:23]
    v_mfma_f32_16x16x32_bf16 v[24:27], v[68:71], v[56:59], v[24:27]
    v_mfma_f32_16x16x32_bf16 v[28:31], v[68:71], v[60:63], v[28:31]
    v_mfma_f32_16x16x32_bf16 v[32:35], v[72:75], v[56:59], v[32:35]
    v_mfma_f32_16x16x32_bf16 v[36:39], v[72:75], v[60:63], v[36:39]
    v_mfma_f32_16x16x32_bf16 v[40:43], v[76:79], v[56:59], v[40:43]
    v_mfma_f32_16x16x32_bf16 v[44:47], v[76:79], v[60:63], v[44:47]
    v_mfma_f32_16x16x32_bf16 v[48:51], v[80:83], v[56:59], v[48:51]
    v_mfma_f32_16x16x32_bf16 v[52:55], v[80:83], v[60:63], v[52:55]
    v_mfma_f32_16x16x32_bf16 v[16:19], v[92:95], v[84:87], v[16:19]
    v_mfma_f32_16x16x32_bf16 v[20:23], v[92:95], v[88:91], v[20:23]
    v_mfma_f32_16x16x32_bf16 v[24:27], v[96:99], v[84:87], v[24:27]
    v_mfma_f32_16x16x32_bf16 v[28:31], v[96:99], v[88:91], v[28:31]
    v_mfma_f32_16x16x32_bf16 v[32:35], v[100:103], v[84:87], v[32:35]
    v_mfma_f32_16x16x32_bf16 v[36:39], v[100:103], v[88:91], v[36:39]
    v_mfma_f32_16x16x32_bf16 v[40:43], v[104:107], v[84:87], v[40:43]
    v_mfma_f32_16x16x32_bf16 v[44:47], v[104:107], v[88:91], v[44:47]
    v_mfma_f32_16x16x32_bf16 v[48:51], v[108:111], v[84:87], v[48:51]
    v_mfma_f32_16x16x32_bf16 v[52:55], v[108:111], v[88:91], v[52:55]
    s_barrier
    v_mov_b32 v112, 0xc0135761
    v_mov_b32 v113, 0xc0135761
    v_mov_b32 v114, 0xbdd2d3e8
    v_mov_b32 v115, 0xbdd2d3e8
    v_mov_b32 v116, 1.0
    v_mov_b32 v117, 1.0
    s_lshl_b32 s48, s39, 7
    v_lshlrev_b32 v3, 2, v1
    v_add_u32 v3, s48, v3
    v_add_u32 v3, 147456, v3
    ds_read_b32 v64, v3 offset:0
    ds_read_b32 v66, v3 offset:512
    ds_read_b32 v65, v3 offset:64
    ds_read_b32 v67, v3 offset:576
    v_lshlrev_b32 v4, 4, v2
    v_add_u32 v4, 148480, v4
    ds_read_b128 v[68:71], v4 offset:0
    ds_read_b128 v[88:91], v4 offset:640
    ds_read_b128 v[72:75], v4 offset:64
    ds_read_b128 v[92:95], v4 offset:704
    ds_read_b128 v[76:79], v4 offset:128
    ds_read_b128 v[96:99], v4 offset:768
    ds_read_b128 v[80:83], v4 offset:192
    ds_read_b128 v[100:103], v4 offset:832
    ds_read_b128 v[84:87], v4 offset:256
    ds_read_b128 v[104:107], v4 offset:896
    s_mul_i32 s48, s37, 6
    s_add_u32 s48, s48, s38
    s_lshl_b32 s48, s48, 3
    s_add_u32 s48, s48, s32
    s_mul_i32 s47, s48, 5120
    s_add_u32 s50, s6, 0x380000
    s_addc_u32 s51, s7, 0
    s_mov_b32 s24, s50
    s_mov_b32 s25, s51
    s_mov_b32 s26, 0x3c0000
    s_mov_b32 s27, 0x00020000
    v_lshlrev_b32 v118, 4, v0
    s_waitcnt lgkmcnt(0)
    v_pk_add_f32 v[68:69], v[68:69], v[88:89]
    v_pk_add_f32 v[70:71], v[70:71], v[90:91]
    v_pk_add_f32 v[72:73], v[72:73], v[92:93]
    v_pk_add_f32 v[74:75], v[74:75], v[94:95]
    v_pk_add_f32 v[76:77], v[76:77], v[96:97]
    v_pk_add_f32 v[78:79], v[78:79], v[98:99]
    v_pk_add_f32 v[80:81], v[80:81], v[100:101]
    v_pk_add_f32 v[82:83], v[82:83], v[102:103]
    v_pk_add_f32 v[84:85], v[84:85], v[104:105]
    v_pk_add_f32 v[86:87], v[86:87], v[106:107]
    v_pk_mul_f32 v[56:57], v[68:69], v[66:67] op_sel:[0,0] op_sel_hi:[1,0]
    v_pk_mul_f32 v[58:59], v[70:71], v[66:67] op_sel:[0,0] op_sel_hi:[1,0]
    v_pk_mul_f32 v[60:61], v[68:69], v[66:67] op_sel:[0,1] op_sel_hi:[1,1]
    v_pk_mul_f32 v[62:63], v[70:71], v[66:67] op_sel:[0,1] op_sel_hi:[1,1]
    v_pk_fma_f32 v[16:17], v[16:17], v[64:65], v[56:57] op_sel:[0,0,0] op_sel_hi:[1,0,1]
    v_pk_fma_f32 v[18:19], v[18:19], v[64:65], v[58:59] op_sel:[0,0,0] op_sel_hi:[1,0,1]
    v_pk_fma_f32 v[20:21], v[20:21], v[64:65], v[60:61] op_sel:[0,1,0] op_sel_hi:[1,1,1]
    v_pk_fma_f32 v[22:23], v[22:23], v[64:65], v[62:63] op_sel:[0,1,0] op_sel_hi:[1,1,1]
    v_pk_mul_f32 v[56:57], v[16:17], v[16:17]
    v_pk_mul_f32 v[58:59], v[18:19], v[18:19]
    v_pk_mul_f32 v[60:61], v[20:21], v[20:21]
    v_pk_mul_f32 v[62:63], v[22:23], v[22:23]
    v_pk_fma_f32 v[56:57], v[56:57], v[114:115], v[112:113]
    v_pk_fma_f32 v[58:59], v[58:59], v[114:115], v[112:113]
    v_pk_fma_f32 v[60:61], v[60:61], v[114:115], v[112:113]
    v_pk_fma_f32 v[62:63], v[62:63], v[114:115], v[112:113]
    v_pk_mul_f32 v[56:57], v[56:57], v[16:17]
    v_pk_mul_f32 v[58:59], v[58:59], v[18:19]
    v_pk_mul_f32 v[60:61], v[60:61], v[20:21]
    v_pk_mul_f32 v[62:63], v[62:63], v[22:23]
    v_exp_f32 v56, v56
    v_exp_f32 v57, v57
    v_exp_f32 v58, v58
    v_exp_f32 v59, v59
    v_exp_f32 v60, v60
    v_exp_f32 v61, v61
    v_exp_f32 v62, v62
    v_exp_f32 v63, v63
    v_pk_add_f32 v[56:57], v[56:57], v[116:117]
    v_pk_add_f32 v[58:59], v[58:59], v[116:117]
    v_pk_add_f32 v[60:61], v[60:61], v[116:117]
    v_pk_add_f32 v[62:63], v[62:63], v[116:117]
    v_rcp_f32 v56, v56
    v_rcp_f32 v57, v57
    v_rcp_f32 v58, v58
    v_rcp_f32 v59, v59
    v_rcp_f32 v60, v60
    v_rcp_f32 v61, v61
    v_rcp_f32 v62, v62
    v_rcp_f32 v63, v63
    v_pk_mul_f32 v[16:17], v[16:17], v[56:57]
    v_pk_mul_f32 v[18:19], v[18:19], v[58:59]
    v_pk_mul_f32 v[20:21], v[20:21], v[60:61]
    v_pk_mul_f32 v[22:23], v[22:23], v[62:63]
    v_cvt_pk_bf16_f32 v16, v16, v17
    v_cvt_pk_bf16_f32 v17, v18, v19
    v_cvt_pk_bf16_f32 v18, v20, v21
    v_cvt_pk_bf16_f32 v19, v22, v23
    v_pk_mul_f32 v[56:57], v[72:73], v[66:67] op_sel:[0,0] op_sel_hi:[1,0]
    v_pk_mul_f32 v[58:59], v[74:75], v[66:67] op_sel:[0,0] op_sel_hi:[1,0]
    v_pk_mul_f32 v[60:61], v[72:73], v[66:67] op_sel:[0,1] op_sel_hi:[1,1]
    v_pk_mul_f32 v[62:63], v[74:75], v[66:67] op_sel:[0,1] op_sel_hi:[1,1]
    v_pk_fma_f32 v[24:25], v[24:25], v[64:65], v[56:57] op_sel:[0,0,0] op_sel_hi:[1,0,1]
    v_pk_fma_f32 v[26:27], v[26:27], v[64:65], v[58:59] op_sel:[0,0,0] op_sel_hi:[1,0,1]
    v_pk_fma_f32 v[28:29], v[28:29], v[64:65], v[60:61] op_sel:[0,1,0] op_sel_hi:[1,1,1]
    v_pk_fma_f32 v[30:31], v[30:31], v[64:65], v[62:63] op_sel:[0,1,0] op_sel_hi:[1,1,1]
    v_pk_mul_f32 v[56:57], v[24:25], v[24:25]
    v_pk_mul_f32 v[58:59], v[26:27], v[26:27]
    v_pk_mul_f32 v[60:61], v[28:29], v[28:29]
    v_pk_mul_f32 v[62:63], v[30:31], v[30:31]
    v_pk_fma_f32 v[56:57], v[56:57], v[114:115], v[112:113]
    v_pk_fma_f32 v[58:59], v[58:59], v[114:115], v[112:113]
    v_pk_fma_f32 v[60:61], v[60:61], v[114:115], v[112:113]
    v_pk_fma_f32 v[62:63], v[62:63], v[114:115], v[112:113]
    v_pk_mul_f32 v[56:57], v[56:57], v[24:25]
    v_pk_mul_f32 v[58:59], v[58:59], v[26:27]
    v_pk_mul_f32 v[60:61], v[60:61], v[28:29]
    v_pk_mul_f32 v[62:63], v[62:63], v[30:31]
    v_exp_f32 v56, v56
    v_exp_f32 v57, v57
    v_exp_f32 v58, v58
    v_exp_f32 v59, v59
    v_exp_f32 v60, v60
    v_exp_f32 v61, v61
    v_exp_f32 v62, v62
    v_exp_f32 v63, v63
    v_pk_add_f32 v[56:57], v[56:57], v[116:117]
    v_pk_add_f32 v[58:59], v[58:59], v[116:117]
    v_pk_add_f32 v[60:61], v[60:61], v[116:117]
    v_pk_add_f32 v[62:63], v[62:63], v[116:117]
    v_rcp_f32 v56, v56
    v_rcp_f32 v57, v57
    v_rcp_f32 v58, v58
    v_rcp_f32 v59, v59
    v_rcp_f32 v60, v60
    v_rcp_f32 v61, v61
    v_rcp_f32 v62, v62
    v_rcp_f32 v63, v63
    v_pk_mul_f32 v[24:25], v[24:25], v[56:57]
    v_pk_mul_f32 v[26:27], v[26:27], v[58:59]
    v_pk_mul_f32 v[28:29], v[28:29], v[60:61]
    v_pk_mul_f32 v[30:31], v[30:31], v[62:63]
    v_cvt_pk_bf16_f32 v24, v24, v25
    v_cvt_pk_bf16_f32 v25, v26, v27
    v_cvt_pk_bf16_f32 v26, v28, v29
    v_cvt_pk_bf16_f32 v27, v30, v31
    v_pk_mul_f32 v[56:57], v[76:77], v[66:67] op_sel:[0,0] op_sel_hi:[1,0]
    v_pk_mul_f32 v[58:59], v[78:79], v[66:67] op_sel:[0,0] op_sel_hi:[1,0]
    v_pk_mul_f32 v[60:61], v[76:77], v[66:67] op_sel:[0,1] op_sel_hi:[1,1]
    v_pk_mul_f32 v[62:63], v[78:79], v[66:67] op_sel:[0,1] op_sel_hi:[1,1]
    v_pk_fma_f32 v[32:33], v[32:33], v[64:65], v[56:57] op_sel:[0,0,0] op_sel_hi:[1,0,1]
    v_pk_fma_f32 v[34:35], v[34:35], v[64:65], v[58:59] op_sel:[0,0,0] op_sel_hi:[1,0,1]
    v_pk_fma_f32 v[36:37], v[36:37], v[64:65], v[60:61] op_sel:[0,1,0] op_sel_hi:[1,1,1]
    v_pk_fma_f32 v[38:39], v[38:39], v[64:65], v[62:63] op_sel:[0,1,0] op_sel_hi:[1,1,1]
    v_pk_mul_f32 v[56:57], v[32:33], v[32:33]
    v_pk_mul_f32 v[58:59], v[34:35], v[34:35]
    v_pk_mul_f32 v[60:61], v[36:37], v[36:37]
    v_pk_mul_f32 v[62:63], v[38:39], v[38:39]
    v_pk_fma_f32 v[56:57], v[56:57], v[114:115], v[112:113]
    v_pk_fma_f32 v[58:59], v[58:59], v[114:115], v[112:113]
    v_pk_fma_f32 v[60:61], v[60:61], v[114:115], v[112:113]
    v_pk_fma_f32 v[62:63], v[62:63], v[114:115], v[112:113]
    v_pk_mul_f32 v[56:57], v[56:57], v[32:33]
    v_pk_mul_f32 v[58:59], v[58:59], v[34:35]
    v_pk_mul_f32 v[60:61], v[60:61], v[36:37]
    v_pk_mul_f32 v[62:63], v[62:63], v[38:39]
    v_exp_f32 v56, v56
    v_exp_f32 v57, v57
    v_exp_f32 v58, v58
    v_exp_f32 v59, v59
    v_exp_f32 v60, v60
    v_exp_f32 v61, v61
    v_exp_f32 v62, v62
    v_exp_f32 v63, v63
    v_pk_add_f32 v[56:57], v[56:57], v[116:117]
    v_pk_add_f32 v[58:59], v[58:59], v[116:117]
    v_pk_add_f32 v[60:61], v[60:61], v[116:117]
    v_pk_add_f32 v[62:63], v[62:63], v[116:117]
    v_rcp_f32 v56, v56
    v_rcp_f32 v57, v57
    v_rcp_f32 v58, v58
    v_rcp_f32 v59, v59
    v_rcp_f32 v60, v60
    v_rcp_f32 v61, v61
    v_rcp_f32 v62, v62
    v_rcp_f32 v63, v63
    v_pk_mul_f32 v[32:33], v[32:33], v[56:57]
    v_pk_mul_f32 v[34:35], v[34:35], v[58:59]
    v_pk_mul_f32 v[36:37], v[36:37], v[60:61]
    v_pk_mul_f32 v[38:39], v[38:39], v[62:63]
    v_cvt_pk_bf16_f32 v32, v32, v33
    v_cvt_pk_bf16_f32 v33, v34, v35
    v_cvt_pk_bf16_f32 v34, v36, v37
    v_cvt_pk_bf16_f32 v35, v38, v39
    v_pk_mul_f32 v[56:57], v[80:81], v[66:67] op_sel:[0,0] op_sel_hi:[1,0]
    v_pk_mul_f32 v[58:59], v[82:83], v[66:67] op_sel:[0,0] op_sel_hi:[1,0]
    v_pk_mul_f32 v[60:61], v[80:81], v[66:67] op_sel:[0,1] op_sel_hi:[1,1]
    v_pk_mul_f32 v[62:63], v[82:83], v[66:67] op_sel:[0,1] op_sel_hi:[1,1]
    v_pk_fma_f32 v[40:41], v[40:41], v[64:65], v[56:57] op_sel:[0,0,0] op_sel_hi:[1,0,1]
    v_pk_fma_f32 v[42:43], v[42:43], v[64:65], v[58:59] op_sel:[0,0,0] op_sel_hi:[1,0,1]
    v_pk_fma_f32 v[44:45], v[44:45], v[64:65], v[60:61] op_sel:[0,1,0] op_sel_hi:[1,1,1]
    v_pk_fma_f32 v[46:47], v[46:47], v[64:65], v[62:63] op_sel:[0,1,0] op_sel_hi:[1,1,1]
    v_pk_mul_f32 v[56:57], v[40:41], v[40:41]
    v_pk_mul_f32 v[58:59], v[42:43], v[42:43]
    v_pk_mul_f32 v[60:61], v[44:45], v[44:45]
    v_pk_mul_f32 v[62:63], v[46:47], v[46:47]
    v_pk_fma_f32 v[56:57], v[56:57], v[114:115], v[112:113]
    v_pk_fma_f32 v[58:59], v[58:59], v[114:115], v[112:113]
    v_pk_fma_f32 v[60:61], v[60:61], v[114:115], v[112:113]
    v_pk_fma_f32 v[62:63], v[62:63], v[114:115], v[112:113]
    v_pk_mul_f32 v[56:57], v[56:57], v[40:41]
    v_pk_mul_f32 v[58:59], v[58:59], v[42:43]
    v_pk_mul_f32 v[60:61], v[60:61], v[44:45]
    v_pk_mul_f32 v[62:63], v[62:63], v[46:47]
    v_exp_f32 v56, v56
    v_exp_f32 v57, v57
    v_exp_f32 v58, v58
    v_exp_f32 v59, v59
    v_exp_f32 v60, v60
    v_exp_f32 v61, v61
    v_exp_f32 v62, v62
    v_exp_f32 v63, v63
    v_pk_add_f32 v[56:57], v[56:57], v[116:117]
    v_pk_add_f32 v[58:59], v[58:59], v[116:117]
    v_pk_add_f32 v[60:61], v[60:61], v[116:117]
    v_pk_add_f32 v[62:63], v[62:63], v[116:117]
    v_rcp_f32 v56, v56
    v_rcp_f32 v57, v57
    v_rcp_f32 v58, v58
    v_rcp_f32 v59, v59
    v_rcp_f32 v60, v60
    v_rcp_f32 v61, v61
    v_rcp_f32 v62, v62
    v_rcp_f32 v63, v63
    v_pk_mul_f32 v[40:41], v[40:41], v[56:57]
    v_pk_mul_f32 v[42:43], v[42:43], v[58:59]
    v_pk_mul_f32 v[44:45], v[44:45], v[60:61]
    v_pk_mul_f32 v[46:47], v[46:47], v[62:63]
    v_cvt_pk_bf16_f32 v40, v40, v41
    v_cvt_pk_bf16_f32 v41, v42, v43
    v_cvt_pk_bf16_f32 v42, v44, v45
    v_cvt_pk_bf16_f32 v43, v46, v47
    v_pk_mul_f32 v[56:57], v[84:85], v[66:67] op_sel:[0,0] op_sel_hi:[1,0]
    v_pk_mul_f32 v[58:59], v[86:87], v[66:67] op_sel:[0,0] op_sel_hi:[1,0]
    v_pk_mul_f32 v[60:61], v[84:85], v[66:67] op_sel:[0,1] op_sel_hi:[1,1]
    v_pk_mul_f32 v[62:63], v[86:87], v[66:67] op_sel:[0,1] op_sel_hi:[1,1]
    v_pk_fma_f32 v[48:49], v[48:49], v[64:65], v[56:57] op_sel:[0,0,0] op_sel_hi:[1,0,1]
    v_pk_fma_f32 v[50:51], v[50:51], v[64:65], v[58:59] op_sel:[0,0,0] op_sel_hi:[1,0,1]
    v_pk_fma_f32 v[52:53], v[52:53], v[64:65], v[60:61] op_sel:[0,1,0] op_sel_hi:[1,1,1]
    v_pk_fma_f32 v[54:55], v[54:55], v[64:65], v[62:63] op_sel:[0,1,0] op_sel_hi:[1,1,1]
    v_pk_mul_f32 v[56:57], v[48:49], v[48:49]
    v_pk_mul_f32 v[58:59], v[50:51], v[50:51]
    v_pk_mul_f32 v[60:61], v[52:53], v[52:53]
    v_pk_mul_f32 v[62:63], v[54:55], v[54:55]
    v_pk_fma_f32 v[56:57], v[56:57], v[114:115], v[112:113]
    v_pk_fma_f32 v[58:59], v[58:59], v[114:115], v[112:113]
    v_pk_fma_f32 v[60:61], v[60:61], v[114:115], v[112:113]
    v_pk_fma_f32 v[62:63], v[62:63], v[114:115], v[112:113]
    v_pk_mul_f32 v[56:57], v[56:57], v[48:49]
    v_pk_mul_f32 v[58:59], v[58:59], v[50:51]
    v_pk_mul_f32 v[60:61], v[60:61], v[52:53]
    v_pk_mul_f32 v[62:63], v[62:63], v[54:55]
    v_exp_f32 v56, v56
    v_exp_f32 v57, v57
    v_exp_f32 v58, v58
    v_exp_f32 v59, v59
    v_exp_f32 v60, v60
    v_exp_f32 v61, v61
    v_exp_f32 v62, v62
    v_exp_f32 v63, v63
    v_pk_add_f32 v[56:57], v[56:57], v[116:117]
    v_pk_add_f32 v[58:59], v[58:59], v[116:117]
    v_pk_add_f32 v[60:61], v[60:61], v[116:117]
    v_pk_add_f32 v[62:63], v[62:63], v[116:117]
    v_rcp_f32 v56, v56
    v_rcp_f32 v57, v57
    v_rcp_f32 v58, v58
    v_rcp_f32 v59, v59
    v_rcp_f32 v60, v60
    v_rcp_f32 v61, v61
    v_rcp_f32 v62, v62
    v_rcp_f32 v63, v63
    v_pk_mul_f32 v[48:49], v[48:49], v[56:57]
    v_pk_mul_f32 v[50:51], v[50:51], v[58:59]
    v_pk_mul_f32 v[52:53], v[52:53], v[60:61]
    v_pk_mul_f32 v[54:55], v[54:55], v[62:63]
    v_cvt_pk_bf16_f32 v48, v48, v49
    v_cvt_pk_bf16_f32 v49, v50, v51
    v_cvt_pk_bf16_f32 v50, v52, v53
    v_cvt_pk_bf16_f32 v51, v54, v55
    buffer_store_dwordx4 v[16:19], v118, s[24:27], s47 offen offset:0 sc1
    buffer_store_dwordx4 v[24:27], v118, s[24:27], s47 offen offset:1024 sc1
    buffer_store_dwordx4 v[32:35], v118, s[24:27], s47 offen offset:2048 sc1
    buffer_store_dwordx4 v[40:43], v118, s[24:27], s47 offen offset:3072 sc1
    s_add_u32 s47, s47, 4096
    buffer_store_dwordx4 v[48:51], v118, s[24:27], s47 offen sc1
    s_branch K1_end
K1c_z1_1:
    s_mov_b32 s41, 0
    s_mov_b32 s43, 0
    s_barrier
K1c_z1_1L_loop:
    s_setprio 1
    ds_read_b128 v[56:59], v112 offset:0
    ds_read_b128 v[60:63], v112 offset:2048
    ds_read_b64_tr_b16 v[64:65], v116 offset:16384
    ds_read_b64_tr_b16 v[66:67], v116 offset:20992
    ds_read_b64_tr_b16 v[68:69], v116 offset:16416
    ds_read_b64_tr_b16 v[70:71], v116 offset:21024
    ds_read_b64_tr_b16 v[72:73], v116 offset:16448
    ds_read_b64_tr_b16 v[74:75], v116 offset:21056
    ds_read_b64_tr_b16 v[76:77], v116 offset:16480
    ds_read_b64_tr_b16 v[78:79], v116 offset:21088
    ds_read_b128 v[84:87], v113 offset:0
    ds_read_b128 v[88:91], v113 offset:2048
    ds_read_b64_tr_b16 v[92:93], v116 offset:25600
    ds_read_b64_tr_b16 v[94:95], v116 offset:30208
    ds_read_b64_tr_b16 v[96:97], v116 offset:25632
    ds_read_b64_tr_b16 v[98:99], v116 offset:30240
    ds_read_b64_tr_b16 v[100:101], v116 offset:25664
    ds_read_b64_tr_b16 v[102:103], v116 offset:30272
    ds_read_b64_tr_b16 v[104:105], v116 offset:25696
    ds_read_b64_tr_b16 v[106:107], v116 offset:30304
    s_setprio 0
    s_mov_b32 s48, s43
    s_add_u32 s43, s43, 34816
    s_cmp_eq_u32 s43, 139264
    s_cselect_b32 s43, 0, s43
    s_sub_u32 s48, s43, s48
    s_add_u32 s41, s41, 1
    v_add_u32 v112, s48, v112
    v_add_u32 v113, s48, v113
    v_add_u32 v116, s48, v116
    s_cmp_eq_u32 s41, 2
    s_cbranch_scc0 K1c_z1_1L_nh0
    s_waitcnt vmcnt(0)
K1c_z1_1L_nh0:
    s_waitcnt lgkmcnt(10)
    v_mfma_f32_16x16x32_bf16 v[16:19], v[64:67], v[56:59], v[16:19]
    v_mfma_f32_16x16x32_bf16 v[20:23], v[64:67], v[60:63], v[20:23]
    v_mfma_f32_16x16x32_bf16 v[24:27], v[68:71], v[56:59], v[24:27]
    v_mfma_f32_16x16x32_bf16 v[28:31], v[68:71], v[60:63], v[28:31]
    v_mfma_f32_16x16x32_bf16 v[32:35], v[72:75], v[56:59], v[32:35]
    v_mfma_f32_16x16x32_bf16 v[36:39], v[72:75], v[60:63], v[36:39]
    v_mfma_f32_16x16x32_bf16 v[40:43], v[76:79], v[56:59], v[40:43]
    v_mfma_f32_16x16x32_bf16 v[44:47], v[76:79], v[60:63], v[44:47]
    s_waitcnt lgkmcnt(0)
    v_mfma_f32_16x16x32_bf16 v[16:19], v[92:95], v[84:87], v[16:19]
    v_mfma_f32_16x16x32_bf16 v[20:23], v[92:95], v[88:91], v[20:23]
    v_mfma_f32_16x16x32_bf16 v[24:27], v[96:99], v[84:87], v[24:27]
    v_mfma_f32_16x16x32_bf16 v[28:31], v[96:99], v[88:91], v[28:31]
    v_mfma_f32_16x16x32_bf16 v[32:35], v[100:103], v[84:87], v[32:35]
    v_mfma_f32_16x16x32_bf16 v[36:39], v[100:103], v[88:91], v[36:39]
    v_mfma_f32_16x16x32_bf16 v[40:43], v[104:107], v[84:87], v[40:43]
    v_mfma_f32_16x16x32_bf16 v[44:47], v[104:107], v[88:91], v[44:47]
    s_cmp_lt_u32 s41, 10
    s_cbranch_scc0 K1c_z1_1L_done
    s_barrier
    s_branch K1c_z1_1L_loop
K1c_z1_1L_done:
    s_barrier
    v_mov_b32 v112, 0xc0135761
    v_mov_b32 v113, 0xc0135761
    v_mov_b32 v114, 0xbdd2d3e8
    v_mov_b32 v115, 0xbdd2d3e8
    v_mov_b32 v116, 1.0
    v_mov_b32 v117, 1.0
    s_lshl_b32 s48, s39, 7
    v_lshlrev_b32 v3, 2, v1
    v_add_u32 v3, s48, v3
    v_add_u32 v3, 147456, v3
    ds_read_b32 v64, v3 offset:0
    ds_read_b32 v66, v3 offset:512
    ds_read_b32 v65, v3 offset:64
    ds_read_b32 v67, v3 offset:576
    v_lshlrev_b32 v4, 4, v2
    v_add_u32 v4, 148800, v4
    ds_read_b128 v[68:71], v4 offset:0
    ds_read_b128 v[88:91], v4 offset:640
    ds_read_b128 v[72:75], v4 offset:64
    ds_read_b128 v[92:95], v4 offset:704
    ds_read_b128 v[76:79], v4 offset:128
    ds_read_b128 v[96:99], v4 offset:768
    ds_read_b128 v[80:83], v4 offset:192
    ds_read_b128 v[100:103], v4 offset:832
    s_mul_i32 s48, s37, 6
    s_add_u32 s48, s48, s38
    s_lshl_b32 s48, s48, 3
    s_add_u32 s48, s48, s32
    s_mul_i32 s47, s48, 5120
    s_add_u32 s50, s6, 0x380000
    s_addc_u32 s51, s7, 0
    s_mov_b32 s24, s50
    s_mov_b32 s25, s51
    s_mov_b32 s26, 0x3c0000
    s_mov_b32 s27, 0x00020000
    v_lshlrev_b32 v118, 4, v0
    s_waitcnt lgkmcnt(0)
    v_pk_add_f32 v[68:69], v[68:69], v[88:89]
    v_pk_add_f32 v[70:71], v[70:71], v[90:91]
    v_pk_add_f32 v[72:73], v[72:73], v[92:93]
    v_pk_add_f32 v[74:75], v[74:75], v[94:95]
    v_pk_add_f32 v[76:77], v[76:77], v[96:97]
    v_pk_add_f32 v[78:79], v[78:79], v[98:99]
    v_pk_add_f32 v[80:81], v[80:81], v[100:101]
    v_pk_add_f32 v[82:83], v[82:83], v[102:103]
    v_pk_mul_f32 v[56:57], v[68:69], v[66:67] op_sel:[0,0] op_sel_hi:[1,0]
    v_pk_mul_f32 v[58:59], v[70:71], v[66:67] op_sel:[0,0] op_sel_hi:[1,0]
    v_pk_mul_f32 v[60:61], v[68:69], v[66:67] op_sel:[0,1] op_sel_hi:[1,1]
    v_pk_mul_f32 v[62:63], v[70:71], v[66:67] op_sel:[0,1] op_sel_hi:[1,1]
    v_pk_fma_f32 v[16:17], v[16:17], v[64:65], v[56:57] op_sel:[0,0,0] op_sel_hi:[1,0,1]
    v_pk_fma_f32 v[18:19], v[18:19], v[64:65], v[58:59] op_sel:[0,0,0] op_sel_hi:[1,0,1]
    v_pk_fma_f32 v[20:21], v[20:21], v[64:65], v[60:61] op_sel:[0,1,0] op_sel_hi:[1,1,1]
    v_pk_fma_f32 v[22:23], v[22:23], v[64:65], v[62:63] op_sel:[0,1,0] op_sel_hi:[1,1,1]
    v_pk_mul_f32 v[56:57], v[16:17], v[16:17]
    v_pk_mul_f32 v[58:59], v[18:19], v[18:19]
    v_pk_mul_f32 v[60:61], v[20:21], v[20:21]
    v_pk_mul_f32 v[62:63], v[22:23], v[22:23]
    v_pk_fma_f32 v[56:57], v[56:57], v[114:115], v[112:113]
    v_pk_fma_f32 v[58:59], v[58:59], v[114:115], v[112:113]
    v_pk_fma_f32 v[60:61], v[60:61], v[114:115], v[112:113]
    v_pk_fma_f32 v[62:63], v[62:63], v[114:115], v[112:113]
    v_pk_mul_f32 v[56:57], v[56:57], v[16:17]
    v_pk_mul_f32 v[58:59], v[58:59], v[18:19]
    v_pk_mul_f32 v[60:61], v[60:61], v[20:21]
    v_pk_mul_f32 v[62:63], v[62:63], v[22:23]
    v_exp_f32 v56, v56
    v_exp_f32 v57, v57
    v_exp_f32 v58, v58
    v_exp_f32 v59, v59
    v_exp_f32 v60, v60
    v_exp_f32 v61, v61
    v_exp_f32 v62, v62
    v_exp_f32 v63, v63
    v_pk_add_f32 v[56:57], v[56:57], v[116:117]
    v_pk_add_f32 v[58:59], v[58:59], v[116:117]
    v_pk_add_f32 v[60:61], v[60:61], v[116:117]
    v_pk_add_f32 v[62:63], v[62:63], v[116:117]
    v_rcp_f32 v56, v56
    v_rcp_f32 v57, v57
    v_rcp_f32 v58, v58
    v_rcp_f32 v59, v59
    v_rcp_f32 v60, v60
    v_rcp_f32 v61, v61
    v_rcp_f32 v62, v62
    v_rcp_f32 v63, v63
    v_pk_mul_f32 v[16:17], v[16:17], v[56:57]
    v_pk_mul_f32 v[18:19], v[18:19], v[58:59]
    v_pk_mul_f32 v[20:21], v[20:21], v[60:61]
    v_pk_mul_f32 v[22:23], v[22:23], v[62:63]
    v_cvt_pk_bf16_f32 v16, v16, v17
    v_cvt_pk_bf16_f32 v17, v18, v19
    v_cvt_pk_bf16_f32 v18, v20, v21
    v_cvt_pk_bf16_f32 v19, v22, v23
    v_pk_mul_f32 v[56:57], v[72:73], v[66:67] op_sel:[0,0] op_sel_hi:[1,0]
    v_pk_mul_f32 v[58:59], v[74:75], v[66:67] op_sel:[0,0] op_sel_hi:[1,0]
    v_pk_mul_f32 v[60:61], v[72:73], v[66:67] op_sel:[0,1] op_sel_hi:[1,1]
    v_pk_mul_f32 v[62:63], v[74:75], v[66:67] op_sel:[0,1] op_sel_hi:[1,1]
    v_pk_fma_f32 v[24:25], v[24:25], v[64:65], v[56:57] op_sel:[0,0,0] op_sel_hi:[1,0,1]
    v_pk_fma_f32 v[26:27], v[26:27], v[64:65], v[58:59] op_sel:[0,0,0] op_sel_hi:[1,0,1]
    v_pk_fma_f32 v[28:29], v[28:29], v[64:65], v[60:61] op_sel:[0,1,0] op_sel_hi:[1,1,1]
    v_pk_fma_f32 v[30:31], v[30:31], v[64:65], v[62:63] op_sel:[0,1,0] op_sel_hi:[1,1,1]
    v_pk_mul_f32 v[56:57], v[24:25], v[24:25]
    v_pk_mul_f32 v[58:59], v[26:27], v[26:27]
    v_pk_mul_f32 v[60:61], v[28:29], v[28:29]
    v_pk_mul_f32 v[62:63], v[30:31], v[30:31]
    v_pk_fma_f32 v[56:57], v[56:57], v[114:115], v[112:113]
    v_pk_fma_f32 v[58:59], v[58:59], v[114:115], v[112:113]
    v_pk_fma_f32 v[60:61], v[60:61], v[114:115], v[112:113]
    v_pk_fma_f32 v[62:63], v[62:63], v[114:115], v[112:113]
    v_pk_mul_f32 v[56:57], v[56:57], v[24:25]
    v_pk_mul_f32 v[58:59], v[58:59], v[26:27]
    v_pk_mul_f32 v[60:61], v[60:61], v[28:29]
    v_pk_mul_f32 v[62:63], v[62:63], v[30:31]
    v_exp_f32 v56, v56
    v_exp_f32 v57, v57
    v_exp_f32 v58, v58
    v_exp_f32 v59, v59
    v_exp_f32 v60, v60
    v_exp_f32 v61, v61
    v_exp_f32 v62, v62
    v_exp_f32 v63, v63
    v_pk_add_f32 v[56:57], v[56:57], v[116:117]
    v_pk_add_f32 v[58:59], v[58:59], v[116:117]
    v_pk_add_f32 v[60:61], v[60:61], v[116:117]
    v_pk_add_f32 v[62:63], v[62:63], v[116:117]
    v_rcp_f32 v56, v56
    v_rcp_f32 v57, v57
    v_rcp_f32 v58, v58
    v_rcp_f32 v59, v59
    v_rcp_f32 v60, v60
    v_rcp_f32 v61, v61
    v_rcp_f32 v62, v62
    v_rcp_f32 v63, v63
    v_pk_mul_f32 v[24:25], v[24:25], v[56:57]
    v_pk_mul_f32 v[26:27], v[26:27], v[58:59]
    v_pk_mul_f32 v[28:29], v[28:29], v[60:61]
    v_pk_mul_f32 v[30:31], v[30:31], v[62:63]
    v_cvt_pk_bf16_f32 v24, v24, v25
    v_cvt_pk_bf16_f32 v25, v26, v27
    v_cvt_pk_bf16_f32 v26, v28, v29
    v_cvt_pk_bf16_f32 v27, v30, v31
    v_pk_mul_f32 v[56:57], v[76:77], v[66:67] op_sel:[0,0] op_sel_hi:[1,0]
    v_pk_mul_f32 v[58:59], v[78:79], v[66:67] op_sel:[0,0] op_sel_hi:[1,0]
    v_pk_mul_f32 v[60:61], v[76:77], v[66:67] op_sel:[0,1] op_sel_hi:[1,1]
    v_pk_mul_f32 v[62:63], v[78:79], v[66:67] op_sel:[0,1] op_sel_hi:[1,1]
    v_pk_fma_f32 v[32:33], v[32:33], v[64:65], v[56:57] op_sel:[0,0,0] op_sel_hi:[1,0,1]
    v_pk_fma_f32 v[34:35], v[34:35], v[64:65], v[58:59] op_sel:[0,0,0] op_sel_hi:[1,0,1]
    v_pk_fma_f32 v[36:37], v[36:37], v[64:65], v[60:61] op_sel:[0,1,0] op_sel_hi:[1,1,1]
    v_pk_fma_f32 v[38:39], v[38:39], v[64:65], v[62:63] op_sel:[0,1,0] op_sel_hi:[1,1,1]
    v_pk_mul_f32 v[56:57], v[32:33], v[32:33]
    v_pk_mul_f32 v[58:59], v[34:35], v[34:35]
    v_pk_mul_f32 v[60:61], v[36:37], v[36:37]
    v_pk_mul_f32 v[62:63], v[38:39], v[38:39]
    v_pk_fma_f32 v[56:57], v[56:57], v[114:115], v[112:113]
    v_pk_fma_f32 v[58:59], v[58:59], v[114:115], v[112:113]
    v_pk_fma_f32 v[60:61], v[60:61], v[114:115], v[112:113]
    v_pk_fma_f32 v[62:63], v[62:63], v[114:115], v[112:113]
    v_pk_mul_f32 v[56:57], v[56:57], v[32:33]
    v_pk_mul_f32 v[58:59], v[58:59], v[34:35]
    v_pk_mul_f32 v[60:61], v[60:61], v[36:37]
    v_pk_mul_f32 v[62:63], v[62:63], v[38:39]
    v_exp_f32 v56, v56
    v_exp_f32 v57, v57
    v_exp_f32 v58, v58
    v_exp_f32 v59, v59
    v_exp_f32 v60, v60
    v_exp_f32 v61, v61
    v_exp_f32 v62, v62
    v_exp_f32 v63, v63
    v_pk_add_f32 v[56:57], v[56:57], v[116:117]
    v_pk_add_f32 v[58:59], v[58:59], v[116:117]
    v_pk_add_f32 v[60:61], v[60:61], v[116:117]
    v_pk_add_f32 v[62:63], v[62:63], v[116:117]
    v_rcp_f32 v56, v56
    v_rcp_f32 v57, v57
    v_rcp_f32 v58, v58
    v_rcp_f32 v59, v59
    v_rcp_f32 v60, v60
    v_rcp_f32 v61, v61
    v_rcp_f32 v62, v62
    v_rcp_f32 v63, v63
    v_pk_mul_f32 v[32:33], v[32:33], v[56:57]
    v_pk_mul_f32 v[34:35], v[34:35], v[58:59]
    v_pk_mul_f32 v[36:37], v[36:37], v[60:61]
    v_pk_mul_f32 v[38:39], v[38:39], v[62:63]
    v_cvt_pk_bf16_f32 v32, v32, v33
    v_cvt_pk_bf16_f32 v33, v34, v35
    v_cvt_pk_bf16_f32 v34, v36, v37
    v_cvt_pk_bf16_f32 v35, v38, v39
    v_pk_mul_f32 v[56:57], v[80:81], v[66:67] op_sel:[0,0] op_sel_hi:[1,0]
    v_pk_mul_f32 v[58:59], v[82:83], v[66:67] op_sel:[0,0] op_sel_hi:[1,0]
    v_pk_mul_f32 v[60:61], v[80:81], v[66:67] op_sel:[0,1] op_sel_hi:[1,1]
    v_pk_mul_f32 v[62:63], v[82:83], v[66:67] op_sel:[0,1] op_sel_hi:[1,1]
    v_pk_fma_f32 v[40:41], v[40:41], v[64:65], v[56:57] op_sel:[0,0,0] op_sel_hi:[1,0,1]
    v_pk_fma_f32 v[42:43], v[42:43], v[64:65], v[58:59] op_sel:[0,0,0] op_sel_hi:[1,0,1]
    v_pk_fma_f32 v[44:45], v[44:45], v[64:65], v[60:61] op_sel:[0,1,0] op_sel_hi:[1,1,1]
    v_pk_fma_f32 v[46:47], v[46:47], v[64:65], v[62:63] op_sel:[0,1,0] op_sel_hi:[1,1,1]
    v_pk_mul_f32 v[56:57], v[40:41], v[40:41]
    v_pk_mul_f32 v[58:59], v[42:43], v[42:43]
    v_pk_mul_f32 v[60:61], v[44:45], v[44:45]
    v_pk_mul_f32 v[62:63], v[46:47], v[46:47]
    v_pk_fma_f32 v[56:57], v[56:57], v[114:115], v[112:113]
    v_pk_fma_f32 v[58:59], v[58:59], v[114:115], v[112:113]
    v_pk_fma_f32 v[60:61], v[60:61], v[114:115], v[112:113]
    v_pk_fma_f32 v[62:63], v[62:63], v[114:115], v[112:113]
    v_pk_mul_f32 v[56:57], v[56:57], v[40:41]
    v_pk_mul_f32 v[58:59], v[58:59], v[42:43]
    v_pk_mul_f32 v[60:61], v[60:61], v[44:45]
    v_pk_mul_f32 v[62:63], v[62:63], v[46:47]
    v_exp_f32 v56, v56
    v_exp_f32 v57, v57
    v_exp_f32 v58, v58
    v_exp_f32 v59, v59
    v_exp_f32 v60, v60
    v_exp_f32 v61, v61
    v_exp_f32 v62, v62
    v_exp_f32 v63, v63
    v_pk_add_f32 v[56:57], v[56:57], v[116:117]
    v_pk_add_f32 v[58:59], v[58:59], v[116:117]
    v_pk_add_f32 v[60:61], v[60:61], v[116:117]
    v_pk_add_f32 v[62:63], v[62:63], v[116:117]
    v_rcp_f32 v56, v56
    v_rcp_f32 v57, v57
    v_rcp_f32 v58, v58
    v_rcp_f32 v59, v59
    v_rcp_f32 v60, v60
    v_rcp_f32 v61, v61
    v_rcp_f32 v62, v62
    v_rcp_f32 v63, v63
    v_pk_mul_f32 v[40:41], v[40:41], v[56:57]
    v_pk_mul_f32 v[42:43], v[42:43], v[58:59]
    v_pk_mul_f32 v[44:45], v[44:45], v[60:61]
    v_pk_mul_f32 v[46:47], v[46:47], v[62:63]
    v_cvt_pk_bf16_f32 v40, v40, v41
    v_cvt_pk_bf16_f32 v41, v42, v43
    v_cvt_pk_bf16_f32 v42, v44, v45
    v_cvt_pk_bf16_f32 v43, v46, v47
    buffer_store_dwordx4 v[16:19], v118, s[24:27], s47 offen offset:0 sc1
    buffer_store_dwordx4 v[24:27], v118, s[24:27], s47 offen offset:1024 sc1
    buffer_store_dwordx4 v[32:35], v118, s[24:27], s47 offen offset:2048 sc1
    buffer_store_dwordx4 v[40:43], v118, s[24:27], s47 offen offset:3072 sc1
    s_branch K1_end
K1Z_prod:
    s_sub_u32 s39, s32, 8
    v_lshrrev_b32 v20, 3, v0
    s_lshl_b32 s48, s39, 5
    v_add_u32 v21, s48, v20
    v_mul_u32_u24 v21, 1280, v21
    v_and_b32 v22, 7, v0
    v_xor_b32 v22, v22, v20
    v_lshl_add_u32 v2, v22, 4, v21
    v_mov_b32 v3, v2
    s_mul_i32 s48, s38, 288
    s_cmp_eq_u32 s53, 0
    s_cselect_b32 s49, 1728, 0
    s_cselect_b32 s50, 0, 1728
    s_add_u32 s49, s49, s48
    s_add_u32 s50, s50, s48
    v_mov_b32 v24, s49
    v_mov_b32 v25, s50
    s_lshl_b32 s48, s39, 6
    s_add_u32 s48, s48, 0
    v_add_u32 v20, s48, v0
    v_mul_u32_u24 v21, 3641, v20
    v_lshrrev_b32 v21, 16, v21
    v_mul_u32_u24 v22, 18, v21
    v_sub_u32 v22, v20, v22
    v_cmp_gt_u32 vcc, 10, v22
    v_and_b32 v26, 0x23, v21
    v_bfe_u32 v27, v21, 2, 2
    v_lshl_or_b32 v26, v27, 3, v26
    v_bfe_u32 v27, v21, 4, 1
    v_lshl_or_b32 v21, v27, 2, v26
    v_mul_u32_u24 v21, 3456, v21
    v_lshl_add_u32 v21, v22, 4, v21
    v_cndmask_b32 v23, v25, v24, vcc
    v_add_u32 v4, v21, v23
    s_lshl_b32 s48, s39, 6
    s_add_u32 s48, s48, 256
    v_add_u32 v20, s48, v0
    v_mul_u32_u24 v21, 3641, v20
    v_lshrrev_b32 v21, 16, v21
    v_mul_u32_u24 v22, 18, v21
    v_sub_u32 v22, v20, v22
    v_cmp_gt_u32 vcc, 10, v22
    v_and_b32 v26, 0x23, v21
    v_bfe_u32 v27, v21, 2, 2
    v_lshl_or_b32 v26, v27, 3, v26
    v_bfe_u32 v27, v21, 4, 1
    v_lshl_or_b32 v21, v27, 2, v26
    v_mul_u32_u24 v21, 3456, v21
    v_lshl_add_u32 v21, v22, 4, v21
    v_cndmask_b32 v23, v25, v24, vcc
    v_add_u32 v5, v21, v23
    s_lshl_b32 s48, s39, 6
    s_add_u32 s48, s48, 512
    v_add_u32 v20, s48, v0
    v_mul_u32_u24 v21, 3641, v20
    v_lshrrev_b32 v21, 16, v21
    v_mul_u32_u24 v22, 18, v21
    v_sub_u32 v22, v20, v22
    v_cmp_gt_u32 vcc, 10, v22
    v_and_b32 v26, 0x23, v21
    v_bfe_u32 v27, v21, 2, 2
    v_lshl_or_b32 v26, v27, 3, v26
    v_bfe_u32 v27, v21, 4, 1
    v_lshl_or_b32 v21, v27, 2, v26
    v_mul_u32_u24 v21, 3456, v21
    v_lshl_add_u32 v21, v22, 4, v21
    v_cndmask_b32 v23, v25, v24, vcc
    v_add_u32 v6, v21, v23
    s_lshl_b32 s48, s39, 6
    s_add_u32 s48, s48, 768
    v_add_u32 v20, s48, v0
    v_mul_u32_u24 v21, 3641, v20
    v_lshrrev_b32 v21, 16, v21
    v_mul_u32_u24 v22, 18, v21
    v_sub_u32 v22, v20, v22
    v_cmp_gt_u32 vcc, 10, v22
    v_and_b32 v26, 0x23, v21
    v_bfe_u32 v27, v21, 2, 2
    v_lshl_or_b32 v26, v27, 3, v26
    v_bfe_u32 v27, v21, 4, 1
    v_lshl_or_b32 v21, v27, 2, v26
    v_mul_u32_u24 v21, 3456, v21
    v_lshl_add_u32 v21, v22, 4, v21
    v_cndmask_b32 v23, v25, v24, vcc
    v_add_u32 v7, v21, v23
    s_lshl_b32 s48, s39, 6
    s_add_u32 s48, s48, 1024
    v_add_u32 v20, s48, v0
    v_mul_u32_u24 v21, 3641, v20
    v_lshrrev_b32 v21, 16, v21
    v_mul_u32_u24 v22, 18, v21
    v_sub_u32 v22, v20, v22
    v_cmp_gt_u32 vcc, 10, v22
    v_and_b32 v26, 0x23, v21
    v_bfe_u32 v27, v21, 2, 2
    v_lshl_or_b32 v26, v27, 3, v26
    v_bfe_u32 v27, v21, 4, 1
    v_lshl_or_b32 v21, v27, 2, v26
    v_mul_u32_u24 v21, 3456, v21
    v_lshl_add_u32 v21, v22, 4, v21
    v_cndmask_b32 v23, v25, v24, vcc
    v_add_u32 v8, v21, v23
    s_mov_b32 s42, 0
    s_mul_i32 s48, s35, 5
    s_lshr_b32 s48, s48, 1
    s_mul_i32 s49, s36, 4
    s_add_u32 s48, s48, s49
    s_cmp_ge_u32 s48, 10
    s_cselect_b32 s49, 10, 0
    s_sub_u32 s48, s48, s49
    s_lshl_b32 s44, s48, 7
    s_mul_i32 s45, s48, 221184
    s_waitcnt lgkmcnt(0)
    s_mul_i32 s48, s37, 163840
    s_add_u32 s4, s4, s48
    s_addc_u32 s5, s5, 0
    s_mov_b32 s16, s4
    s_mov_b32 s17, s5
    s_mov_b32 s18, 0x28000
    s_mov_b32 s19, 0x00020000
    s_mov_b32 s20, s12
    s_mov_b32 s21, s13
    s_mov_b32 s22, 0x21c000
    s_mov_b32 s23, 0x00020000
    s_lshl_b32 s46, s39, 12
    s_add_u32 s46, s46, s42
    s_add_u32 m0, s46, 0
    s_add_u32 s47, s44, 0
    buffer_load_dwordx4 v2, s[16:19], s47 offen lds
    s_add_u32 m0, s46, 1024
    s_add_u32 s47, s44, 10240
    buffer_load_dwordx4 v3, s[16:19], s47 offen lds
    s_add_u32 m0, s46, 2048
    s_add_u32 s47, s44, 20480
    buffer_load_dwordx4 v2, s[16:19], s47 offen lds
    s_add_u32 m0, s46, 3072
    s_add_u32 s47, s44, 30720
    buffer_load_dwordx4 v3, s[16:19], s47 offen lds
    s_lshl_b32 s46, s39, 10
    s_add_u32 s46, s46, s42
    s_add_u32 m0, s46, 16384
    s_nop 0
    buffer_load_dwordx4 v4, s[20:23], s45 offen lds
    s_add_u32 m0, s46, 20480
    s_nop 0
    buffer_load_dwordx4 v5, s[20:23], s45 offen lds
    s_add_u32 m0, s46, 24576
    s_nop 0
    buffer_load_dwordx4 v6, s[20:23], s45 offen lds
    s_add_u32 m0, s46, 28672
    s_nop 0
    buffer_load_dwordx4 v7, s[20:23], s45 offen lds
    s_cmp_lt_u32 s39, 2
    s_cbranch_scc0 K1Zp_s_1
    s_add_u32 m0, s46, 32768
    s_nop 0
    buffer_load_dwordx4 v8, s[20:23], s45 offen lds
K1Zp_s_1:
    s_add_u32 s42, s42, 34816
    s_cmp_eq_u32 s42, 139264
    s_cselect_b32 s42, 0, s42
    s_add_u32 s44, s44, 128
    s_add_u32 s45, s45, 221184
    s_cmp_eq_u32 s44, 1280
    s_cselect_b32 s44, 0, s44
    s_cselect_b32 s45, 0, s45
    s_lshl_b32 s46, s39, 12
    s_add_u32 s46, s46, s42
    s_add_u32 m0, s46, 0
    s_add_u32 s47, s44, 0
    buffer_load_dwordx4 v2, s[16:19], s47 offen lds
    s_add_u32 m0, s46, 1024
    s_add_u32 s47, s44, 10240
    buffer_load_dwordx4 v3, s[16:19], s47 offen lds
    s_add_u32 m0, s46, 2048
    s_add_u32 s47, s44, 20480
    buffer_load_dwordx4 v2, s[16:19], s47 offen lds
    s_add_u32 m0, s46, 3072
    s_add_u32 s47, s44, 30720
    buffer_load_dwordx4 v3, s[16:19], s47 offen lds
    s_lshl_b32 s46, s39, 10
    s_add_u32 s46, s46, s42
    s_add_u32 m0, s46, 16384
    s_nop 0
    buffer_load_dwordx4 v4, s[20:23], s45 offen lds
    s_add_u32 m0, s46, 20480
    s_nop 0
    buffer_load_dwordx4 v5, s[20:23], s45 offen lds
    s_add_u32 m0, s46, 24576
    s_nop 0
    buffer_load_dwordx4 v6, s[20:23], s45 offen lds
    s_add_u32 m0, s46, 28672
    s_nop 0
    buffer_load_dwordx4 v7, s[20:23], s45 offen lds
    s_cmp_lt_u32 s39, 2
    s_cbranch_scc0 K1Zp_s_2
    s_add_u32 m0, s46, 32768
    s_nop 0
    buffer_load_dwordx4 v8, s[20:23], s45 offen lds
K1Zp_s_2:
    s_add_u32 s42, s42, 34816
    s_cmp_eq_u32 s42, 139264
    s_cselect_b32 s42, 0, s42
    s_add_u32 s44, s44, 128
    s_add_u32 s45, s45, 221184
    s_cmp_eq_u32 s44, 1280
    s_cselect_b32 s44, 0, s44
    s_cselect_b32 s45, 0, s45
    s_waitcnt vmcnt(8)
    s_barrier
    s_lshl_b32 s46, s39, 12
    s_add_u32 s46, s46, s42
    s_add_u32 m0, s46, 0
    s_add_u32 s47, s44, 0
    buffer_load_dwordx4 v2, s[16:19], s47 offen lds
    s_add_u32 m0, s46, 1024
    s_add_u32 s47, s44, 10240
    buffer_load_dwordx4 v3, s[16:19], s47 offen lds
    s_add_u32 m0, s46, 2048
    s_add_u32 s47, s44, 20480
    buffer_load_dwordx4 v2, s[16:19], s47 offen lds
    s_add_u32 m0, s46, 3072
    s_add_u32 s47, s44, 30720
    buffer_load_dwordx4 v3, s[16:19], s47 offen lds
    s_lshl_b32 s46, s39, 10
    s_add_u32 s46, s46, s42
    s_add_u32 m0, s46, 16384
    s_nop 0
    buffer_load_dwordx4 v4, s[20:23], s45 offen lds
    s_add_u32 m0, s46, 20480
    s_nop 0
    buffer_load_dwordx4 v5, s[20:23], s45 offen lds
    s_add_u32 m0, s46, 24576
    s_nop 0
    buffer_load_dwordx4 v6, s[20:23], s45 offen lds
    s_add_u32 m0, s46, 28672
    s_nop 0
    buffer_load_dwordx4 v7, s[20:23], s45 offen lds
    s_cmp_lt_u32 s39, 2
    s_cbranch_scc0 K1Zp_s_3
    s_add_u32 m0, s46, 32768
    s_nop 0
    buffer_load_dwordx4 v8, s[20:23], s45 offen lds
K1Zp_s_3:
    s_add_u32 s42, s42, 34816
    s_cmp_eq_u32 s42, 139264
    s_cselect_b32 s42, 0, s42
    s_add_u32 s44, s44, 128
    s_add_u32 s45, s45, 221184
    s_cmp_eq_u32 s44, 1280
    s_cselect_b32 s44, 0, s44
    s_cselect_b32 s45, 0, s45
    s_lshl_b32 s46, s39, 12
    s_add_u32 s46, s46, s42
    s_add_u32 m0, s46, 0
    s_add_u32 s47, s44, 0
    buffer_load_dwordx4 v2, s[16:19], s47 offen lds
    s_add_u32 m0, s46, 1024
    s_add_u32 s47, s44, 10240
    buffer_load_dwordx4 v3, s[16:19], s47 offen lds
    s_add_u32 m0, s46, 2048
    s_add_u32 s47, s44, 20480
    buffer_load_dwordx4 v2, s[16:19], s47 offen lds
    s_add_u32 m0, s46, 3072
    s_add_u32 s47, s44, 30720
    buffer_load_dwordx4 v3, s[16:19], s47 offen lds
    s_lshl_b32 s46, s39, 10
    s_add_u32 s46, s46, s42
    s_add_u32 m0, s46, 16384
    s_nop 0
    buffer_load_dwordx4 v4, s[20:23], s45 offen lds
    s_add_u32 m0, s46, 20480
    s_nop 0
    buffer_load_dwordx4 v5, s[20:23], s45 offen lds
    s_add_u32 m0, s46, 24576
    s_nop 0
    buffer_load_dwordx4 v6, s[20:23], s45 offen lds
    s_add_u32 m0, s46, 28672
    s_nop 0
    buffer_load_dwordx4 v7, s[20:23], s45 offen lds
    s_cmp_lt_u32 s39, 2
    s_cbranch_scc0 K1Zp_s_4
    s_add_u32 m0, s46, 32768
    s_nop 0
    buffer_load_dwordx4 v8, s[20:23], s45 offen lds
K1Zp_s_4:
    s_add_u32 s42, s42, 34816
    s_cmp_eq_u32 s42, 139264
    s_cselect_b32 s42, 0, s42
    s_add_u32 s44, s44, 128
    s_add_u32 s45, s45, 221184
    s_cmp_eq_u32 s44, 1280
    s_cselect_b32 s44, 0, s44
    s_cselect_b32 s45, 0, s45
    s_mov_b32 s41, 6
K1Zp_loop:
    s_waitcnt vmcnt(16)
    s_barrier
    s_lshl_b32 s46, s39, 12
    s_add_u32 s46, s46, s42
    s_add_u32 m0, s46, 0
    s_add_u32 s47, s44, 0
    buffer_load_dwordx4 v2, s[16:19], s47 offen lds
    s_add_u32 m0, s46, 1024
    s_add_u32 s47, s44, 10240
    buffer_load_dwordx4 v3, s[16:19], s47 offen lds
    s_add_u32 m0, s46, 2048
    s_add_u32 s47, s44, 20480
    buffer_load_dwordx4 v2, s[16:19], s47 offen lds
    s_add_u32 m0, s46, 3072
    s_add_u32 s47, s44, 30720
    buffer_load_dwordx4 v3, s[16:19], s47 offen lds
    s_lshl_b32 s46, s39, 10
    s_add_u32 s46, s46, s42
    s_add_u32 m0, s46, 16384
    s_nop 0
    buffer_load_dwordx4 v4, s[20:23], s45 offen lds
    s_add_u32 m0, s46, 20480
    s_nop 0
    buffer_load_dwordx4 v5, s[20:23], s45 offen lds
    s_add_u32 m0, s46, 24576
    s_nop 0
    buffer_load_dwordx4 v6, s[20:23], s45 offen lds
    s_add_u32 m0, s46, 28672
    s_nop 0
    buffer_load_dwordx4 v7, s[20:23], s45 offen lds
    s_cmp_lt_u32 s39, 2
    s_cbranch_scc0 K1Zp_s_5
    s_add_u32 m0, s46, 32768
    s_nop 0
    buffer_load_dwordx4 v8, s[20:23], s45 offen lds
K1Zp_s_5:
    s_add_u32 s42, s42, 34816
    s_cmp_eq_u32 s42, 139264
    s_cselect_b32 s42, 0, s42
    s_add_u32 s44, s44, 128
    s_add_u32 s45, s45, 221184
    s_cmp_eq_u32 s44, 1280
    s_cselect_b32 s44, 0, s44
    s_cselect_b32 s45, 0, s45
    s_sub_u32 s41, s41, 1
    s_cmp_lg_u32 s41, 0
    s_cbranch_scc1 K1Zp_loop
    s_waitcnt vmcnt(16)
    s_barrier
    s_waitcnt vmcnt(8)
    s_barrier
    s_waitcnt vmcnt(0)
    s_barrier
    s_barrier
    s_branch K1_end
K1Z_work:
    s_sub_u32 s39, s32, 12
    s_waitcnt lgkmcnt(0)
    s_mov_b32 s60, s14
    s_mov_b32 s61, s15
    s_mov_b32 s62, 0x100
    s_mov_b32 s63, 0x00020000
    s_add_u32 s50, s6, 0x8d0000
    s_addc_u32 s51, s7, 0
    s_mov_b32 s56, s50
    s_mov_b32 s57, s51
    s_mov_b32 s58, 0x30000
    s_mov_b32 s59, 0x00020000
    s_cmp_eq_u32 s39, 0
    s_cbranch_scc0 K1Zw_nojob
    s_mul_i32 s47, s37, 12288
    s_lshl_b32 s48, s38, 1
    s_add_u32 s48, s48, s53
    s_lshl_b32 s48, s48, 10
    s_add_u32 s47, s47, s48
    v_mov_b32 v8, -1
    v_mov_b32 v9, -1
    v_mov_b32 v10, -1
    v_mov_b32 v11, -1
    v_lshlrev_b32 v3, 4, v0
    buffer_store_dwordx4 v[8:11], v3, s[56:59], s47 offen sc1
K1Zw_nojob:
    s_cmp_eq_u32 s39, 0
    s_cbranch_scc0 K1Zw_cf_6
    s_add_u32 s50, s6, 0x8cc000
    s_addc_u32 s51, s7, 0
    s_mov_b32 s24, s50
    s_mov_b32 s25, s51
    s_mov_b32 s26, 0x4000
    s_mov_b32 s27, 0x00020000
    s_lshl_b32 s48, s2, 5
    v_mov_b32 v12, 0
    v_lshlrev_b32 v13, 13, v0
    s_mov_b32 exec_lo, 3
    s_mov_b32 exec_hi, 0
    buffer_store_dword v12, v13, s[24:27], s48 offen sc1
    s_mov_b64 exec, -1
K1Zw_cf_6:
    s_load_dwordx2 s[86:87], s[0:1], 56
    s_load_dwordx4 s[96:99], s[0:1], 8
    s_load_dwordx2 s[88:89], s[0:1], 72
    v_lshrrev_b32 v4, 4, v0
    v_and_b32 v5, 15, v0
    v_lshlrev_b32 v5, 7, v5
    s_lshl_b32 s48, s35, 9
    s_lshl_b32 s49, s34, 4
    s_add_u32 s48, s48, s49
    v_add_u32 v6, s48, v4
    v_lshlrev_b32 v6, 12, v6
    v_add_u32 v6, v6, v5
    s_lshl_b32 s48, s36, 11
    v_add_u32 v6, s48, v6
    s_mul_i32 s48, s35, 288
    s_mul_i32 s49, s34, 9
    s_add_u32 s48, s48, s49
    v_add_u32 v7, s48, v4
    v_lshlrev_b32 v7, 12, v7
    v_add_u32 v7, v7, v5
    v_and_b32 v21, 15, v0
    v_lshlrev_b32 v21, 4, v21
    v_mov_b32 v20, 0
    v_mov_b32 v16, 0
    v_mov_b32 v17, 0
    v_mov_b32 v18, 0
    v_mov_b32 v19, 0
    s_waitcnt lgkmcnt(0)
    s_mov_b32 s20, s86
    s_mov_b32 s21, s87
    s_mov_b32 s22, 0x800000
    s_mov_b32 s23, 0x00020000
    s_cmp_eq_u32 s36, 0
    s_cselect_b32 s50, s96, s98
    s_cselect_b32 s51, s97, s99
    s_mov_b32 s28, s50
    s_mov_b32 s29, s51
    s_mov_b32 s30, 0x800000
    s_mov_b32 s31, 0x00020000
    s_cmp_eq_u32 s39, 2
    s_cbranch_scc0 K1Zw_cp_7
    s_getpc_b64 s[90:91]
K1Zw_pc_8:
    s_sub_u32 s90, s90, K1Zw_pc_8-KSTART
    s_subb_u32 s91, s91, 0
    s_mov_b32 s24, s90
    s_mov_b32 s25, s91
    s_mov_b32 s26, KEND-KSTART
    s_mov_b32 s27, 0x00020000
    s_lshl_b32 s47, s34, 11
    v_lshlrev_b32 v11, 7, v0
    s_mov_b32 exec_hi, 0
    s_mov_b32 exec_lo, 0xffff
    buffer_load_dword v10, v11, s[24:27], s47 offen
    s_mov_b64 exec, -1
K1Zw_cp_7:
    s_cmp_eq_u32 s39, 3
    s_cbranch_scc0 K1Zw_e3_9
    s_mov_b32 s24, s12
    s_mov_b32 s25, s13
    s_mov_b32 s26, 0x21c000
    s_mov_b32 s27, 0x00020000
    s_mul_i32 s47, s2, 8704
    v_lshlrev_b32 v11, 7, v0
    buffer_load_dword v10, v11, s[24:27], s47 offen
    s_add_u32 s47, s47, 8192
    s_mov_b32 exec_hi, 0
    s_mov_b32 exec_lo, 15
    buffer_load_dword v10, v11, s[24:27], s47 offen
    s_mov_b64 exec, -1
K1Zw_e3_9:
    s_cmp_eq_u32 s39, 2
    s_cbranch_scc0 K1Zw_e2_10
    s_cmp_lt_u32 s2, 128
    s_cselect_b32 s50, s8, s10
    s_cselect_b32 s51, s9, s11
    s_mov_b32 s24, s50
    s_mov_b32 s25, s51
    s_mov_b32 s26, 0x64500
    s_mov_b32 s27, 0x00020000
    s_and_b32 s47, s2, 127
    s_mul_i32 s47, s47, 3200
    s_add_u32 s47, s47, 1280
    v_lshlrev_b32 v11, 7, v0
    s_mov_b32 exec_hi, 0
    s_mov_b32 exec_lo, 0x1ffffff
    buffer_load_dword v10, v11, s[24:27], s47 offen
    s_mov_b64 exec, -1
K1Zw_e2_10:
    v_and_b32 v120, 15, v0
    v_lshrrev_b32 v121, 4, v0
    v_lshrrev_b32 v122, 2, v120
    v_lshl_add_u32 v122, v121, 2, v122
    v_mul_u32_u24 v122, 288, v122
    v_and_b32 v120, 3, v120
    v_lshl_add_u32 v122, v120, 3, v122
    s_and_b32 s48, s39, 1
    s_mul_i32 s48, s48, 9216
    s_cmp_lt_u32 s39, 2
    s_cselect_b32 s49, 160, 0
    s_add_u32 s48, s48, s49
    s_add_u32 s48, s48, 16384
    v_add_u32 v14, s48, v122
    v_mov_b32 v108, 0x3f803f80
    v_mov_b32 v109, 0x3f803f80
    v_mov_b32 v110, 0x3f803f80
    v_mov_b32 v111, 0x3f803f80
    v_mov_b32 v88, 0
    v_mov_b32 v89, 0
    v_mov_b32 v90, 0
    v_mov_b32 v91, 0
    v_mov_b32 v92, 0
    v_mov_b32 v93, 0
    v_mov_b32 v94, 0
    v_mov_b32 v95, 0
    v_mov_b32 v96, 0
    v_mov_b32 v97, 0
    v_mov_b32 v98, 0
    v_mov_b32 v99, 0
    v_mov_b32 v100, 0
    v_mov_b32 v101, 0
    v_mov_b32 v102, 0
    v_mov_b32 v103, 0
    v_mov_b32 v104, 0
    v_mov_b32 v105, 0
    v_mov_b32 v106, 0
    v_mov_b32 v107, 0
    v_mov_b32 v48, 0
    v_mov_b32 v49, 0
    v_mov_b32 v50, 0
    v_mov_b32 v51, 0
    v_mov_b32 v52, 0
    v_mov_b32 v53, 0
    v_mov_b32 v54, 0
    v_mov_b32 v55, 0
    v_mov_b32 v56, 0
    v_mov_b32 v57, 0
    v_mov_b32 v58, 0
    v_mov_b32 v59, 0
    v_mov_b32 v60, 0
    v_mov_b32 v61, 0
    v_mov_b32 v62, 0
    v_mov_b32 v63, 0
    v_mov_b32 v64, 0
    v_mov_b32 v65, 0
    v_mov_b32 v66, 0
    v_mov_b32 v67, 0
    v_mov_b32 v68, 0
    v_mov_b32 v69, 0
    v_mov_b32 v70, 0
    v_mov_b32 v71, 0
    v_mov_b32 v72, 0
    v_mov_b32 v73, 0
    v_mov_b32 v74, 0
    v_mov_b32 v75, 0
    v_mov_b32 v76, 0
    v_mov_b32 v77, 0
    v_mov_b32 v78, 0
    v_mov_b32 v79, 0
    v_mov_b32 v80, 0
    v_mov_b32 v81, 0
    v_mov_b32 v82, 0
    v_mov_b32 v83, 0
    v_mov_b32 v84, 0
    v_mov_b32 v85, 0
    v_mov_b32 v86, 0
    v_mov_b32 v87, 0
    s_mov_b32 s43, 0
    s_barrier
    v_add_u32 v15, s43, v14
    ds_read_b64_tr_b16 v[48:49], v15 offset:0
    ds_read_b64_tr_b16 v[50:51], v15 offset:4608
    ds_read_b64_tr_b16 v[52:53], v15 offset:32
    ds_read_b64_tr_b16 v[54:55], v15 offset:4640
    ds_read_b64_tr_b16 v[56:57], v15 offset:64
    ds_read_b64_tr_b16 v[58:59], v15 offset:4672
    ds_read_b64_tr_b16 v[60:61], v15 offset:96
    ds_read_b64_tr_b16 v[62:63], v15 offset:4704
    s_cmp_lt_u32 s39, 2
    s_cbranch_scc1 K1Zw_c_11
    ds_read_b64_tr_b16 v[64:65], v15 offset:128
    ds_read_b64_tr_b16 v[66:67], v15 offset:4736
K1Zw_c_11:
    v_mfma_f32_16x16x32_bf16 v[88:91], v[108:111], v[68:71], v[88:91]
    v_mfma_f32_16x16x32_bf16 v[92:95], v[108:111], v[72:75], v[92:95]
    v_mfma_f32_16x16x32_bf16 v[96:99], v[108:111], v[76:79], v[96:99]
    v_mfma_f32_16x16x32_bf16 v[100:103], v[108:111], v[80:83], v[100:103]
    v_mfma_f32_16x16x32_bf16 v[104:107], v[108:111], v[84:87], v[104:107]
    s_waitcnt lgkmcnt(0)
    s_add_u32 s43, s43, 34816
    s_cmp_eq_u32 s43, 139264
    s_cselect_b32 s43, 0, s43
    s_barrier
    v_add_u32 v15, s43, v14
    ds_read_b64_tr_b16 v[68:69], v15 offset:0
    ds_read_b64_tr_b16 v[70:71], v15 offset:4608
    ds_read_b64_tr_b16 v[72:73], v15 offset:32
    ds_read_b64_tr_b16 v[74:75], v15 offset:4640
    ds_read_b64_tr_b16 v[76:77], v15 offset:64
    ds_read_b64_tr_b16 v[78:79], v15 offset:4672
    ds_read_b64_tr_b16 v[80:81], v15 offset:96
    ds_read_b64_tr_b16 v[82:83], v15 offset:4704
    s_cmp_lt_u32 s39, 2
    s_cbranch_scc1 K1Zw_c_12
    ds_read_b64_tr_b16 v[84:85], v15 offset:128
    ds_read_b64_tr_b16 v[86:87], v15 offset:4736
K1Zw_c_12:
    v_mfma_f32_16x16x32_bf16 v[88:91], v[108:111], v[48:51], v[88:91]
    v_mfma_f32_16x16x32_bf16 v[92:95], v[108:111], v[52:55], v[92:95]
    v_mfma_f32_16x16x32_bf16 v[96:99], v[108:111], v[56:59], v[96:99]
    v_mfma_f32_16x16x32_bf16 v[100:103], v[108:111], v[60:63], v[100:103]
    v_mfma_f32_16x16x32_bf16 v[104:107], v[108:111], v[64:67], v[104:107]
    s_waitcnt lgkmcnt(0)
    s_add_u32 s43, s43, 34816
    s_cmp_eq_u32 s43, 139264
    s_cselect_b32 s43, 0, s43
    s_barrier
    v_add_u32 v15, s43, v14
    ds_read_b64_tr_b16 v[48:49], v15 offset:0
    ds_read_b64_tr_b16 v[50:51], v15 offset:4608
    ds_read_b64_tr_b16 v[52:53], v15 offset:32
    ds_read_b64_tr_b16 v[54:55], v15 offset:4640
    ds_read_b64_tr_b16 v[56:57], v15 offset:64
    ds_read_b64_tr_b16 v[58:59], v15 offset:4672
    ds_read_b64_tr_b16 v[60:61], v15 offset:96
    ds_read_b64_tr_b16 v[62:63], v15 offset:4704
    s_cmp_lt_u32 s39, 2
    s_cbranch_scc1 K1Zw_c_13
    ds_read_b64_tr_b16 v[64:65], v15 offset:128
    ds_read_b64_tr_b16 v[66:67], v15 offset:4736
K1Zw_c_13:
    s_cmp_eq_u32 s39, 1
    s_cbranch_scc0 K1Zw_p_14
K1Zw_p_14:
    s_cmp_eq_u32 s39, 0
    s_cbranch_scc0 K1Zw_a_15
    s_waitcnt vmcnt(0)
    v_mov_b32 v4, 1
    s_and_b32 s48, s2, 15
    s_lshl_b32 s48, s48, 4
    v_mov_b32 v3, s48
    v_cmp_eq_u32 vcc, 0, v0
    s_and_saveexec_b64 s[54:55], vcc
    buffer_atomic_add v4, v3, s[60:63], 0 offen sc1
    s_mov_b64 exec, s[54:55]
K1Zw_a_15:
    v_mfma_f32_16x16x32_bf16 v[88:91], v[108:111], v[68:71], v[88:91]
    v_mfma_f32_16x16x32_bf16 v[92:95], v[108:111], v[72:75], v[92:95]
    v_mfma_f32_16x16x32_bf16 v[96:99], v[108:111], v[76:79], v[96:99]
    v_mfma_f32_16x16x32_bf16 v[100:103], v[108:111], v[80:83], v[100:103]
    v_mfma_f32_16x16x32_bf16 v[104:107], v[108:111], v[84:87], v[104:107]
    s_waitcnt lgkmcnt(0)
    s_add_u32 s43, s43, 34816
    s_cmp_eq_u32 s43, 139264
    s_cselect_b32 s43, 0, s43
    s_barrier
    v_add_u32 v15, s43, v14
    ds_read_b64_tr_b16 v[68:69], v15 offset:0
    ds_read_b64_tr_b16 v[70:71], v15 offset:4608
    ds_read_b64_tr_b16 v[72:73], v15 offset:32
    ds_read_b64_tr_b16 v[74:75], v15 offset:4640
    ds_read_b64_tr_b16 v[76:77], v15 offset:64
    ds_read_b64_tr_b16 v[78:79], v15 offset:4672
    ds_read_b64_tr_b16 v[80:81], v15 offset:96
    ds_read_b64_tr_b16 v[82:83], v15 offset:4704
    s_cmp_lt_u32 s39, 2
    s_cbranch_scc1 K1Zw_c_16
    ds_read_b64_tr_b16 v[84:85], v15 offset:128
    ds_read_b64_tr_b16 v[86:87], v15 offset:4736
K1Zw_c_16:
    s_cmp_eq_u32 s39, 1
    s_cbranch_scc0 K1Zw_p_17
K1Zw_p_17:
    v_mfma_f32_16x16x32_bf16 v[88:91], v[108:111], v[48:51], v[88:91]
    v_mfma_f32_16x16x32_bf16 v[92:95], v[108:111], v[52:55], v[92:95]
    v_mfma_f32_16x16x32_bf16 v[96:99], v[108:111], v[56:59], v[96:99]
    v_mfma_f32_16x16x32_bf16 v[100:103], v[108:111], v[60:63], v[100:103]
    v_mfma_f32_16x16x32_bf16 v[104:107], v[108:111], v[64:67], v[104:107]
    s_waitcnt lgkmcnt(0)
    s_add_u32 s43, s43, 34816
    s_cmp_eq_u32 s43, 139264
    s_cselect_b32 s43, 0, s43
    s_barrier
    v_add_u32 v15, s43, v14
    ds_read_b64_tr_b16 v[48:49], v15 offset:0
    ds_read_b64_tr_b16 v[50:51], v15 offset:4608
    ds_read_b64_tr_b16 v[52:53], v15 offset:32
    ds_read_b64_tr_b16 v[54:55], v15 offset:4640
    ds_read_b64_tr_b16 v[56:57], v15 offset:64
    ds_read_b64_tr_b16 v[58:59], v15 offset:4672
    ds_read_b64_tr_b16 v[60:61], v15 offset:96
    ds_read_b64_tr_b16 v[62:63], v15 offset:4704
    s_cmp_lt_u32 s39, 2
    s_cbranch_scc1 K1Zw_c_18
    ds_read_b64_tr_b16 v[64:65], v15 offset:128
    ds_read_b64_tr_b16 v[66:67], v15 offset:4736
K1Zw_c_18:
    s_cmp_eq_u32 s39, 1
    s_cbranch_scc0 K1Zw_p_19
K1Zw_p_19:
    v_mfma_f32_16x16x32_bf16 v[88:91], v[108:111], v[68:71], v[88:91]
    v_mfma_f32_16x16x32_bf16 v[92:95], v[108:111], v[72:75], v[92:95]
    v_mfma_f32_16x16x32_bf16 v[96:99], v[108:111], v[76:79], v[96:99]
    v_mfma_f32_16x16x32_bf16 v[100:103], v[108:111], v[80:83], v[100:103]
    v_mfma_f32_16x16x32_bf16 v[104:107], v[108:111], v[84:87], v[104:107]
    s_waitcnt lgkmcnt(0)
    s_add_u32 s43, s43, 34816
    s_cmp_eq_u32 s43, 139264
    s_cselect_b32 s43, 0, s43
    s_barrier
    v_add_u32 v15, s43, v14
    ds_read_b64_tr_b16 v[68:69], v15 offset:0
    ds_read_b64_tr_b16 v[70:71], v15 offset:4608
    ds_read_b64_tr_b16 v[72:73], v15 offset:32
    ds_read_b64_tr_b16 v[74:75], v15 offset:4640
    ds_read_b64_tr_b16 v[76:77], v15 offset:64
    ds_read_b64_tr_b16 v[78:79], v15 offset:4672
    ds_read_b64_tr_b16 v[80:81], v15 offset:96
    ds_read_b64_tr_b16 v[82:83], v15 offset:4704
    s_cmp_lt_u32 s39, 2
    s_cbranch_scc1 K1Zw_c_20
    ds_read_b64_tr_b16 v[84:85], v15 offset:128
    ds_read_b64_tr_b16 v[86:87], v15 offset:4736
K1Zw_c_20:
    s_cmp_eq_u32 s39, 1
    s_cbranch_scc0 K1Zw_p_21
K1Zw_p_21:
    s_cmp_eq_u32 s39, 0
    s_cbranch_scc0 K1Zw_q_22
    buffer_load_dword v20, v21, s[60:63], 0 offen sc1
K1Zw_q_22:
    v_mfma_f32_16x16x32_bf16 v[88:91], v[108:111], v[48:51], v[88:91]
    v_mfma_f32_16x16x32_bf16 v[92:95], v[108:111], v[52:55], v[92:95]
    v_mfma_f32_16x16x32_bf16 v[96:99], v[108:111], v[56:59], v[96:99]
    v_mfma_f32_16x16x32_bf16 v[100:103], v[108:111], v[60:63], v[100:103]
    v_mfma_f32_16x16x32_bf16 v[104:107], v[108:111], v[64:67], v[104:107]
    s_waitcnt lgkmcnt(0)
    s_add_u32 s43, s43, 34816
    s_cmp_eq_u32 s43, 139264
    s_cselect_b32 s43, 0, s43
    s_barrier
    v_add_u32 v15, s43, v14
    ds_read_b64_tr_b16 v[48:49], v15 offset:0
    ds_read_b64_tr_b16 v[50:51], v15 offset:4608
    ds_read_b64_tr_b16 v[52:53], v15 offset:32
    ds_read_b64_tr_b16 v[54:55], v15 offset:4640
    ds_read_b64_tr_b16 v[56:57], v15 offset:64
    ds_read_b64_tr_b16 v[58:59], v15 offset:4672
    ds_read_b64_tr_b16 v[60:61], v15 offset:96
    ds_read_b64_tr_b16 v[62:63], v15 offset:4704
    s_cmp_lt_u32 s39, 2
    s_cbranch_scc1 K1Zw_c_23
    ds_read_b64_tr_b16 v[64:65], v15 offset:128
    ds_read_b64_tr_b16 v[66:67], v15 offset:4736
K1Zw_c_23:
    s_cmp_eq_u32 s39, 1
    s_cbranch_scc0 K1Zw_p_24
    s_mov_b32 s47, 0
    buffer_load_dword v10, v7, s[28:31], s47 offen
K1Zw_p_24:
    v_mfma_f32_16x16x32_bf16 v[88:91], v[108:111], v[68:71], v[88:91]
    v_mfma_f32_16x16x32_bf16 v[92:95], v[108:111], v[72:75], v[92:95]
    v_mfma_f32_16x16x32_bf16 v[96:99], v[108:111], v[76:79], v[96:99]
    v_mfma_f32_16x16x32_bf16 v[100:103], v[108:111], v[80:83], v[100:103]
    v_mfma_f32_16x16x32_bf16 v[104:107], v[108:111], v[84:87], v[104:107]
    s_waitcnt lgkmcnt(0)
    s_add_u32 s43, s43, 34816
    s_cmp_eq_u32 s43, 139264
    s_cselect_b32 s43, 0, s43
    s_barrier
    v_add_u32 v15, s43, v14
    ds_read_b64_tr_b16 v[68:69], v15 offset:0
    ds_read_b64_tr_b16 v[70:71], v15 offset:4608
    ds_read_b64_tr_b16 v[72:73], v15 offset:32
    ds_read_b64_tr_b16 v[74:75], v15 offset:4640
    ds_read_b64_tr_b16 v[76:77], v15 offset:64
    ds_read_b64_tr_b16 v[78:79], v15 offset:4672
    ds_read_b64_tr_b16 v[80:81], v15 offset:96
    ds_read_b64_tr_b16 v[82:83], v15 offset:4704
    s_cmp_lt_u32 s39, 2
    s_cbranch_scc1 K1Zw_c_25
    ds_read_b64_tr_b16 v[84:85], v15 offset:128
    ds_read_b64_tr_b16 v[86:87], v15 offset:4736
K1Zw_c_25:
    s_cmp_eq_u32 s39, 1
    s_cbranch_scc0 K1Zw_p_26
    s_mov_b32 s47, 16384
    buffer_load_dword v10, v7, s[28:31], s47 offen
K1Zw_p_26:
    s_cmp_eq_u32 s39, 0
    s_cbranch_scc0 K1Zw_r_27
    s_mov_b32 s52, 0
K1Zw_pl_28:
    s_waitcnt vmcnt(0)
    v_cmp_gt_u32 vcc, 16, v20
    s_nop 1
    s_cmp_eq_u64 vcc, 0
    s_cbranch_scc1 K1Zw_ok_29
    buffer_load_dword v20, v21, s[60:63], 0 offen sc1
    s_add_u32 s52, s52, 1
    s_cmp_lt_u32 s52, 4000
    s_cbranch_scc1 K1Zw_pl_28
K1Zw_ok_29:
    s_add_u32 s50, s6, 0x8c8000
    s_addc_u32 s51, s7, 0
    s_mov_b32 s24, s50
    s_mov_b32 s25, s51
    s_mov_b32 s26, 0x4000
    s_mov_b32 s27, 0x00020000
    s_lshl_b32 s48, s37, 7
    v_add_u32 v22, s48, v0
    v_add_u32 v23, 64, v22
    v_lshlrev_b32 v22, 3, v22
    v_lshlrev_b32 v23, 3, v23
    buffer_load_dwordx2 v[16:17], v22, s[24:27], 0 offen sc1
    buffer_load_dwordx2 v[18:19], v23, s[24:27], 0 offen sc1
K1Zw_r_27:
    v_mfma_f32_16x16x32_bf16 v[88:91], v[108:111], v[48:51], v[88:91]
    v_mfma_f32_16x16x32_bf16 v[92:95], v[108:111], v[52:55], v[92:95]
    v_mfma_f32_16x16x32_bf16 v[96:99], v[108:111], v[56:59], v[96:99]
    v_mfma_f32_16x16x32_bf16 v[100:103], v[108:111], v[60:63], v[100:103]
    v_mfma_f32_16x16x32_bf16 v[104:107], v[108:111], v[64:67], v[104:107]
    s_waitcnt lgkmcnt(0)
    s_add_u32 s43, s43, 34816
    s_cmp_eq_u32 s43, 139264
    s_cselect_b32 s43, 0, s43
    s_barrier
    v_add_u32 v15, s43, v14
    ds_read_b64_tr_b16 v[48:49], v15 offset:0
    ds_read_b64_tr_b16 v[50:51], v15 offset:4608
    ds_read_b64_tr_b16 v[52:53], v15 offset:32
    ds_read_b64_tr_b16 v[54:55], v15 offset:4640
    ds_read_b64_tr_b16 v[56:57], v15 offset:64
    ds_read_b64_tr_b16 v[58:59], v15 offset:4672
    ds_read_b64_tr_b16 v[60:61], v15 offset:96
    ds_read_b64_tr_b16 v[62:63], v15 offset:4704
    s_cmp_lt_u32 s39, 2
    s_cbranch_scc1 K1Zw_c_30
    ds_read_b64_tr_b16 v[64:65], v15 offset:128
    ds_read_b64_tr_b16 v[66:67], v15 offset:4736
K1Zw_c_30:
    s_cmp_eq_u32 s39, 1
    s_cbranch_scc0 K1Zw_p_31
    s_mov_b32 s47, 32768
    s_mov_b32 exec_hi, 0
    s_mov_b32 exec_lo, 0xffff
    buffer_load_dword v10, v7, s[28:31], s47 offen
    s_mov_b64 exec, -1
K1Zw_p_31:
    s_cmp_eq_u32 s39, 2
    s_cbranch_scc0 K1Zw_wo_32
    s_mov_b32 s24, s88
    s_mov_b32 s25, s89
    s_mov_b32 s26, 0x10e000
    s_mov_b32 s27, 0x00020000
    s_mul_i32 s47, s2, 4352
    v_lshlrev_b32 v11, 7, v0
    s_mov_b32 exec_hi, 3
    buffer_load_dword v10, v11, s[24:27], s47 offen
    s_mov_b32 exec_hi, -1
K1Zw_wo_32:
    v_mfma_f32_16x16x32_bf16 v[88:91], v[108:111], v[68:71], v[88:91]
    v_mfma_f32_16x16x32_bf16 v[92:95], v[108:111], v[72:75], v[92:95]
    v_mfma_f32_16x16x32_bf16 v[96:99], v[108:111], v[76:79], v[96:99]
    v_mfma_f32_16x16x32_bf16 v[100:103], v[108:111], v[80:83], v[100:103]
    v_mfma_f32_16x16x32_bf16 v[104:107], v[108:111], v[84:87], v[104:107]
    s_waitcnt lgkmcnt(0)
    s_add_u32 s43, s43, 34816
    s_cmp_eq_u32 s43, 139264
    s_cselect_b32 s43, 0, s43
    s_barrier
    v_add_u32 v15, s43, v14
    ds_read_b64_tr_b16 v[68:69], v15 offset:0
    ds_read_b64_tr_b16 v[70:71], v15 offset:4608
    ds_read_b64_tr_b16 v[72:73], v15 offset:32
    ds_read_b64_tr_b16 v[74:75], v15 offset:4640
    ds_read_b64_tr_b16 v[76:77], v15 offset:64
    ds_read_b64_tr_b16 v[78:79], v15 offset:4672
    ds_read_b64_tr_b16 v[80:81], v15 offset:96
    ds_read_b64_tr_b16 v[82:83], v15 offset:4704
    s_cmp_lt_u32 s39, 2
    s_cbranch_scc1 K1Zw_c_33
    ds_read_b64_tr_b16 v[84:85], v15 offset:128
    ds_read_b64_tr_b16 v[86:87], v15 offset:4736
K1Zw_c_33:
    v_mfma_f32_16x16x32_bf16 v[88:91], v[108:111], v[48:51], v[88:91]
    v_mfma_f32_16x16x32_bf16 v[92:95], v[108:111], v[52:55], v[92:95]
    v_mfma_f32_16x16x32_bf16 v[96:99], v[108:111], v[56:59], v[96:99]
    v_mfma_f32_16x16x32_bf16 v[100:103], v[108:111], v[60:63], v[100:103]
    v_mfma_f32_16x16x32_bf16 v[104:107], v[108:111], v[64:67], v[104:107]
    s_waitcnt lgkmcnt(0)
    s_add_u32 s43, s43, 34816
    s_cmp_eq_u32 s43, 139264
    s_cselect_b32 s43, 0, s43
    v_mfma_f32_16x16x32_bf16 v[88:91], v[108:111], v[68:71], v[88:91]
    v_mfma_f32_16x16x32_bf16 v[92:95], v[108:111], v[72:75], v[92:95]
    v_mfma_f32_16x16x32_bf16 v[96:99], v[108:111], v[76:79], v[96:99]
    v_mfma_f32_16x16x32_bf16 v[100:103], v[108:111], v[80:83], v[100:103]
    v_mfma_f32_16x16x32_bf16 v[104:107], v[108:111], v[84:87], v[104:107]
    s_cmp_eq_u32 s39, 0
    s_cbranch_scc0 K1Zw_w_34
    s_waitcnt vmcnt(0)
    v_lshlrev_b32 v26, 2, v0
    v_add_u32 v26, 147456, v26
    ds_write_b32 v26, v16
    ds_write_b32 v26, v17 offset:512
    ds_write_b32 v26, v18 offset:256
    ds_write_b32 v26, v19 offset:768
K1Zw_w_34:
    s_and_b32 s48, s39, 1
    s_mul_i32 s48, s48, 640
    s_cmp_lt_u32 s39, 2
    s_cselect_b32 s49, 320, 0
    s_add_u32 s48, s48, s49
    v_and_b32 v26, 15, v0
    v_lshlrev_b32 v26, 2, v26
    v_add_u32 v26, s48, v26
    v_add_u32 v26, 148480, v26
    s_nop 7
    ds_write_b32 v26, v88 offset:0
    ds_write_b32 v26, v92 offset:64
    ds_write_b32 v26, v96 offset:128
    ds_write_b32 v26, v100 offset:192
    s_cmp_lt_u32 s39, 2
    s_cbranch_scc1 K1Zw_f_35
    ds_write_b32 v26, v104 offset:256
K1Zw_f_35:
    s_waitcnt lgkmcnt(0)
    s_barrier
    s_cmp_eq_u32 s39, 1
    s_cbranch_scc0 K1Zw_pl8_36
    s_mov_b32 s47, 0
    buffer_load_dword v10, v6, s[20:23], s47 offen
    s_mov_b32 s47, 16384
    buffer_load_dword v10, v6, s[20:23], s47 offen
    s_mov_b32 s47, 32768
    buffer_load_dword v10, v6, s[20:23], s47 offen
    s_mov_b32 s47, 49152
    buffer_load_dword v10, v6, s[20:23], s47 offen
K1Zw_pl8_36:
    s_branch K1_end
K1A_entry:
    s_sub_u32 s48, s34, 24
    s_lshr_b32 s49, s48, 1
    s_and_b32 s38, s48, 1
    s_lshl_b32 s37, s35, 2
    s_add_u32 s37, s37, s49
    s_cmp_ge_u32 s32, 12
    s_cbranch_scc1 K1A_work
    s_cmp_ge_u32 s32, 8
    s_cbranch_scc1 K1A_prod
    s_and_b32 s39, s32, 3
    s_lshr_b32 s40, s32, 2
    v_and_b32 v1, 15, v0
    v_lshrrev_b32 v2, 4, v0
    v_and_b32 v3, 7, v0
    v_xor_b32 v3, v3, v2
    v_lshlrev_b32 v3, 4, v3
    v_lshl_add_u32 v3, v1, 7, v3
    s_lshl_b32 s48, s39, 11
    v_add_u32 v112, s48, v3
    v_xor_b32 v113, 64, v112
    s_mul_i32 s48, s40, 10240
    s_add_u32 s48, s48, 16384
    v_add_u32 v114, s48, v3
    v_xor_b32 v115, 64, v114
    s_lshl_b32 s48, s2, 3
    s_add_u32 s48, s48, s32
    s_mul_i32 s49, s48, 1280
    v_lshlrev_b32 v56, 4, v0
    v_mov_b32 v57, 0x3f803f80
    v_mov_b32 v68, 0
    v_mov_b32 v69, 0
    v_mov_b32 v70, 0
    v_mov_b32 v71, 0
    s_waitcnt lgkmcnt(0)
    s_add_u32 s50, s4, s49
    s_addc_u32 s51, s5, 0
    s_mov_b32 s24, s50
    s_mov_b32 s25, s51
    s_mov_b32 s26, 0x500
    s_mov_b32 s27, 0x00020000
    buffer_load_dwordx4 v[60:63], v56, s[24:27], 0 offen
    buffer_load_dwordx4 v[64:67], v56, s[24:27], 0 offen offset:1024
    s_add_u32 s50, s6, 0x8c8000
    s_addc_u32 s51, s7, 0
    s_mov_b32 s28, s50
    s_mov_b32 s29, s51
    s_mov_b32 s30, 0x4000
    s_mov_b32 s31, 0x00020000
    s_lshl_b32 s47, s48, 3
    v_mov_b32 v16, 0
    v_mov_b32 v17, 0
    v_mov_b32 v18, 0
    v_mov_b32 v19, 0
    v_mov_b32 v20, 0
    v_mov_b32 v21, 0
    v_mov_b32 v22, 0
    v_mov_b32 v23, 0
    v_mov_b32 v24, 0
    v_mov_b32 v25, 0
    v_mov_b32 v26, 0
    v_mov_b32 v27, 0
    v_mov_b32 v28, 0
    v_mov_b32 v29, 0
    v_mov_b32 v30, 0
    v_mov_b32 v31, 0
    v_mov_b32 v32, 0
    v_mov_b32 v33, 0
    v_mov_b32 v34, 0
    v_mov_b32 v35, 0
    v_mov_b32 v36, 0
    v_mov_b32 v37, 0
    v_mov_b32 v38, 0
    v_mov_b32 v39, 0
    v_mov_b32 v40, 0
    v_mov_b32 v41, 0
    v_mov_b32 v42, 0
    v_mov_b32 v43, 0
    v_mov_b32 v44, 0
    v_mov_b32 v45, 0
    v_mov_b32 v46, 0
    v_mov_b32 v47, 0
    v_mov_b32 v48, 0
    v_mov_b32 v49, 0
    v_mov_b32 v50, 0
    v_mov_b32 v51, 0
    v_mov_b32 v52, 0
    v_mov_b32 v53, 0
    v_mov_b32 v54, 0
    v_mov_b32 v55, 0
    s_waitcnt vmcnt(0)
    v_dot2_f32_bf16 v68, v60, v60, v68
    v_dot2_f32_bf16 v70, v60, v57, v70
    v_dot2_f32_bf16 v69, v61, v61, v69
    v_dot2_f32_bf16 v71, v61, v57, v71
    v_dot2_f32_bf16 v68, v62, v62, v68
    v_dot2_f32_bf16 v70, v62, v57, v70
    v_dot2_f32_bf16 v69, v63, v63, v69
    v_dot2_f32_bf16 v71, v63, v57, v71
    v_dot2_f32_bf16 v68, v64, v64, v68
    v_dot2_f32_bf16 v70, v64, v57, v70
    v_dot2_f32_bf16 v69, v65, v65, v69
    v_dot2_f32_bf16 v71, v65, v57, v71
    v_dot2_f32_bf16 v68, v66, v66, v68
    v_dot2_f32_bf16 v70, v66, v57, v70
    v_dot2_f32_bf16 v69, v67, v67, v69
    v_dot2_f32_bf16 v71, v67, v57, v71
    s_nop 3
    v_add_f32 v68, v68, v69
    v_add_f32 v70, v70, v71
    s_nop 1
    v_add_f32_dpp v68, v68, v68 quad_perm:[1,0,3,2] row_mask:0xf bank_mask:0xf
    v_add_f32_dpp v70, v70, v70 quad_perm:[1,0,3,2] row_mask:0xf bank_mask:0xf
    s_nop 0
    v_add_f32_dpp v68, v68, v68 quad_perm:[2,3,0,1] row_mask:0xf bank_mask:0xf
    v_add_f32_dpp v70, v70, v70 quad_perm:[2,3,0,1] row_mask:0xf bank_mask:0xf
    s_nop 0
    v_add_f32_dpp v68, v68, v68 row_half_mirror row_mask:0xf bank_mask:0xf
    v_add_f32_dpp v70, v70, v70 row_half_mirror row_mask:0xf bank_mask:0xf
    s_nop 0
    v_add_f32_dpp v68, v68, v68 row_mirror row_mask:0xf bank_mask:0xf
    v_add_f32_dpp v70, v70, v70 row_mirror row_mask:0xf bank_mask:0xf
    s_nop 0
    v_mov_b32 v69, v68
    v_mov_b32 v71, v70
    s_nop 1
    v_permlane16_swap_b32 v68, v69
    v_permlane16_swap_b32 v70, v71
    s_nop 1
    v_add_f32 v68, v68, v69
    v_add_f32 v70, v70, v71
    v_mov_b32 v69, v68
    v_mov_b32 v71, v70
    s_nop 1
    v_permlane32_swap_b32 v68, v69
    v_permlane32_swap_b32 v70, v71
    s_nop 1
    v_add_f32 v68, v68, v69
    v_add_f32 v70, v70, v71
    v_mul_f32 v70, 0x3acccccd, v70
    v_mul_f32 v68, 0x3acccccd, v68
    v_fma_f32 v68, -v70, v70, v68
    v_max_f32 v68, 0, v68
    v_add_f32 v68, 0x3727c5ac, v68
    v_rsq_f32 v72, v68
    s_nop 0
    v_mul_f32 v73, v70, v72
    v_sub_f32 v73, 0, v73
    v_mov_b32 v74, 0
    v_cmp_eq_u32 vcc, 0, v0
    s_and_saveexec_b64 s[54:55], vcc
    buffer_store_dwordx2 v[72:73], v74, s[28:31], s47 offen sc1
    s_mov_b64 exec, s[54:55]
    s_cmp_eq_u32 s40, 0
    s_cbranch_scc0 K1A_c1
    s_mov_b32 s41, 0
    s_mov_b32 s43, 0
    s_barrier
    ds_read_b128 v[56:59], v112 offset:0
    ds_read_b128 v[60:63], v112 offset:8192
    ds_read_b128 v[64:67], v114 offset:0
    ds_read_b128 v[68:71], v114 offset:2048
    ds_read_b128 v[72:75], v114 offset:4096
    ds_read_b128 v[76:79], v114 offset:6144
    ds_read_b128 v[80:83], v114 offset:8192
    ds_read_b128 v[84:87], v113 offset:0
    ds_read_b128 v[88:91], v113 offset:8192
    ds_read_b128 v[92:95], v115 offset:0
    ds_read_b128 v[96:99], v115 offset:2048
    ds_read_b128 v[100:103], v115 offset:4096
    ds_read_b128 v[104:107], v115 offset:6144
    ds_read_b128 v[108:111], v115 offset:8192
    s_mov_b32 s48, s43
    s_add_u32 s43, s43, 36864
    s_cmp_eq_u32 s43, 147456
    s_cselect_b32 s43, 0, s43
    s_sub_u32 s48, s43, s48
    s_add_u32 s41, s41, 1
    v_add_u32 v112, s48, v112
    v_add_u32 v113, s48, v113
    v_add_u32 v114, s48, v114
    v_add_u32 v115, s48, v115
    s_waitcnt lgkmcnt(0)
K1A0_loop:
    s_barrier
    v_mfma_f32_16x16x32_bf16 v[16:19], v[56:59], v[64:67], v[16:19]
    v_mfma_f32_16x16x32_bf16 v[20:23], v[60:63], v[64:67], v[20:23]
    v_mfma_f32_16x16x32_bf16 v[24:27], v[56:59], v[68:71], v[24:27]
    v_mfma_f32_16x16x32_bf16 v[28:31], v[60:63], v[68:71], v[28:31]
    v_mfma_f32_16x16x32_bf16 v[32:35], v[56:59], v[72:75], v[32:35]
    v_mfma_f32_16x16x32_bf16 v[36:39], v[60:63], v[72:75], v[36:39]
    v_mfma_f32_16x16x32_bf16 v[40:43], v[56:59], v[76:79], v[40:43]
    v_mfma_f32_16x16x32_bf16 v[44:47], v[60:63], v[76:79], v[44:47]
    v_mfma_f32_16x16x32_bf16 v[48:51], v[56:59], v[80:83], v[48:51]
    v_mfma_f32_16x16x32_bf16 v[52:55], v[60:63], v[80:83], v[52:55]
    v_mfma_f32_16x16x32_bf16 v[16:19], v[84:87], v[92:95], v[16:19]
    v_mfma_f32_16x16x32_bf16 v[20:23], v[88:91], v[92:95], v[20:23]
    v_mfma_f32_16x16x32_bf16 v[24:27], v[84:87], v[96:99], v[24:27]
    ds_read_b128 v[56:59], v112 offset:0
    v_mfma_f32_16x16x32_bf16 v[28:31], v[88:91], v[96:99], v[28:31]
    ds_read_b128 v[60:63], v112 offset:8192
    v_mfma_f32_16x16x32_bf16 v[32:35], v[84:87], v[100:103], v[32:35]
    ds_read_b128 v[64:67], v114 offset:0
    v_mfma_f32_16x16x32_bf16 v[36:39], v[88:91], v[100:103], v[36:39]
    ds_read_b128 v[68:71], v114 offset:2048
    v_mfma_f32_16x16x32_bf16 v[40:43], v[84:87], v[104:107], v[40:43]
    ds_read_b128 v[72:75], v114 offset:4096
    v_mfma_f32_16x16x32_bf16 v[44:47], v[88:91], v[104:107], v[44:47]
    ds_read_b128 v[76:79], v114 offset:6144
    v_mfma_f32_16x16x32_bf16 v[48:51], v[84:87], v[108:111], v[48:51]
    ds_read_b128 v[80:83], v114 offset:8192
    v_mfma_f32_16x16x32_bf16 v[52:55], v[88:91], v[108:111], v[52:55]
    ds_read_b128 v[84:87], v113 offset:0
    ds_read_b128 v[88:91], v113 offset:8192
    ds_read_b128 v[92:95], v115 offset:0
    ds_read_b128 v[96:99], v115 offset:2048
    ds_read_b128 v[100:103], v115 offset:4096
    ds_read_b128 v[104:107], v115 offset:6144
    ds_read_b128 v[108:111], v115 offset:8192
    s_mov_b32 s48, s43
    s_add_u32 s43, s43, 36864
    s_cmp_eq_u32 s43, 147456
    s_cselect_b32 s43, 0, s43
    s_sub_u32 s48, s43, s48
    s_add_u32 s41, s41, 1
    v_add_u32 v112, s48, v112
    v_add_u32 v113, s48, v113
    v_add_u32 v114, s48, v114
    v_add_u32 v115, s48, v115
    s_cmp_eq_u32 s41, 2
    s_cbranch_scc0 K1A0_nh0
    s_waitcnt vmcnt(0)
K1A0_nh0:
    s_waitcnt lgkmcnt(0)
    s_cmp_lt_u32 s41, 10
    s_cbranch_scc1 K1A0_loop
    v_mfma_f32_16x16x32_bf16 v[16:19], v[56:59], v[64:67], v[16:19]
    v_mfma_f32_16x16x32_bf16 v[20:23], v[60:63], v[64:67], v[20:23]
    v_mfma_f32_16x16x32_bf16 v[24:27], v[56:59], v[68:71], v[24:27]
    v_mfma_f32_16x16x32_bf16 v[28:31], v[60:63], v[68:71], v[28:31]
    v_mfma_f32_16x16x32_bf16 v[32:35], v[56:59], v[72:75], v[32:35]
    v_mfma_f32_16x16x32_bf16 v[36:39], v[60:63], v[72:75], v[36:39]
    v_mfma_f32_16x16x32_bf16 v[40:43], v[56:59], v[76:79], v[40:43]
    v_mfma_f32_16x16x32_bf16 v[44:47], v[60:63], v[76:79], v[44:47]
    v_mfma_f32_16x16x32_bf16 v[48:51], v[56:59], v[80:83], v[48:51]
    v_mfma_f32_16x16x32_bf16 v[52:55], v[60:63], v[80:83], v[52:55]
    v_mfma_f32_16x16x32_bf16 v[16:19], v[84:87], v[92:95], v[16:19]
    v_mfma_f32_16x16x32_bf16 v[20:23], v[88:91], v[92:95], v[20:23]
    v_mfma_f32_16x16x32_bf16 v[24:27], v[84:87], v[96:99], v[24:27]
    v_mfma_f32_16x16x32_bf16 v[28:31], v[88:91], v[96:99], v[28:31]
    v_mfma_f32_16x16x32_bf16 v[32:35], v[84:87], v[100:103], v[32:35]
    v_mfma_f32_16x16x32_bf16 v[36:39], v[88:91], v[100:103], v[36:39]
    v_mfma_f32_16x16x32_bf16 v[40:43], v[84:87], v[104:107], v[40:43]
    v_mfma_f32_16x16x32_bf16 v[44:47], v[88:91], v[104:107], v[44:47]
    v_mfma_f32_16x16x32_bf16 v[48:51], v[84:87], v[108:111], v[48:51]
    v_mfma_f32_16x16x32_bf16 v[52:55], v[88:91], v[108:111], v[52:55]
    s_branch K1A_cd
K1A_c1:
    s_mov_b32 s41, 0
    s_mov_b32 s43, 0
    s_barrier
K1A1_loop:
    s_setprio 1
    ds_read_b128 v[56:59], v112 offset:0
    ds_read_b128 v[60:63], v112 offset:8192
    ds_read_b128 v[64:67], v114 offset:0
    ds_read_b128 v[68:71], v114 offset:2048
    ds_read_b128 v[72:75], v114 offset:4096
    ds_read_b128 v[76:79], v114 offset:6144
    ds_read_b128 v[80:83], v114 offset:8192
    ds_read_b128 v[84:87], v113 offset:0
    ds_read_b128 v[88:91], v113 offset:8192
    ds_read_b128 v[92:95], v115 offset:0
    ds_read_b128 v[96:99], v115 offset:2048
    ds_read_b128 v[100:103], v115 offset:4096
    ds_read_b128 v[104:107], v115 offset:6144
    ds_read_b128 v[108:111], v115 offset:8192
    s_setprio 0
    s_mov_b32 s48, s43
    s_add_u32 s43, s43, 36864
    s_cmp_eq_u32 s43, 147456
    s_cselect_b32 s43, 0, s43
    s_sub_u32 s48, s43, s48
    s_add_u32 s41, s41, 1
    v_add_u32 v112, s48, v112
    v_add_u32 v113, s48, v113
    v_add_u32 v114, s48, v114
    v_add_u32 v115, s48, v115
    s_cmp_eq_u32 s41, 2
    s_cbranch_scc0 K1A1_nh0
    s_waitcnt vmcnt(0)
K1A1_nh0:
    s_waitcnt lgkmcnt(7)
    v_mfma_f32_16x16x32_bf16 v[16:19], v[56:59], v[64:67], v[16:19]
    v_mfma_f32_16x16x32_bf16 v[20:23], v[60:63], v[64:67], v[20:23]
    v_mfma_f32_16x16x32_bf16 v[24:27], v[56:59], v[68:71], v[24:27]
    v_mfma_f32_16x16x32_bf16 v[28:31], v[60:63], v[68:71], v[28:31]
    v_mfma_f32_16x16x32_bf16 v[32:35], v[56:59], v[72:75], v[32:35]
    v_mfma_f32_16x16x32_bf16 v[36:39], v[60:63], v[72:75], v[36:39]
    v_mfma_f32_16x16x32_bf16 v[40:43], v[56:59], v[76:79], v[40:43]
    v_mfma_f32_16x16x32_bf16 v[44:47], v[60:63], v[76:79], v[44:47]
    v_mfma_f32_16x16x32_bf16 v[48:51], v[56:59], v[80:83], v[48:51]
    v_mfma_f32_16x16x32_bf16 v[52:55], v[60:63], v[80:83], v[52:55]
    s_waitcnt lgkmcnt(0)
    v_mfma_f32_16x16x32_bf16 v[16:19], v[84:87], v[92:95], v[16:19]
    v_mfma_f32_16x16x32_bf16 v[20:23], v[88:91], v[92:95], v[20:23]
    v_mfma_f32_16x16x32_bf16 v[24:27], v[84:87], v[96:99], v[24:27]
    v_mfma_f32_16x16x32_bf16 v[28:31], v[88:91], v[96:99], v[28:31]
    v_mfma_f32_16x16x32_bf16 v[32:35], v[84:87], v[100:103], v[32:35]
    v_mfma_f32_16x16x32_bf16 v[36:39], v[88:91], v[100:103], v[36:39]
    v_mfma_f32_16x16x32_bf16 v[40:43], v[84:87], v[104:107], v[40:43]
    v_mfma_f32_16x16x32_bf16 v[44:47], v[88:91], v[104:107], v[44:47]
    v_mfma_f32_16x16x32_bf16 v[48:51], v[84:87], v[108:111], v[48:51]
    v_mfma_f32_16x16x32_bf16 v[52:55], v[88:91], v[108:111], v[52:55]
    s_cmp_lt_u32 s41, 10
    s_cbranch_scc0 K1A1_done
    s_barrier
    s_branch K1A1_loop
K1A1_done:
K1A_cd:
    s_barrier
    s_lshl_b32 s48, s39, 6
    v_lshlrev_b32 v3, 4, v2
    v_add_u32 v3, s48, v3
    v_add_u32 v3, 147456, v3
    ds_read_b128 v[56:59], v3
    ds_read_b128 v[60:63], v3 offset:256
    s_mul_i32 s48, s36, 655360
    s_lshl_b32 s49, s38, 1
    s_add_u32 s49, s49, s40
    s_mul_i32 s49, s49, 163840
    s_add_u32 s48, s48, s49
    s_mul_i32 s49, s37, 10240
    s_add_u32 s48, s48, s49
    s_lshr_b32 s49, s39, 1
    s_mul_i32 s49, s49, 5120
    s_add_u32 s47, s48, s49
    s_add_u32 s50, s6, 0x780000
    s_addc_u32 s51, s7, 0
    s_mov_b32 s24, s50
    s_mov_b32 s25, s51
    s_mov_b32 s26, 0x140000
    s_mov_b32 s27, 0x00020000
    s_and_b32 s48, s39, 1
    s_lshl_b32 s48, s48, 9
    v_lshrrev_b32 v3, 1, v2
    v_lshlrev_b32 v3, 8, v3
    v_lshl_add_u32 v3, v1, 4, v3
    v_and_b32 v4, 1, v2
    v_lshl_add_u32 v3, v4, 3, v3
    v_add_u32 v76, s48, v3
    s_waitcnt lgkmcnt(0)
    s_or_b32 s48, s37, s39
    s_or_b32 s48, s48, s36
    s_cmp_eq_u32 s48, 0
    s_cbranch_scc0 K1A_nosp
    s_add_u32 s50, s6, 0x8c0000
    s_addc_u32 s51, s7, 0
    s_mov_b32 s28, s50
    s_mov_b32 s29, s51
    s_mov_b32 s30, 0x500
    s_mov_b32 s31, 0x00020000
    s_mul_i32 s48, s38, 640
    s_mul_i32 s49, s40, 320
    s_add_u32 s48, s48, s49
    v_lshlrev_b32 v5, 2, v1
    v_cmp_gt_u32 vcc, 16, v0
    s_and_saveexec_b64 s[54:55], vcc
    v_mul_f32 v64, v20, v60
    buffer_store_dword v64, v5, s[28:31], s48 offen offset:0 sc1
    s_nop 0
    v_mul_f32 v64, v28, v60
    buffer_store_dword v64, v5, s[28:31], s48 offen offset:64 sc1
    s_nop 0
    v_mul_f32 v64, v36, v60
    buffer_store_dword v64, v5, s[28:31], s48 offen offset:128 sc1
    s_nop 0
    v_mul_f32 v64, v44, v60
    buffer_store_dword v64, v5, s[28:31], s48 offen offset:192 sc1
    s_nop 0
    v_mul_f32 v64, v52, v60
    buffer_store_dword v64, v5, s[28:31], s48 offen offset:256 sc1
    s_nop 0
    v_mov_b32 v60, 0
    s_mov_b64 exec, s[54:55]
K1A_nosp:
    s_cmp_eq_u32 s36, 0
    s_cselect_b32 s48, 1.0, -1.0
    v_mul_f32 v60, s48, v60
    v_mul_f32 v61, s48, v61
    v_mul_f32 v62, s48, v62
    v_mul_f32 v63, s48, v63
    v_pk_mul_f32 v[66:67], v[20:21], v[60:61]
    v_pk_mul_f32 v[68:69], v[22:23], v[62:63]
    v_pk_fma_f32 v[66:67], v[16:17], v[56:57], v[66:67]
    v_pk_fma_f32 v[68:69], v[18:19], v[58:59], v[68:69]
    v_cvt_pk_bf16_f32 v70, v66, v67
    v_cvt_pk_bf16_f32 v71, v68, v69
    buffer_store_dwordx2 v[70:71], v76, s[24:27], s47 offen offset:0 sc1
    v_pk_mul_f32 v[66:67], v[28:29], v[60:61]
    v_pk_mul_f32 v[68:69], v[30:31], v[62:63]
    v_pk_fma_f32 v[66:67], v[24:25], v[56:57], v[66:67]
    v_pk_fma_f32 v[68:69], v[26:27], v[58:59], v[68:69]
    v_cvt_pk_bf16_f32 v72, v66, v67
    v_cvt_pk_bf16_f32 v73, v68, v69
    buffer_store_dwordx2 v[72:73], v76, s[24:27], s47 offen offset:1024 sc1
    v_pk_mul_f32 v[66:67], v[36:37], v[60:61]
    v_pk_mul_f32 v[68:69], v[38:39], v[62:63]
    v_pk_fma_f32 v[66:67], v[32:33], v[56:57], v[66:67]
    v_pk_fma_f32 v[68:69], v[34:35], v[58:59], v[68:69]
    v_cvt_pk_bf16_f32 v70, v66, v67
    v_cvt_pk_bf16_f32 v71, v68, v69
    buffer_store_dwordx2 v[70:71], v76, s[24:27], s47 offen offset:2048 sc1
    v_pk_mul_f32 v[66:67], v[44:45], v[60:61]
    v_pk_mul_f32 v[68:69], v[46:47], v[62:63]
    v_pk_fma_f32 v[66:67], v[40:41], v[56:57], v[66:67]
    v_pk_fma_f32 v[68:69], v[42:43], v[58:59], v[68:69]
    v_cvt_pk_bf16_f32 v72, v66, v67
    v_cvt_pk_bf16_f32 v73, v68, v69
    buffer_store_dwordx2 v[72:73], v76, s[24:27], s47 offen offset:3072 sc1
    v_pk_mul_f32 v[66:67], v[52:53], v[60:61]
    v_pk_mul_f32 v[68:69], v[54:55], v[62:63]
    v_pk_fma_f32 v[66:67], v[48:49], v[56:57], v[66:67]
    v_pk_fma_f32 v[68:69], v[50:51], v[58:59], v[68:69]
    v_cvt_pk_bf16_f32 v70, v66, v67
    v_cvt_pk_bf16_f32 v71, v68, v69
    s_add_u32 s47, s47, 4096
    buffer_store_dwordx2 v[70:71], v76, s[24:27], s47 offen sc1
    s_branch K1_end
K1A_prod:
    s_sub_u32 s39, s32, 8
    v_lshrrev_b32 v20, 3, v0
    v_and_b32 v22, 7, v0
    v_xor_b32 v22, v22, v20
    v_lshlrev_b32 v22, 4, v22
    s_lshl_b32 s48, s37, 6
    s_cmp_lt_u32 s39, 2
    s_cbranch_scc0 K1Ap_bot
    s_lshl_b32 s49, s39, 5
    s_add_u32 s49, s49, s48
    v_add_u32 v21, s49, v20
    v_add_u32 v21, 0, v21
    v_mul_u32_u24 v21, 1280, v21
    v_add_u32 v2, v21, v22
    v_add_u32 v21, s49, v20
    v_add_u32 v21, 8, v21
    v_mul_u32_u24 v21, 1280, v21
    v_add_u32 v3, v21, v22
    v_add_u32 v21, s49, v20
    v_add_u32 v21, 16, v21
    v_mul_u32_u24 v21, 1280, v21
    v_add_u32 v4, v21, v22
    v_add_u32 v21, s49, v20
    v_add_u32 v21, 24, v21
    v_mul_u32_u24 v21, 1280, v21
    v_add_u32 v5, v21, v22
    s_branch K1Ap_xd
K1Ap_bot:
    s_sub_u32 s49, s39, 2
    s_lshl_b32 s49, s49, 5
    s_add_u32 s49, s49, s48
    s_sub_u32 s49, 2048, s49
    v_sub_u32 v21, s49, v20
    v_subrev_u32 v21, 0, v21
    v_cmp_eq_u32 vcc, 2048, v21
    v_mov_b32 v23, 1024
    s_nop 0
    v_cndmask_b32 v21, v21, v23, vcc
    v_mul_u32_u24 v21, 1280, v21
    v_add_u32 v2, v21, v22
    v_sub_u32 v21, s49, v20
    v_subrev_u32 v21, 8, v21
    v_mul_u32_u24 v21, 1280, v21
    v_add_u32 v3, v21, v22
    v_sub_u32 v21, s49, v20
    v_subrev_u32 v21, 16, v21
    v_mul_u32_u24 v21, 1280, v21
    v_add_u32 v4, v21, v22
    v_sub_u32 v21, s49, v20
    v_subrev_u32 v21, 24, v21
    v_mul_u32_u24 v21, 1280, v21
    v_add_u32 v5, v21, v22
K1Ap_xd:
    s_mul_i32 s48, s39, 40
    v_add_u32 v21, s48, v20
    v_mul_u32_u24 v21, 1280, v21
    v_add_u32 v6, v21, v22
    s_mov_b32 s42, 0
    s_mul_i32 s48, s35, 5
    s_lshr_b32 s48, s48, 1
    s_mul_i32 s49, s36, 4
    s_add_u32 s48, s48, s49
    s_cmp_ge_u32 s48, 10
    s_cselect_b32 s49, 10, 0
    s_sub_u32 s48, s48, s49
    s_lshl_b32 s44, s48, 7
    s_waitcnt lgkmcnt(0)
    s_mov_b32 s16, s4
    s_mov_b32 s17, s5
    s_mov_b32 s18, 0x280000
    s_mov_b32 s19, 0x00020000
    s_cmp_eq_u32 s36, 0
    s_cselect_b32 s50, s8, s10
    s_cselect_b32 s51, s9, s11
    s_mul_i32 s48, s38, 204800
    s_add_u32 s48, s48, 1280
    s_add_u32 s50, s50, s48
    s_addc_u32 s51, s51, 0
    s_mov_b32 s20, s50
    s_mov_b32 s21, s51
    s_mov_b32 s22, 0x32000
    s_mov_b32 s23, 0x00020000
    s_lshl_b32 s46, s39, 12
    s_add_u32 s46, s46, s42
    s_add_u32 m0, s46, 0
    s_nop 0
    buffer_load_dwordx4 v2, s[16:19], s44 offen lds
    s_add_u32 m0, s46, 1024
    s_nop 0
    buffer_load_dwordx4 v3, s[16:19], s44 offen lds
    s_add_u32 m0, s46, 2048
    s_nop 0
    buffer_load_dwordx4 v4, s[16:19], s44 offen lds
    s_add_u32 m0, s46, 3072
    s_nop 0
    buffer_load_dwordx4 v5, s[16:19], s44 offen lds
    s_mul_i32 s46, s39, 5120
    s_add_u32 s46, s46, s42
    s_add_u32 m0, s46, 16384
    s_add_u32 s47, s44, 0
    buffer_load_dwordx4 v6, s[20:23], s47 offen lds
    s_add_u32 m0, s46, 17408
    s_add_u32 s47, s44, 10240
    buffer_load_dwordx4 v6, s[20:23], s47 offen lds
    s_add_u32 m0, s46, 18432
    s_add_u32 s47, s44, 20480
    buffer_load_dwordx4 v6, s[20:23], s47 offen lds
    s_add_u32 m0, s46, 19456
    s_add_u32 s47, s44, 30720
    buffer_load_dwordx4 v6, s[20:23], s47 offen lds
    s_add_u32 m0, s46, 20480
    s_add_u32 s47, s44, 40960
    buffer_load_dwordx4 v6, s[20:23], s47 offen lds
    s_add_u32 s42, s42, 36864
    s_cmp_eq_u32 s42, 147456
    s_cselect_b32 s42, 0, s42
    s_add_u32 s44, s44, 128
    s_cmp_eq_u32 s44, 1280
    s_cselect_b32 s44, 0, s44
    s_lshl_b32 s46, s39, 12
    s_add_u32 s46, s46, s42
    s_add_u32 m0, s46, 0
    s_nop 0
    buffer_load_dwordx4 v2, s[16:19], s44 offen lds
    s_add_u32 m0, s46, 1024
    s_nop 0
    buffer_load_dwordx4 v3, s[16:19], s44 offen lds
    s_add_u32 m0, s46, 2048
    s_nop 0
    buffer_load_dwordx4 v4, s[16:19], s44 offen lds
    s_add_u32 m0, s46, 3072
    s_nop 0
    buffer_load_dwordx4 v5, s[16:19], s44 offen lds
    s_mul_i32 s46, s39, 5120
    s_add_u32 s46, s46, s42
    s_add_u32 m0, s46, 16384
    s_add_u32 s47, s44, 0
    buffer_load_dwordx4 v6, s[20:23], s47 offen lds
    s_add_u32 m0, s46, 17408
    s_add_u32 s47, s44, 10240
    buffer_load_dwordx4 v6, s[20:23], s47 offen lds
    s_add_u32 m0, s46, 18432
    s_add_u32 s47, s44, 20480
    buffer_load_dwordx4 v6, s[20:23], s47 offen lds
    s_add_u32 m0, s46, 19456
    s_add_u32 s47, s44, 30720
    buffer_load_dwordx4 v6, s[20:23], s47 offen lds
    s_add_u32 m0, s46, 20480
    s_add_u32 s47, s44, 40960
    buffer_load_dwordx4 v6, s[20:23], s47 offen lds
    s_add_u32 s42, s42, 36864
    s_cmp_eq_u32 s42, 147456
    s_cselect_b32 s42, 0, s42
    s_add_u32 s44, s44, 128
    s_cmp_eq_u32 s44, 1280
    s_cselect_b32 s44, 0, s44
    s_waitcnt vmcnt(9)
    s_barrier
    s_lshl_b32 s46, s39, 12
    s_add_u32 s46, s46, s42
    s_add_u32 m0, s46, 0
    s_nop 0
    buffer_load_dwordx4 v2, s[16:19], s44 offen lds
    s_add_u32 m0, s46, 1024
    s_nop 0
    buffer_load_dwordx4 v3, s[16:19], s44 offen lds
    s_add_u32 m0, s46, 2048
    s_nop 0
    buffer_load_dwordx4 v4, s[16:19], s44 offen lds
    s_add_u32 m0, s46, 3072
    s_nop 0
    buffer_load_dwordx4 v5, s[16:19], s44 offen lds
    s_mul_i32 s46, s39, 5120
    s_add_u32 s46, s46, s42
    s_add_u32 m0, s46, 16384
    s_add_u32 s47, s44, 0
    buffer_load_dwordx4 v6, s[20:23], s47 offen lds
    s_add_u32 m0, s46, 17408
    s_add_u32 s47, s44, 10240
    buffer_load_dwordx4 v6, s[20:23], s47 offen lds
    s_add_u32 m0, s46, 18432
    s_add_u32 s47, s44, 20480
    buffer_load_dwordx4 v6, s[20:23], s47 offen lds
    s_add_u32 m0, s46, 19456
    s_add_u32 s47, s44, 30720
    buffer_load_dwordx4 v6, s[20:23], s47 offen lds
    s_add_u32 m0, s46, 20480
    s_add_u32 s47, s44, 40960
    buffer_load_dwordx4 v6, s[20:23], s47 offen lds
    s_add_u32 s42, s42, 36864
    s_cmp_eq_u32 s42, 147456
    s_cselect_b32 s42, 0, s42
    s_add_u32 s44, s44, 128
    s_cmp_eq_u32 s44, 1280
    s_cselect_b32 s44, 0, s44
    s_lshl_b32 s46, s39, 12
    s_add_u32 s46, s46, s42
    s_add_u32 m0, s46, 0
    s_nop 0
    buffer_load_dwordx4 v2, s[16:19], s44 offen lds
    s_add_u32 m0, s46, 1024
    s_nop 0
    buffer_load_dwordx4 v3, s[16:19], s44 offen lds
    s_add_u32 m0, s46, 2048
    s_nop 0
    buffer_load_dwordx4 v4, s[16:19], s44 offen lds
    s_add_u32 m0, s46, 3072
    s_nop 0
    buffer_load_dwordx4 v5, s[16:19], s44 offen lds
    s_mul_i32 s46, s39, 5120
    s_add_u32 s46, s46, s42
    s_add_u32 m0, s46, 16384
    s_add_u32 s47, s44, 0
    buffer_load_dwordx4 v6, s[20:23], s47 offen lds
    s_add_u32 m0, s46, 17408
    s_add_u32 s47, s44, 10240
    buffer_load_dwordx4 v6, s[20:23], s47 offen lds
    s_add_u32 m0, s46, 18432
    s_add_u32 s47, s44, 20480
    buffer_load_dwordx4 v6, s[20:23], s47 offen lds
    s_add_u32 m0, s46, 19456
    s_add_u32 s47, s44, 30720
    buffer_load_dwordx4 v6, s[20:23], s47 offen lds
    s_add_u32 m0, s46, 20480
    s_add_u32 s47, s44, 40960
    buffer_load_dwordx4 v6, s[20:23], s47 offen lds
    s_add_u32 s42, s42, 36864
    s_cmp_eq_u32 s42, 147456
    s_cselect_b32 s42, 0, s42
    s_add_u32 s44, s44, 128
    s_cmp_eq_u32 s44, 1280
    s_cselect_b32 s44, 0, s44
    s_mov_b32 s41, 6
K1Ap_loop:
    s_waitcnt vmcnt(18)
    s_barrier
    s_lshl_b32 s46, s39, 12
    s_add_u32 s46, s46, s42
    s_add_u32 m0, s46, 0
    s_nop 0
    buffer_load_dwordx4 v2, s[16:19], s44 offen lds
    s_add_u32 m0, s46, 1024
    s_nop 0
    buffer_load_dwordx4 v3, s[16:19], s44 offen lds
    s_add_u32 m0, s46, 2048
    s_nop 0
    buffer_load_dwordx4 v4, s[16:19], s44 offen lds
    s_add_u32 m0, s46, 3072
    s_nop 0
    buffer_load_dwordx4 v5, s[16:19], s44 offen lds
    s_mul_i32 s46, s39, 5120
    s_add_u32 s46, s46, s42
    s_add_u32 m0, s46, 16384
    s_add_u32 s47, s44, 0
    buffer_load_dwordx4 v6, s[20:23], s47 offen lds
    s_add_u32 m0, s46, 17408
    s_add_u32 s47, s44, 10240
    buffer_load_dwordx4 v6, s[20:23], s47 offen lds
    s_add_u32 m0, s46, 18432
    s_add_u32 s47, s44, 20480
    buffer_load_dwordx4 v6, s[20:23], s47 offen lds
    s_add_u32 m0, s46, 19456
    s_add_u32 s47, s44, 30720
    buffer_load_dwordx4 v6, s[20:23], s47 offen lds
    s_add_u32 m0, s46, 20480
    s_add_u32 s47, s44, 40960
    buffer_load_dwordx4 v6, s[20:23], s47 offen lds
    s_add_u32 s42, s42, 36864
    s_cmp_eq_u32 s42, 147456
    s_cselect_b32 s42, 0, s42
    s_add_u32 s44, s44, 128
    s_cmp_eq_u32 s44, 1280
    s_cselect_b32 s44, 0, s44
    s_sub_u32 s41, s41, 1
    s_cmp_lg_u32 s41, 0
    s_cbranch_scc1 K1Ap_loop
    s_waitcnt vmcnt(18)
    s_barrier
    s_waitcnt vmcnt(9)
    s_barrier
    s_waitcnt vmcnt(0)
    s_barrier
    s_barrier
    s_branch K1_end
K1A_work:
    s_sub_u32 s39, s32, 12
    s_waitcnt lgkmcnt(0)
    s_mov_b32 s60, s14
    s_mov_b32 s61, s15
    s_mov_b32 s62, 0x100
    s_mov_b32 s63, 0x00020000
    s_add_u32 s50, s6, 0x8d0000
    s_addc_u32 s51, s7, 0
    s_mov_b32 s56, s50
    s_mov_b32 s57, s51
    s_mov_b32 s58, 0x30000
    s_mov_b32 s59, 0x00020000
    s_cmp_eq_u32 s39, 0
    s_cbranch_scc0 K1Aw_cf_37
    s_add_u32 s50, s6, 0x8cc000
    s_addc_u32 s51, s7, 0
    s_mov_b32 s24, s50
    s_mov_b32 s25, s51
    s_mov_b32 s26, 0x4000
    s_mov_b32 s27, 0x00020000
    s_lshl_b32 s48, s2, 5
    v_mov_b32 v12, 0
    v_lshlrev_b32 v13, 13, v0
    s_mov_b32 exec_lo, 3
    s_mov_b32 exec_hi, 0
    buffer_store_dword v12, v13, s[24:27], s48 offen sc1
    s_mov_b64 exec, -1
K1Aw_cf_37:
    s_load_dwordx2 s[86:87], s[0:1], 56
    s_load_dwordx4 s[96:99], s[0:1], 8
    s_load_dwordx2 s[88:89], s[0:1], 72
    v_lshrrev_b32 v4, 4, v0
    v_and_b32 v5, 15, v0
    v_lshlrev_b32 v5, 7, v5
    s_lshl_b32 s48, s35, 9
    s_lshl_b32 s49, s34, 4
    s_add_u32 s48, s48, s49
    v_add_u32 v6, s48, v4
    v_lshlrev_b32 v6, 12, v6
    v_add_u32 v6, v6, v5
    s_lshl_b32 s48, s36, 11
    v_add_u32 v6, s48, v6
    s_mul_i32 s48, s35, 288
    s_mul_i32 s49, s34, 9
    s_add_u32 s48, s48, s49
    v_add_u32 v7, s48, v4
    v_lshlrev_b32 v7, 12, v7
    v_add_u32 v7, v7, v5
    v_and_b32 v21, 15, v0
    v_lshlrev_b32 v21, 4, v21
    v_mov_b32 v20, 0
    v_mov_b32 v16, 0
    v_mov_b32 v17, 0
    v_mov_b32 v18, 0
    v_mov_b32 v19, 0
    s_waitcnt lgkmcnt(0)
    s_mov_b32 s20, s86
    s_mov_b32 s21, s87
    s_mov_b32 s22, 0x800000
    s_mov_b32 s23, 0x00020000
    s_cmp_eq_u32 s36, 0
    s_cselect_b32 s50, s96, s98
    s_cselect_b32 s51, s97, s99
    s_mov_b32 s28, s50
    s_mov_b32 s29, s51
    s_mov_b32 s30, 0x800000
    s_mov_b32 s31, 0x00020000
    s_cmp_eq_u32 s39, 2
    s_cbranch_scc0 K1Aw_cp_38
    s_getpc_b64 s[90:91]
K1Aw_pc_39:
    s_sub_u32 s90, s90, K1Aw_pc_39-KSTART
    s_subb_u32 s91, s91, 0
    s_mov_b32 s24, s90
    s_mov_b32 s25, s91
    s_mov_b32 s26, KEND-KSTART
    s_mov_b32 s27, 0x00020000
    s_lshl_b32 s47, s34, 11
    v_lshlrev_b32 v11, 7, v0
    s_mov_b32 exec_hi, 0
    s_mov_b32 exec_lo, 0xffff
    buffer_load_dword v10, v11, s[24:27], s47 offen
    s_mov_b64 exec, -1
K1Aw_cp_38:
    s_cmp_eq_u32 s39, 3
    s_cbranch_scc0 K1Aw_e3_40
    s_mov_b32 s24, s12
    s_mov_b32 s25, s13
    s_mov_b32 s26, 0x21c000
    s_mov_b32 s27, 0x00020000
    s_mul_i32 s47, s2, 8704
    v_lshlrev_b32 v11, 7, v0
    buffer_load_dword v10, v11, s[24:27], s47 offen
    s_add_u32 s47, s47, 8192
    s_mov_b32 exec_hi, 0
    s_mov_b32 exec_lo, 15
    buffer_load_dword v10, v11, s[24:27], s47 offen
    s_mov_b64 exec, -1
K1Aw_e3_40:
    s_cmp_eq_u32 s39, 2
    s_cbranch_scc0 K1Aw_e2_41
    s_cmp_lt_u32 s2, 128
    s_cselect_b32 s50, s8, s10
    s_cselect_b32 s51, s9, s11
    s_mov_b32 s24, s50
    s_mov_b32 s25, s51
    s_mov_b32 s26, 0x64500
    s_mov_b32 s27, 0x00020000
    s_and_b32 s47, s2, 127
    s_mul_i32 s47, s47, 3200
    s_add_u32 s47, s47, 1280
    v_lshlrev_b32 v11, 7, v0
    s_mov_b32 exec_hi, 0
    s_mov_b32 exec_lo, 0x1ffffff
    buffer_load_dword v10, v11, s[24:27], s47 offen
    s_mov_b64 exec, -1
K1Aw_e2_41:
    s_mov_b32 s43, 0
    s_barrier
    s_barrier
    s_barrier
    s_cmp_eq_u32 s39, 1
    s_cbranch_scc0 K1Aw_p_42
K1Aw_p_42:
    s_cmp_eq_u32 s39, 0
    s_cbranch_scc0 K1Aw_a_43
    s_waitcnt vmcnt(0)
    v_mov_b32 v4, 1
    s_and_b32 s48, s2, 15
    s_lshl_b32 s48, s48, 4
    v_mov_b32 v3, s48
    v_cmp_eq_u32 vcc, 0, v0
    s_and_saveexec_b64 s[54:55], vcc
    buffer_atomic_add v4, v3, s[60:63], 0 offen sc1
    s_mov_b64 exec, s[54:55]
K1Aw_a_43:
    s_barrier
    s_cmp_eq_u32 s39, 1
    s_cbranch_scc0 K1Aw_p_44
K1Aw_p_44:
    s_barrier
    s_cmp_eq_u32 s39, 1
    s_cbranch_scc0 K1Aw_p_45
K1Aw_p_45:
    s_barrier
    s_cmp_eq_u32 s39, 1
    s_cbranch_scc0 K1Aw_p_46
K1Aw_p_46:
    s_cmp_eq_u32 s39, 0
    s_cbranch_scc0 K1Aw_q_47
    buffer_load_dword v20, v21, s[60:63], 0 offen sc1
K1Aw_q_47:
    s_barrier
    s_cmp_eq_u32 s39, 1
    s_cbranch_scc0 K1Aw_p_48
    s_mov_b32 s47, 0
    buffer_load_dword v10, v7, s[28:31], s47 offen
K1Aw_p_48:
    s_barrier
    s_cmp_eq_u32 s39, 1
    s_cbranch_scc0 K1Aw_p_49
    s_mov_b32 s47, 16384
    buffer_load_dword v10, v7, s[28:31], s47 offen
K1Aw_p_49:
    s_cmp_eq_u32 s39, 0
    s_cbranch_scc0 K1Aw_r_50
    s_mov_b32 s52, 0
K1Aw_pl_51:
    s_waitcnt vmcnt(0)
    v_cmp_gt_u32 vcc, 16, v20
    s_nop 1
    s_cmp_eq_u64 vcc, 0
    s_cbranch_scc1 K1Aw_ok_52
    buffer_load_dword v20, v21, s[60:63], 0 offen sc1
    s_add_u32 s52, s52, 1
    s_cmp_lt_u32 s52, 4000
    s_cbranch_scc1 K1Aw_pl_51
K1Aw_ok_52:
    s_add_u32 s50, s6, 0x8c8000
    s_addc_u32 s51, s7, 0
    s_mov_b32 s24, s50
    s_mov_b32 s25, s51
    s_mov_b32 s26, 0x4000
    s_mov_b32 s27, 0x00020000
    s_lshl_b32 s48, s37, 6
    v_add_u32 v22, s48, v0
    v_sub_u32 v23, 2048, v22
    v_cmp_eq_u32 vcc, 2048, v23
    v_mov_b32 v24, 1024
    s_nop 0
    v_cndmask_b32 v23, v23, v24, vcc
    v_lshlrev_b32 v22, 3, v22
    v_lshlrev_b32 v23, 3, v23
    buffer_load_dwordx2 v[16:17], v22, s[24:27], 0 offen sc1
    buffer_load_dwordx2 v[18:19], v23, s[24:27], 0 offen sc1
K1Aw_r_50:
    s_barrier
    s_cmp_eq_u32 s39, 1
    s_cbranch_scc0 K1Aw_p_53
    s_mov_b32 s47, 32768
    s_mov_b32 exec_hi, 0
    s_mov_b32 exec_lo, 0xffff
    buffer_load_dword v10, v7, s[28:31], s47 offen
    s_mov_b64 exec, -1
K1Aw_p_53:
    s_cmp_eq_u32 s39, 2
    s_cbranch_scc0 K1Aw_wo_54
    s_mov_b32 s24, s88
    s_mov_b32 s25, s89
    s_mov_b32 s26, 0x10e000
    s_mov_b32 s27, 0x00020000
    s_mul_i32 s47, s2, 4352
    v_lshlrev_b32 v11, 7, v0
    s_mov_b32 exec_hi, 3
    buffer_load_dword v10, v11, s[24:27], s47 offen
    s_mov_b32 exec_hi, -1
K1Aw_wo_54:
    s_barrier
    s_cmp_eq_u32 s39, 0
    s_cbranch_scc0 K1Aw_w_55
    s_waitcnt vmcnt(0)
    v_lshlrev_b32 v26, 2, v0
    v_add_u32 v26, 147456, v26
    ds_write_b32 v26, v16
    ds_write_b32 v26, v17 offset:512
    ds_write_b32 v26, v18 offset:256
    ds_write_b32 v26, v19 offset:768
K1Aw_w_55:
    s_waitcnt lgkmcnt(0)
    s_barrier
    s_cmp_eq_u32 s39, 1
    s_cbranch_scc0 K1Aw_pl8_56
    s_mov_b32 s47, 0
    buffer_load_dword v10, v6, s[20:23], s47 offen
    s_mov_b32 s47, 16384
    buffer_load_dword v10, v6, s[20:23], s47 offen
    s_mov_b32 s47, 32768
    buffer_load_dword v10, v6, s[20:23], s47 offen
    s_mov_b32 s47, 49152
    buffer_load_dword v10, v6, s[20:23], s47 offen
K1Aw_pl8_56:
K1_end:
    s_cmp_ge_u32 s32, 12
    s_cbranch_scc1 K1_nw
    s_waitcnt vmcnt(0)
K1_nw:
    s_waitcnt lgkmcnt(0)
    s_barrier
    s_cmp_eq_u32 s32, 0
    s_cbranch_scc0 K1_fl
    s_add_u32 s88, s6, 0x8cc000
    s_addc_u32 s89, s7, 0
    s_mov_b32 s92, s88
    s_mov_b32 s93, s89
    s_mov_b32 s94, 0x2000
    s_mov_b32 s95, 0x00020000
    s_lshl_b32 s88, s2, 5
    v_mov_b32 v2, 1
    v_mov_b32 v3, 0
    s_mov_b32 exec_lo, 1
    s_mov_b32 exec_hi, 0
    buffer_store_dword v2, v3, s[92:95], s88 offen sc1
    s_mov_b64 exec, -1
K1_fl:
    s_setprio 0
K2_entry:
    s_load_dwordx4 s[8:11], s[0:1], 8
    s_load_dwordx2 s[4:5], s[0:1], 56
    s_load_dwordx2 s[12:13], s[0:1], 64
    s_load_dwordx2 s[6:7], s[0:1], 96
    s_load_dwordx2 s[14:15], s[0:1], 72
    s_and_b32 s33, s2, 7
    s_lshr_b32 s34, s2, 3
    s_and_b32 s36, s33, 1
    s_cmp_ge_u32 s34, 24
    s_cbranch_scc1 K2T_entry
    s_mul_i32 s48, s34, 43
    s_lshr_b32 s48, s48, 8
    s_mul_i32 s49, s48, 6
    s_sub_u32 s38, s34, s49
    s_lshr_b32 s49, s33, 1
    s_lshl_b32 s49, s49, 2
    s_add_u32 s37, s49, s48
    s_cmp_ge_u32 s32, 8
    s_cbranch_scc1 K2G_prod
    s_and_b32 s39, s32, 3
    s_lshr_b32 s40, s32, 2
    v_and_b32 v6, 15, v0
    v_lshrrev_b32 v7, 4, v0
    v_and_b32 v8, 7, v0
    v_xor_b32 v8, v8, v7
    v_lshlrev_b32 v8, 4, v8
    v_lshl_add_u32 v8, v6, 7, v8
    s_lshl_b32 s48, s39, 12
    v_add_u32 v112, s48, v8
    v_xor_b32 v113, 64, v112
    s_mul_i32 s48, s40, 5120
    s_add_u32 s48, s48, 16384
    v_lshlrev_b32 v14, 4, v0
    v_add_u32 v114, s48, v14
    v_mov_b32 v16, 0
    v_mov_b32 v17, 0
    v_mov_b32 v18, 0
    v_mov_b32 v19, 0
    v_mov_b32 v20, 0
    v_mov_b32 v21, 0
    v_mov_b32 v22, 0
    v_mov_b32 v23, 0
    v_mov_b32 v24, 0
    v_mov_b32 v25, 0
    v_mov_b32 v26, 0
    v_mov_b32 v27, 0
    v_mov_b32 v28, 0
    v_mov_b32 v29, 0
    v_mov_b32 v30, 0
    v_mov_b32 v31, 0
    v_mov_b32 v32, 0
    v_mov_b32 v33, 0
    v_mov_b32 v34, 0
    v_mov_b32 v35, 0
    v_mov_b32 v36, 0
    v_mov_b32 v37, 0
    v_mov_b32 v38, 0
    v_mov_b32 v39, 0
    v_mov_b32 v40, 0
    v_mov_b32 v41, 0
    v_mov_b32 v42, 0
    v_mov_b32 v43, 0
    v_mov_b32 v44, 0
    v_mov_b32 v45, 0
    v_mov_b32 v46, 0
    v_mov_b32 v47, 0
    v_mov_b32 v48, 0
    v_mov_b32 v49, 0
    v_mov_b32 v50, 0
    v_mov_b32 v51, 0
    v_mov_b32 v52, 0
    v_mov_b32 v53, 0
    v_mov_b32 v54, 0
    v_mov_b32 v55, 0
    s_mul_i32 s48, s37, 6
    s_add_u32 s48, s48, s38
    s_lshl_b32 s48, s48, 3
    s_add_u32 s48, s48, s32
    s_mul_i32 s47, s48, 5120
    s_lshl_b32 s48, s37, 7
    s_lshl_b32 s49, s39, 5
    s_add_u32 s48, s48, s49
    v_add_u32 v15, s48, v6
    v_lshlrev_b32 v15, 1, v15
    s_waitcnt lgkmcnt(0)
    s_add_u32 s50, s6, 0x380000
    s_addc_u32 s51, s7, 0
    s_mov_b32 s56, s50
    s_mov_b32 s57, s51
    s_mov_b32 s58, 0x3c0000
    s_mov_b32 s59, 0x00020000
    s_mov_b32 s28, s12
    s_mov_b32 s29, s13
    s_mov_b32 s30, 0x1000
    s_mov_b32 s31, 0x00020000
    v_mov_b32 v6, 0x7fffff00
    s_cmp_eq_u32 s40, 0
    s_cbranch_scc0 K2Gc_1
K2Gc_0:
    s_mov_b32 s41, 0
    s_mov_b32 s43, 0
    s_barrier
    s_barrier
    ds_read_b128 v[56:59], v112 offset:0
    ds_read_b128 v[60:63], v112 offset:2048
    ds_read_b128 v[64:67], v114 offset:0
    ds_read_b128 v[68:71], v114 offset:1024
    ds_read_b128 v[72:75], v114 offset:2048
    ds_read_b128 v[76:79], v114 offset:3072
    ds_read_b128 v[80:83], v114 offset:4096
    ds_read_b128 v[84:87], v113 offset:0
    ds_read_b128 v[88:91], v113 offset:2048
    ds_read_b128 v[92:95], v114 offset:9216
    ds_read_b128 v[96:99], v114 offset:10240
    ds_read_b128 v[100:103], v114 offset:11264
    ds_read_b128 v[104:107], v114 offset:12288
    ds_read_b128 v[108:111], v114 offset:13312
    s_mov_b32 s48, s43
    s_add_u32 s43, s43, 34816
    s_cmp_eq_u32 s43, 139264
    s_cselect_b32 s43, 0, s43
    s_sub_u32 s48, s43, s48
    s_add_u32 s41, s41, 1
    v_add_u32 v112, s48, v112
    v_add_u32 v113, s48, v113
    v_add_u32 v114, s48, v114
    s_waitcnt lgkmcnt(0)
K2Gc_0L_loop:
    s_barrier
    v_mfma_f32_16x16x32_bf16 v[16:19], v[64:67], v[56:59], v[16:19]
    v_mfma_f32_16x16x32_bf16 v[20:23], v[64:67], v[60:63], v[20:23]
    v_mfma_f32_16x16x32_bf16 v[24:27], v[68:71], v[56:59], v[24:27]
    v_mfma_f32_16x16x32_bf16 v[28:31], v[68:71], v[60:63], v[28:31]
    v_mfma_f32_16x16x32_bf16 v[32:35], v[72:75], v[56:59], v[32:35]
    v_mfma_f32_16x16x32_bf16 v[36:39], v[72:75], v[60:63], v[36:39]
    v_mfma_f32_16x16x32_bf16 v[40:43], v[76:79], v[56:59], v[40:43]
    v_mfma_f32_16x16x32_bf16 v[44:47], v[76:79], v[60:63], v[44:47]
    v_mfma_f32_16x16x32_bf16 v[48:51], v[80:83], v[56:59], v[48:51]
    v_mfma_f32_16x16x32_bf16 v[52:55], v[80:83], v[60:63], v[52:55]
    v_mfma_f32_16x16x32_bf16 v[16:19], v[92:95], v[84:87], v[16:19]
    v_mfma_f32_16x16x32_bf16 v[20:23], v[92:95], v[88:91], v[20:23]
    v_mfma_f32_16x16x32_bf16 v[24:27], v[96:99], v[84:87], v[24:27]
    ds_read_b128 v[56:59], v112 offset:0
    v_mfma_f32_16x16x32_bf16 v[28:31], v[96:99], v[88:91], v[28:31]
    ds_read_b128 v[60:63], v112 offset:2048
    v_mfma_f32_16x16x32_bf16 v[32:35], v[100:103], v[84:87], v[32:35]
    ds_read_b128 v[64:67], v114 offset:0
    v_mfma_f32_16x16x32_bf16 v[36:39], v[100:103], v[88:91], v[36:39]
    ds_read_b128 v[68:71], v114 offset:1024
    v_mfma_f32_16x16x32_bf16 v[40:43], v[104:107], v[84:87], v[40:43]
    ds_read_b128 v[72:75], v114 offset:2048
    v_mfma_f32_16x16x32_bf16 v[44:47], v[104:107], v[88:91], v[44:47]
    ds_read_b128 v[76:79], v114 offset:3072
    v_mfma_f32_16x16x32_bf16 v[48:51], v[108:111], v[84:87], v[48:51]
    ds_read_b128 v[80:83], v114 offset:4096
    v_mfma_f32_16x16x32_bf16 v[52:55], v[108:111], v[88:91], v[52:55]
    ds_read_b128 v[84:87], v113 offset:0
    ds_read_b128 v[88:91], v113 offset:2048
    ds_read_b128 v[92:95], v114 offset:9216
    ds_read_b128 v[96:99], v114 offset:10240
    ds_read_b128 v[100:103], v114 offset:11264
    ds_read_b128 v[104:107], v114 offset:12288
    ds_read_b128 v[108:111], v114 offset:13312
    s_mov_b32 s48, s43
    s_add_u32 s43, s43, 34816
    s_cmp_eq_u32 s43, 139264
    s_cselect_b32 s43, 0, s43
    s_sub_u32 s48, s43, s48
    s_add_u32 s41, s41, 1
    v_add_u32 v112, s48, v112
    v_add_u32 v113, s48, v113
    v_add_u32 v114, s48, v114
    s_cmp_eq_u32 s41, 12
    s_cbranch_scc0 K2Gc_0L_nh0
    buffer_load_dwordx4 v[2:5], v14, s[56:59], s47 offen offset:0 sc1
    buffer_load_dwordx4 v[6:9], v14, s[56:59], s47 offen offset:1024 sc1
    buffer_load_dwordx4 v[10:13], v14, s[56:59], s47 offen offset:2048 sc1
    buffer_load_dwordx4 v[116:119], v14, s[56:59], s47 offen offset:3072 sc1
    s_add_u32 s47, s47, 4096
    buffer_load_dwordx4 v[120:123], v14, s[56:59], s47 offen sc1
    buffer_load_ushort v124, v15, s[28:31], 0 offen
    buffer_load_ushort v125, v15, s[28:31], 0 offen offset:32
K2Gc_0L_nh0:
    s_waitcnt lgkmcnt(0)
    s_cmp_lt_u32 s41, 16
    s_cbranch_scc1 K2Gc_0L_loop
    v_mfma_f32_16x16x32_bf16 v[16:19], v[64:67], v[56:59], v[16:19]
    v_mfma_f32_16x16x32_bf16 v[20:23], v[64:67], v[60:63], v[20:23]
    v_mfma_f32_16x16x32_bf16 v[24:27], v[68:71], v[56:59], v[24:27]
    v_mfma_f32_16x16x32_bf16 v[28:31], v[68:71], v[60:63], v[28:31]
    v_mfma_f32_16x16x32_bf16 v[32:35], v[72:75], v[56:59], v[32:35]
    v_mfma_f32_16x16x32_bf16 v[36:39], v[72:75], v[60:63], v[36:39]
    v_mfma_f32_16x16x32_bf16 v[40:43], v[76:79], v[56:59], v[40:43]
    v_mfma_f32_16x16x32_bf16 v[44:47], v[76:79], v[60:63], v[44:47]
    v_mfma_f32_16x16x32_bf16 v[48:51], v[80:83], v[56:59], v[48:51]
    v_mfma_f32_16x16x32_bf16 v[52:55], v[80:83], v[60:63], v[52:55]
    v_mfma_f32_16x16x32_bf16 v[16:19], v[92:95], v[84:87], v[16:19]
    v_mfma_f32_16x16x32_bf16 v[20:23], v[92:95], v[88:91], v[20:23]
    v_mfma_f32_16x16x32_bf16 v[24:27], v[96:99], v[84:87], v[24:27]
    v_mfma_f32_16x16x32_bf16 v[28:31], v[96:99], v[88:91], v[28:31]
    v_mfma_f32_16x16x32_bf16 v[32:35], v[100:103], v[84:87], v[32:35]
    v_mfma_f32_16x16x32_bf16 v[36:39], v[100:103], v[88:91], v[36:39]
    v_mfma_f32_16x16x32_bf16 v[40:43], v[104:107], v[84:87], v[40:43]
    v_mfma_f32_16x16x32_bf16 v[44:47], v[104:107], v[88:91], v[44:47]
    v_mfma_f32_16x16x32_bf16 v[48:51], v[108:111], v[84:87], v[48:51]
    v_mfma_f32_16x16x32_bf16 v[52:55], v[108:111], v[88:91], v[52:55]
    s_barrier
    s_waitcnt vmcnt(0)
    s_cmp_eq_u32 s36, 0
    s_cselect_b32 s48, 1.0, 0
    v_lshlrev_b32 v124, 16, v124
    v_lshlrev_b32 v125, 16, v125
    v_mul_f32 v124, s48, v124
    v_mul_f32 v125, s48, v125
    s_mul_i32 s48, s36, 3538944
    s_add_u32 s50, s6, 0x900000
    s_addc_u32 s51, s7, 0
    s_add_u32 s50, s50, s48
    s_addc_u32 s51, s51, 0
    s_mov_b32 s24, s50
    s_mov_b32 s25, s51
    s_mov_b32 s26, 0x360000
    s_mov_b32 s27, 0x00020000
    s_lshl_b32 s48, s37, 3
    s_lshl_b32 s49, s39, 1
    s_add_u32 s48, s48, s49
    s_mul_i32 s48, s48, 27648
    s_mul_i32 s49, s38, 9
    s_add_u32 s49, s49, 0
    s_lshl_b32 s49, s49, 9
    s_add_u32 s47, s48, s49
    s_add_u32 s52, s47, 27648
    v_lshlrev_b32 v14, 3, v0
    v_lshlrev_b32 v56, 16, v2
    v_and_b32 v57, 0xffff0000, v2
    v_lshlrev_b32 v58, 16, v3
    v_and_b32 v59, 0xffff0000, v3
    v_lshlrev_b32 v60, 16, v4
    v_and_b32 v61, 0xffff0000, v4
    v_lshlrev_b32 v62, 16, v5
    v_and_b32 v63, 0xffff0000, v5
    v_pk_add_f32 v[16:17], v[16:17], v[124:125] op_sel:[0,0] op_sel_hi:[1,0]
    v_pk_add_f32 v[18:19], v[18:19], v[124:125] op_sel:[0,0] op_sel_hi:[1,0]
    v_pk_add_f32 v[20:21], v[20:21], v[124:125] op_sel:[0,1] op_sel_hi:[1,1]
    v_pk_add_f32 v[22:23], v[22:23], v[124:125] op_sel:[0,1] op_sel_hi:[1,1]
    v_pk_mul_f32 v[16:17], v[16:17], v[56:57]
    v_pk_mul_f32 v[18:19], v[18:19], v[58:59]
    v_pk_mul_f32 v[20:21], v[20:21], v[60:61]
    v_pk_mul_f32 v[22:23], v[22:23], v[62:63]
    v_cvt_pk_bf16_f32 v64, v16, v17
    v_cvt_pk_bf16_f32 v65, v18, v19
    v_cvt_pk_bf16_f32 v66, v20, v21
    v_cvt_pk_bf16_f32 v67, v22, v23
    buffer_store_dwordx2 v[64:65], v14, s[24:27], s47 offen offset:0 sc1
    buffer_store_dwordx2 v[66:67], v14, s[24:27], s52 offen offset:0 sc1
    v_lshlrev_b32 v56, 16, v6
    v_and_b32 v57, 0xffff0000, v6
    v_lshlrev_b32 v58, 16, v7
    v_and_b32 v59, 0xffff0000, v7
    v_lshlrev_b32 v60, 16, v8
    v_and_b32 v61, 0xffff0000, v8
    v_lshlrev_b32 v62, 16, v9
    v_and_b32 v63, 0xffff0000, v9
    v_pk_add_f32 v[24:25], v[24:25], v[124:125] op_sel:[0,0] op_sel_hi:[1,0]
    v_pk_add_f32 v[26:27], v[26:27], v[124:125] op_sel:[0,0] op_sel_hi:[1,0]
    v_pk_add_f32 v[28:29], v[28:29], v[124:125] op_sel:[0,1] op_sel_hi:[1,1]
    v_pk_add_f32 v[30:31], v[30:31], v[124:125] op_sel:[0,1] op_sel_hi:[1,1]
    v_pk_mul_f32 v[24:25], v[24:25], v[56:57]
    v_pk_mul_f32 v[26:27], v[26:27], v[58:59]
    v_pk_mul_f32 v[28:29], v[28:29], v[60:61]
    v_pk_mul_f32 v[30:31], v[30:31], v[62:63]
    v_cvt_pk_bf16_f32 v68, v24, v25
    v_cvt_pk_bf16_f32 v69, v26, v27
    v_cvt_pk_bf16_f32 v70, v28, v29
    v_cvt_pk_bf16_f32 v71, v30, v31
    buffer_store_dwordx2 v[68:69], v14, s[24:27], s47 offen offset:512 sc1
    buffer_store_dwordx2 v[70:71], v14, s[24:27], s52 offen offset:512 sc1
    v_lshlrev_b32 v56, 16, v10
    v_and_b32 v57, 0xffff0000, v10
    v_lshlrev_b32 v58, 16, v11
    v_and_b32 v59, 0xffff0000, v11
    v_lshlrev_b32 v60, 16, v12
    v_and_b32 v61, 0xffff0000, v12
    v_lshlrev_b32 v62, 16, v13
    v_and_b32 v63, 0xffff0000, v13
    v_pk_add_f32 v[32:33], v[32:33], v[124:125] op_sel:[0,0] op_sel_hi:[1,0]
    v_pk_add_f32 v[34:35], v[34:35], v[124:125] op_sel:[0,0] op_sel_hi:[1,0]
    v_pk_add_f32 v[36:37], v[36:37], v[124:125] op_sel:[0,1] op_sel_hi:[1,1]
    v_pk_add_f32 v[38:39], v[38:39], v[124:125] op_sel:[0,1] op_sel_hi:[1,1]
    v_pk_mul_f32 v[32:33], v[32:33], v[56:57]
    v_pk_mul_f32 v[34:35], v[34:35], v[58:59]
    v_pk_mul_f32 v[36:37], v[36:37], v[60:61]
    v_pk_mul_f32 v[38:39], v[38:39], v[62:63]
    v_cvt_pk_bf16_f32 v64, v32, v33
    v_cvt_pk_bf16_f32 v65, v34, v35
    v_cvt_pk_bf16_f32 v66, v36, v37
    v_cvt_pk_bf16_f32 v67, v38, v39
    buffer_store_dwordx2 v[64:65], v14, s[24:27], s47 offen offset:1024 sc1
    buffer_store_dwordx2 v[66:67], v14, s[24:27], s52 offen offset:1024 sc1
    v_lshlrev_b32 v56, 16, v116
    v_and_b32 v57, 0xffff0000, v116
    v_lshlrev_b32 v58, 16, v117
    v_and_b32 v59, 0xffff0000, v117
    v_lshlrev_b32 v60, 16, v118
    v_and_b32 v61, 0xffff0000, v118
    v_lshlrev_b32 v62, 16, v119
    v_and_b32 v63, 0xffff0000, v119
    v_pk_add_f32 v[40:41], v[40:41], v[124:125] op_sel:[0,0] op_sel_hi:[1,0]
    v_pk_add_f32 v[42:43], v[42:43], v[124:125] op_sel:[0,0] op_sel_hi:[1,0]
    v_pk_add_f32 v[44:45], v[44:45], v[124:125] op_sel:[0,1] op_sel_hi:[1,1]
    v_pk_add_f32 v[46:47], v[46:47], v[124:125] op_sel:[0,1] op_sel_hi:[1,1]
    v_pk_mul_f32 v[40:41], v[40:41], v[56:57]
    v_pk_mul_f32 v[42:43], v[42:43], v[58:59]
    v_pk_mul_f32 v[44:45], v[44:45], v[60:61]
    v_pk_mul_f32 v[46:47], v[46:47], v[62:63]
    v_cvt_pk_bf16_f32 v68, v40, v41
    v_cvt_pk_bf16_f32 v69, v42, v43
    v_cvt_pk_bf16_f32 v70, v44, v45
    v_cvt_pk_bf16_f32 v71, v46, v47
    buffer_store_dwordx2 v[68:69], v14, s[24:27], s47 offen offset:1536 sc1
    buffer_store_dwordx2 v[70:71], v14, s[24:27], s52 offen offset:1536 sc1
    v_lshlrev_b32 v56, 16, v120
    v_and_b32 v57, 0xffff0000, v120
    v_lshlrev_b32 v58, 16, v121
    v_and_b32 v59, 0xffff0000, v121
    v_lshlrev_b32 v60, 16, v122
    v_and_b32 v61, 0xffff0000, v122
    v_lshlrev_b32 v62, 16, v123
    v_and_b32 v63, 0xffff0000, v123
    v_pk_add_f32 v[48:49], v[48:49], v[124:125] op_sel:[0,0] op_sel_hi:[1,0]
    v_pk_add_f32 v[50:51], v[50:51], v[124:125] op_sel:[0,0] op_sel_hi:[1,0]
    v_pk_add_f32 v[52:53], v[52:53], v[124:125] op_sel:[0,1] op_sel_hi:[1,1]
    v_pk_add_f32 v[54:55], v[54:55], v[124:125] op_sel:[0,1] op_sel_hi:[1,1]
    v_pk_mul_f32 v[48:49], v[48:49], v[56:57]
    v_pk_mul_f32 v[50:51], v[50:51], v[58:59]
    v_pk_mul_f32 v[52:53], v[52:53], v[60:61]
    v_pk_mul_f32 v[54:55], v[54:55], v[62:63]
    v_cvt_pk_bf16_f32 v64, v48, v49
    v_cvt_pk_bf16_f32 v65, v50, v51
    v_cvt_pk_bf16_f32 v66, v52, v53
    v_cvt_pk_bf16_f32 v67, v54, v55
    buffer_store_dwordx2 v[64:65], v14, s[24:27], s47 offen offset:2048 sc1
    buffer_store_dwordx2 v[66:67], v14, s[24:27], s52 offen offset:2048 sc1
    s_branch K2_end
K2Gc_1:
    s_mov_b32 s41, 0
    s_mov_b32 s43, 0
    s_barrier
    s_barrier
K2Gc_1L_loop:
    s_setprio 1
    ds_read_b128 v[56:59], v112 offset:0
    ds_read_b128 v[60:63], v112 offset:2048
    ds_read_b128 v[64:67], v114 offset:0
    ds_read_b128 v[68:71], v114 offset:1024
    ds_read_b128 v[72:75], v114 offset:2048
    ds_read_b128 v[76:79], v114 offset:3072
    ds_read_b128 v[84:87], v113 offset:0
    ds_read_b128 v[88:91], v113 offset:2048
    ds_read_b128 v[92:95], v114 offset:9216
    ds_read_b128 v[96:99], v114 offset:10240
    ds_read_b128 v[100:103], v114 offset:11264
    ds_read_b128 v[104:107], v114 offset:12288
    s_setprio 0
    s_mov_b32 s48, s43
    s_add_u32 s43, s43, 34816
    s_cmp_eq_u32 s43, 139264
    s_cselect_b32 s43, 0, s43
    s_sub_u32 s48, s43, s48
    s_add_u32 s41, s41, 1
    v_add_u32 v112, s48, v112
    v_add_u32 v113, s48, v113
    v_add_u32 v114, s48, v114
    s_cmp_eq_u32 s41, 3
    s_cbranch_scc0 K2Gc_1L_nh0
    s_cmp_eq_u32 s32, 4
    s_cbranch_scc0 K2G_sp_57
    s_add_u32 s88, s6, 0x8cc000
    s_addc_u32 s89, s7, 0
    s_mov_b32 s92, s88
    s_mov_b32 s93, s89
    s_mov_b32 s94, 0x2000
    s_mov_b32 s95, 0x00020000
    s_cmp_eq_u32 s36, 0
    s_cselect_b32 s88, 6, 8
    v_lshrrev_b32 v6, 1, v0
    v_add_u32 v6, s88, v6
    v_sub_u32 v7, 15, v6
    v_cmp_gt_u32 vcc, 8, v6
    v_and_b32 v8, 1, v6
    s_nop 0
    v_cndmask_b32 v7, v7, v6, vcc
    v_lshrrev_b32 v7, 1, v7
    v_cndmask_b32_e64 v5, 2, 0, vcc
    v_add_u32 v8, v8, v5
    s_cmp_ge_u32 s38, 3
    s_cselect_b32 s89, 1, 0
    s_cselect_b32 s90, 3, 0
    s_sub_u32 s90, s38, s90
    s_lshl_b32 s90, s90, 1
    v_mul_u32_u24 v8, 6, v8
    v_and_b32 v5, 1, v0
    v_add_u32 v8, v8, v5
    v_add_u32 v8, s90, v8
    v_lshlrev_b32 v7, 1, v7
    v_add_u32 v7, s89, v7
    v_lshl_add_u32 v6, v8, 3, v7
    v_lshlrev_b32 v6, 5, v6
    v_mov_b32 v9, 0x7fffff00
    v_cmp_gt_u32 vcc, 4, v0
    s_nop 1
    v_cndmask_b32 v6, v9, v6, vcc
    v_cndmask_b32_e64 v5, 1, 0, vcc
    buffer_load_dword v3, v6, s[92:95], 0 offen sc1
K2G_sp_57:
K2Gc_1L_nh0:
    s_cmp_eq_u32 s41, 5
    s_cbranch_scc0 K2Gc_1L_nh1
    s_cmp_eq_u32 s32, 4
    s_cbranch_scc0 K2G_sp_59
    s_add_u32 s88, s6, 0x8cc000
    s_addc_u32 s89, s7, 0
    s_mov_b32 s92, s88
    s_mov_b32 s93, s89
    s_mov_b32 s94, 0x2000
    s_mov_b32 s95, 0x00020000
    s_mov_b32 s90, 0
K2G_spp_60_lp:
    s_waitcnt vmcnt(0)
    v_or_b32 v3, v3, v5
    v_cmp_ne_u32 vcc, 1, v3
    s_nop 1
    s_cmp_eq_u64 vcc, 0
    s_cbranch_scc1 K2G_spp_60_ok
    buffer_load_dword v3, v6, s[92:95], 0 offen sc1
    s_add_u32 s90, s90, 1
    s_cmp_lt_u32 s90, 4000
    s_cbranch_scc1 K2G_spp_60_lp
    s_waitcnt vmcnt(0)
K2G_spp_60_ok:
K2G_sp_59:
K2Gc_1L_nh1:
    s_cmp_eq_u32 s41, 7
    s_cbranch_scc0 K2Gc_1L_nh2
    s_cmp_eq_u32 s32, 4
    s_cbranch_scc0 K2G_sp_61
    s_add_u32 s88, s6, 0x8cc000
    s_addc_u32 s89, s7, 0
    s_mov_b32 s92, s88
    s_mov_b32 s93, s89
    s_mov_b32 s94, 0x2000
    s_mov_b32 s95, 0x00020000
    s_cmp_eq_u32 s36, 0
    s_cselect_b32 s88, 4, 10
    v_lshrrev_b32 v6, 1, v0
    v_add_u32 v6, s88, v6
    v_mov_b32 v7, s37
    v_cmp_le_u32 vcc, 4, v0
    s_nop 1
    v_cndmask_b32 v6, v6, v7, vcc
    v_sub_u32 v7, 15, v6
    v_cmp_gt_u32 vcc, 8, v6
    v_and_b32 v8, 1, v6
    s_nop 0
    v_cndmask_b32 v7, v7, v6, vcc
    v_lshrrev_b32 v7, 1, v7
    v_cndmask_b32_e64 v5, 2, 0, vcc
    v_add_u32 v8, v8, v5
    s_cmp_ge_u32 s38, 3
    s_cselect_b32 s89, 1, 0
    s_cselect_b32 s90, 3, 0
    s_sub_u32 s90, s38, s90
    s_lshl_b32 s90, s90, 1
    v_mul_u32_u24 v8, 6, v8
    v_and_b32 v5, 1, v0
    v_add_u32 v8, v8, v5
    v_add_u32 v8, s90, v8
    v_lshlrev_b32 v7, 1, v7
    v_add_u32 v7, s89, v7
    v_lshl_add_u32 v6, v8, 3, v7
    v_lshlrev_b32 v6, 5, v6
    v_mov_b32 v9, 0x7fffff00
    v_cmp_gt_u32 vcc, 6, v0
    s_nop 1
    v_cndmask_b32 v6, v9, v6, vcc
    v_cndmask_b32_e64 v5, 1, 0, vcc
    buffer_load_dword v3, v6, s[92:95], 0 offen sc1
K2G_sp_61:
K2Gc_1L_nh2:
    s_cmp_eq_u32 s41, 9
    s_cbranch_scc0 K2Gc_1L_nh3
    s_cmp_eq_u32 s32, 4
    s_cbranch_scc0 K2G_sp_63
    s_add_u32 s88, s6, 0x8cc000
    s_addc_u32 s89, s7, 0
    s_mov_b32 s92, s88
    s_mov_b32 s93, s89
    s_mov_b32 s94, 0x2000
    s_mov_b32 s95, 0x00020000
    s_mov_b32 s90, 0
K2G_spp_64_lp:
    s_waitcnt vmcnt(0)
    v_or_b32 v3, v3, v5
    v_cmp_ne_u32 vcc, 1, v3
    s_nop 1
    s_cmp_eq_u64 vcc, 0
    s_cbranch_scc1 K2G_spp_64_ok
    buffer_load_dword v3, v6, s[92:95], 0 offen sc1
    s_add_u32 s90, s90, 1
    s_cmp_lt_u32 s90, 4000
    s_cbranch_scc1 K2G_spp_64_lp
    s_waitcnt vmcnt(0)
K2G_spp_64_ok:
K2G_sp_63:
K2Gc_1L_nh3:
    s_cmp_eq_u32 s41, 12
    s_cbranch_scc0 K2Gc_1L_nh4
    buffer_load_dwordx4 v[2:5], v14, s[56:59], s47 offen offset:0 sc1
    buffer_load_dwordx4 v[6:9], v14, s[56:59], s47 offen offset:1024 sc1
    buffer_load_dwordx4 v[10:13], v14, s[56:59], s47 offen offset:2048 sc1
    buffer_load_dwordx4 v[116:119], v14, s[56:59], s47 offen offset:3072 sc1
    buffer_load_ushort v124, v15, s[28:31], 0 offen
    buffer_load_ushort v125, v15, s[28:31], 0 offen offset:32
K2Gc_1L_nh4:
    s_waitcnt lgkmcnt(6)
    v_mfma_f32_16x16x32_bf16 v[16:19], v[64:67], v[56:59], v[16:19]
    v_mfma_f32_16x16x32_bf16 v[20:23], v[64:67], v[60:63], v[20:23]
    v_mfma_f32_16x16x32_bf16 v[24:27], v[68:71], v[56:59], v[24:27]
    v_mfma_f32_16x16x32_bf16 v[28:31], v[68:71], v[60:63], v[28:31]
    v_mfma_f32_16x16x32_bf16 v[32:35], v[72:75], v[56:59], v[32:35]
    v_mfma_f32_16x16x32_bf16 v[36:39], v[72:75], v[60:63], v[36:39]
    v_mfma_f32_16x16x32_bf16 v[40:43], v[76:79], v[56:59], v[40:43]
    v_mfma_f32_16x16x32_bf16 v[44:47], v[76:79], v[60:63], v[44:47]
    s_waitcnt lgkmcnt(0)
    v_mfma_f32_16x16x32_bf16 v[16:19], v[92:95], v[84:87], v[16:19]
    v_mfma_f32_16x16x32_bf16 v[20:23], v[92:95], v[88:91], v[20:23]
    v_mfma_f32_16x16x32_bf16 v[24:27], v[96:99], v[84:87], v[24:27]
    v_mfma_f32_16x16x32_bf16 v[28:31], v[96:99], v[88:91], v[28:31]
    v_mfma_f32_16x16x32_bf16 v[32:35], v[100:103], v[84:87], v[32:35]
    v_mfma_f32_16x16x32_bf16 v[36:39], v[100:103], v[88:91], v[36:39]
    v_mfma_f32_16x16x32_bf16 v[40:43], v[104:107], v[84:87], v[40:43]
    v_mfma_f32_16x16x32_bf16 v[44:47], v[104:107], v[88:91], v[44:47]
    s_cmp_lt_u32 s41, 16
    s_cbranch_scc0 K2Gc_1L_done
    s_barrier
    s_branch K2Gc_1L_loop
K2Gc_1L_done:
    s_barrier
    s_waitcnt vmcnt(0)
    s_cmp_eq_u32 s36, 0
    s_cselect_b32 s48, 1.0, 0
    v_lshlrev_b32 v124, 16, v124
    v_lshlrev_b32 v125, 16, v125
    v_mul_f32 v124, s48, v124
    v_mul_f32 v125, s48, v125
    s_mul_i32 s48, s36, 3538944
    s_add_u32 s50, s6, 0x900000
    s_addc_u32 s51, s7, 0
    s_add_u32 s50, s50, s48
    s_addc_u32 s51, s51, 0
    s_mov_b32 s24, s50
    s_mov_b32 s25, s51
    s_mov_b32 s26, 0x360000
    s_mov_b32 s27, 0x00020000
    s_lshl_b32 s48, s37, 3
    s_lshl_b32 s49, s39, 1
    s_add_u32 s48, s48, s49
    s_mul_i32 s48, s48, 27648
    s_mul_i32 s49, s38, 9
    s_add_u32 s49, s49, 5
    s_lshl_b32 s49, s49, 9
    s_add_u32 s47, s48, s49
    s_add_u32 s52, s47, 27648
    v_lshlrev_b32 v14, 3, v0
    v_lshlrev_b32 v56, 16, v2
    v_and_b32 v57, 0xffff0000, v2
    v_lshlrev_b32 v58, 16, v3
    v_and_b32 v59, 0xffff0000, v3
    v_lshlrev_b32 v60, 16, v4
    v_and_b32 v61, 0xffff0000, v4
    v_lshlrev_b32 v62, 16, v5
    v_and_b32 v63, 0xffff0000, v5
    v_pk_add_f32 v[16:17], v[16:17], v[124:125] op_sel:[0,0] op_sel_hi:[1,0]
    v_pk_add_f32 v[18:19], v[18:19], v[124:125] op_sel:[0,0] op_sel_hi:[1,0]
    v_pk_add_f32 v[20:21], v[20:21], v[124:125] op_sel:[0,1] op_sel_hi:[1,1]
    v_pk_add_f32 v[22:23], v[22:23], v[124:125] op_sel:[0,1] op_sel_hi:[1,1]
    v_pk_mul_f32 v[16:17], v[16:17], v[56:57]
    v_pk_mul_f32 v[18:19], v[18:19], v[58:59]
    v_pk_mul_f32 v[20:21], v[20:21], v[60:61]
    v_pk_mul_f32 v[22:23], v[22:23], v[62:63]
    v_cvt_pk_bf16_f32 v64, v16, v17
    v_cvt_pk_bf16_f32 v65, v18, v19
    v_cvt_pk_bf16_f32 v66, v20, v21
    v_cvt_pk_bf16_f32 v67, v22, v23
    buffer_store_dwordx2 v[64:65], v14, s[24:27], s47 offen offset:0 sc1
    buffer_store_dwordx2 v[66:67], v14, s[24:27], s52 offen offset:0 sc1
    v_lshlrev_b32 v56, 16, v6
    v_and_b32 v57, 0xffff0000, v6
    v_lshlrev_b32 v58, 16, v7
    v_and_b32 v59, 0xffff0000, v7
    v_lshlrev_b32 v60, 16, v8
    v_and_b32 v61, 0xffff0000, v8
    v_lshlrev_b32 v62, 16, v9
    v_and_b32 v63, 0xffff0000, v9
    v_pk_add_f32 v[24:25], v[24:25], v[124:125] op_sel:[0,0] op_sel_hi:[1,0]
    v_pk_add_f32 v[26:27], v[26:27], v[124:125] op_sel:[0,0] op_sel_hi:[1,0]
    v_pk_add_f32 v[28:29], v[28:29], v[124:125] op_sel:[0,1] op_sel_hi:[1,1]
    v_pk_add_f32 v[30:31], v[30:31], v[124:125] op_sel:[0,1] op_sel_hi:[1,1]
    v_pk_mul_f32 v[24:25], v[24:25], v[56:57]
    v_pk_mul_f32 v[26:27], v[26:27], v[58:59]
    v_pk_mul_f32 v[28:29], v[28:29], v[60:61]
    v_pk_mul_f32 v[30:31], v[30:31], v[62:63]
    v_cvt_pk_bf16_f32 v68, v24, v25
    v_cvt_pk_bf16_f32 v69, v26, v27
    v_cvt_pk_bf16_f32 v70, v28, v29
    v_cvt_pk_bf16_f32 v71, v30, v31
    buffer_store_dwordx2 v[68:69], v14, s[24:27], s47 offen offset:512 sc1
    buffer_store_dwordx2 v[70:71], v14, s[24:27], s52 offen offset:512 sc1
    v_lshlrev_b32 v56, 16, v10
    v_and_b32 v57, 0xffff0000, v10
    v_lshlrev_b32 v58, 16, v11
    v_and_b32 v59, 0xffff0000, v11
    v_lshlrev_b32 v60, 16, v12
    v_and_b32 v61, 0xffff0000, v12
    v_lshlrev_b32 v62, 16, v13
    v_and_b32 v63, 0xffff0000, v13
    v_pk_add_f32 v[32:33], v[32:33], v[124:125] op_sel:[0,0] op_sel_hi:[1,0]
    v_pk_add_f32 v[34:35], v[34:35], v[124:125] op_sel:[0,0] op_sel_hi:[1,0]
    v_pk_add_f32 v[36:37], v[36:37], v[124:125] op_sel:[0,1] op_sel_hi:[1,1]
    v_pk_add_f32 v[38:39], v[38:39], v[124:125] op_sel:[0,1] op_sel_hi:[1,1]
    v_pk_mul_f32 v[32:33], v[32:33], v[56:57]
    v_pk_mul_f32 v[34:35], v[34:35], v[58:59]
    v_pk_mul_f32 v[36:37], v[36:37], v[60:61]
    v_pk_mul_f32 v[38:39], v[38:39], v[62:63]
    v_cvt_pk_bf16_f32 v64, v32, v33
    v_cvt_pk_bf16_f32 v65, v34, v35
    v_cvt_pk_bf16_f32 v66, v36, v37
    v_cvt_pk_bf16_f32 v67, v38, v39
    buffer_store_dwordx2 v[64:65], v14, s[24:27], s47 offen offset:1024 sc1
    buffer_store_dwordx2 v[66:67], v14, s[24:27], s52 offen offset:1024 sc1
    v_lshlrev_b32 v56, 16, v116
    v_and_b32 v57, 0xffff0000, v116
    v_lshlrev_b32 v58, 16, v117
    v_and_b32 v59, 0xffff0000, v117
    v_lshlrev_b32 v60, 16, v118
    v_and_b32 v61, 0xffff0000, v118
    v_lshlrev_b32 v62, 16, v119
    v_and_b32 v63, 0xffff0000, v119
    v_pk_add_f32 v[40:41], v[40:41], v[124:125] op_sel:[0,0] op_sel_hi:[1,0]
    v_pk_add_f32 v[42:43], v[42:43], v[124:125] op_sel:[0,0] op_sel_hi:[1,0]
    v_pk_add_f32 v[44:45], v[44:45], v[124:125] op_sel:[0,1] op_sel_hi:[1,1]
    v_pk_add_f32 v[46:47], v[46:47], v[124:125] op_sel:[0,1] op_sel_hi:[1,1]
    v_pk_mul_f32 v[40:41], v[40:41], v[56:57]
    v_pk_mul_f32 v[42:43], v[42:43], v[58:59]
    v_pk_mul_f32 v[44:45], v[44:45], v[60:61]
    v_pk_mul_f32 v[46:47], v[46:47], v[62:63]
    v_cvt_pk_bf16_f32 v68, v40, v41
    v_cvt_pk_bf16_f32 v69, v42, v43
    v_cvt_pk_bf16_f32 v70, v44, v45
    v_cvt_pk_bf16_f32 v71, v46, v47
    buffer_store_dwordx2 v[68:69], v14, s[24:27], s47 offen offset:1536 sc1
    buffer_store_dwordx2 v[70:71], v14, s[24:27], s52 offen offset:1536 sc1
    s_branch K2_end
K2G_prod:
    s_sub_u32 s39, s32, 8
    v_lshrrev_b32 v20, 3, v0
    v_and_b32 v22, 7, v0
    v_xor_b32 v22, v22, v20
    v_lshlrev_b32 v22, 4, v22
    s_lshl_b32 s48, s39, 4
    v_add_u32 v21, s48, v20
    v_lshlrev_b32 v21, 12, v21
    v_add_u32 v2, v21, v22
    s_mul_i32 s48, s39, 3
    s_lshl_b32 s49, s39, 1
    s_add_u32 s49, s49, 2
    s_cmp_lt_u32 s39, 2
    s_cselect_b32 s53, s48, s49
    s_lshl_b32 s53, s53, 10
    v_lshlrev_b32 v20, 4, v0
    v_add_u32 v3, s53, v20
    s_mov_b32 s42, 0
    s_mul_i32 s48, s38, 0
    s_and_b32 s49, s37, 3
    s_mul_i32 s49, s49, 0
    s_add_u32 s48, s48, s49
    s_and_b32 s48, s48, 15
    s_lshl_b32 s44, s48, 7
    s_mul_i32 s45, s48, 18432
    s_mul_i32 s48, s37, 524288
    s_lshl_b32 s49, s36, 11
    s_add_u32 s48, s48, s49
    s_sub_u32 s49, 524288, s49
    s_mul_i32 s50, s38, 589824
    s_mul_i32 s51, s36, 294912
    s_add_u32 s52, s50, s51
    s_waitcnt lgkmcnt(0)
    s_add_u32 s4, s4, s48
    s_addc_u32 s5, s5, 0
    s_mov_b32 s16, s4
    s_mov_b32 s17, s5
    s_mov_b32 s18, s49
    s_mov_b32 s19, 0x00020000
    s_add_u32 s50, s6, s52
    s_addc_u32 s51, s7, 0
    s_mov_b32 s20, s50
    s_mov_b32 s21, s51
    s_mov_b32 s22, 0x48000
    s_mov_b32 s23, 0x00020000
    s_cmp_eq_u32 s36, 0
    s_cselect_b32 s48, 0, 8
    s_lshl_b32 s44, s48, 7
    s_mul_i32 s45, s48, 18432
    s_lshl_b32 s46, s39, 11
    s_add_u32 s46, s46, 0
    s_add_u32 m0, s46, 0
    s_add_u32 s47, s44, 0
    buffer_load_dwordx4 v2, s[16:19], s47 offen lds
    s_add_u32 m0, s46, 1024
    s_add_u32 s47, s44, 32768
    buffer_load_dwordx4 v2, s[16:19], s47 offen lds
    s_add_u32 s44, s44, 128
    s_lshl_b32 s46, s39, 11
    s_add_u32 s46, s46, 34816
    s_add_u32 m0, s46, 0
    s_add_u32 s47, s44, 0
    buffer_load_dwordx4 v2, s[16:19], s47 offen lds
    s_add_u32 m0, s46, 1024
    s_add_u32 s47, s44, 32768
    buffer_load_dwordx4 v2, s[16:19], s47 offen lds
    s_add_u32 s44, s44, 128
    s_lshl_b32 s46, s39, 11
    s_add_u32 s46, s46, 69632
    s_add_u32 m0, s46, 0
    s_add_u32 s47, s44, 0
    buffer_load_dwordx4 v2, s[16:19], s47 offen lds
    s_add_u32 m0, s46, 1024
    s_add_u32 s47, s44, 32768
    buffer_load_dwordx4 v2, s[16:19], s47 offen lds
    s_add_u32 s44, s44, 128
    s_lshl_b32 s46, s39, 11
    s_add_u32 s46, s46, 104448
    s_add_u32 m0, s46, 0
    s_add_u32 s47, s44, 0
    buffer_load_dwordx4 v2, s[16:19], s47 offen lds
    s_add_u32 m0, s46, 1024
    s_add_u32 s47, s44, 32768
    buffer_load_dwordx4 v2, s[16:19], s47 offen lds
    s_add_u32 s44, s44, 128
    s_cmp_eq_u32 s32, 8
    s_cbranch_scc0 K2Gp_g1
    s_add_u32 s88, s6, 0x8cc000
    s_addc_u32 s89, s7, 0
    s_mov_b32 s92, s88
    s_mov_b32 s93, s89
    s_mov_b32 s94, 0x2000
    s_mov_b32 s95, 0x00020000
    s_cmp_eq_u32 s36, 0
    s_cselect_b32 s88, 0, 12
    v_lshrrev_b32 v28, 1, v0
    v_add_u32 v28, s88, v28
    v_sub_u32 v29, 15, v28
    v_cmp_gt_u32 vcc, 8, v28
    v_and_b32 v30, 1, v28
    s_nop 0
    v_cndmask_b32 v29, v29, v28, vcc
    v_lshrrev_b32 v29, 1, v29
    v_cndmask_b32_e64 v27, 2, 0, vcc
    v_add_u32 v30, v30, v27
    s_cmp_ge_u32 s38, 3
    s_cselect_b32 s89, 1, 0
    s_cselect_b32 s90, 3, 0
    s_sub_u32 s90, s38, s90
    s_lshl_b32 s90, s90, 1
    v_mul_u32_u24 v30, 6, v30
    v_and_b32 v27, 1, v0
    v_add_u32 v30, v30, v27
    v_add_u32 v30, s90, v30
    v_lshlrev_b32 v29, 1, v29
    v_add_u32 v29, s89, v29
    v_lshl_add_u32 v28, v30, 3, v29
    v_lshlrev_b32 v28, 5, v28
    v_mov_b32 v31, 0x7fffff00
    v_cmp_gt_u32 vcc, 8, v0
    s_nop 1
    v_cndmask_b32 v28, v31, v28, vcc
    v_cndmask_b32_e64 v27, 1, 0, vcc
    s_mov_b32 s90, 0
    buffer_load_dword v25, v28, s[92:95], 0 offen sc1
K2Gp_g1p_lp:
    s_waitcnt vmcnt(0)
    v_or_b32 v25, v25, v27
    v_cmp_ne_u32 vcc, 1, v25
    s_nop 1
    s_cmp_eq_u64 vcc, 0
    s_cbranch_scc1 K2Gp_g1p_ok
    buffer_load_dword v25, v28, s[92:95], 0 offen sc1
    s_add_u32 s90, s90, 1
    s_cmp_lt_u32 s90, 4000
    s_cbranch_scc1 K2Gp_g1p_lp
    s_waitcnt vmcnt(0)
K2Gp_g1p_ok:
K2Gp_g1:
    s_barrier
    s_add_u32 m0, s53, 16384
    s_cmp_lt_u32 s39, 2
    buffer_load_dwordx4 v3, s[20:23], s45 offen offset:0 sc1 lds
    buffer_load_dwordx4 v3, s[20:23], s45 offen offset:1024 sc1 lds
    s_cbranch_scc0 K2Gp_z_65
    buffer_load_dwordx4 v3, s[20:23], s45 offen offset:2048 sc1 lds
K2Gp_z_65:
    s_add_u32 s45, s45, 18432
    s_add_u32 m0, s53, 51200
    s_cmp_lt_u32 s39, 2
    buffer_load_dwordx4 v3, s[20:23], s45 offen offset:0 sc1 lds
    buffer_load_dwordx4 v3, s[20:23], s45 offen offset:1024 sc1 lds
    s_cbranch_scc0 K2Gp_z_66
    buffer_load_dwordx4 v3, s[20:23], s45 offen offset:2048 sc1 lds
K2Gp_z_66:
    s_add_u32 s45, s45, 18432
    s_waitcnt vmcnt(2)
    s_barrier
    s_add_u32 m0, s53, 86016
    s_cmp_lt_u32 s39, 2
    buffer_load_dwordx4 v3, s[20:23], s45 offen offset:0 sc1 lds
    buffer_load_dwordx4 v3, s[20:23], s45 offen offset:1024 sc1 lds
    s_cbranch_scc0 K2Gp_z_67
    buffer_load_dwordx4 v3, s[20:23], s45 offen offset:2048 sc1 lds
K2Gp_z_67:
    s_add_u32 s45, s45, 18432
    s_add_u32 m0, s53, 120832
    s_cmp_lt_u32 s39, 2
    buffer_load_dwordx4 v3, s[20:23], s45 offen offset:0 sc1 lds
    buffer_load_dwordx4 v3, s[20:23], s45 offen offset:1024 sc1 lds
    s_cbranch_scc0 K2Gp_z_68
    buffer_load_dwordx4 v3, s[20:23], s45 offen offset:2048 sc1 lds
K2Gp_z_68:
    s_add_u32 s45, s45, 18432
    s_waitcnt vmcnt(4)
    s_barrier
    s_lshl_b32 s46, s39, 11
    s_add_u32 s46, s46, s42
    s_add_u32 m0, s46, 0
    s_add_u32 s47, s44, 0
    buffer_load_dwordx4 v2, s[16:19], s47 offen lds
    s_add_u32 m0, s46, 1024
    s_add_u32 s47, s44, 32768
    buffer_load_dwordx4 v2, s[16:19], s47 offen lds
    s_add_u32 s46, s42, s53
    s_add_u32 m0, s46, 16384
    s_nop 0
    buffer_load_dwordx4 v3, s[20:23], s45 offen offset:0 sc1 lds
    buffer_load_dwordx4 v3, s[20:23], s45 offen offset:1024 sc1 lds
    s_cmp_lt_u32 s39, 2
    s_cbranch_scc0 K2Gp_t_69
    buffer_load_dwordx4 v3, s[20:23], s45 offen offset:2048 sc1 lds
K2Gp_t_69:
    s_add_u32 s42, s42, 34816
    s_cmp_eq_u32 s42, 139264
    s_cselect_b32 s42, 0, s42
    s_add_u32 s44, s44, 128
    s_add_u32 s45, s45, 18432
    s_cmp_eq_u32 s44, 2048
    s_cselect_b32 s44, 0, s44
    s_cselect_b32 s45, 0, s45
    s_waitcnt vmcnt(6)
    s_barrier
    s_lshl_b32 s46, s39, 11
    s_add_u32 s46, s46, s42
    s_add_u32 m0, s46, 0
    s_add_u32 s47, s44, 0
    buffer_load_dwordx4 v2, s[16:19], s47 offen lds
    s_add_u32 m0, s46, 1024
    s_add_u32 s47, s44, 32768
    buffer_load_dwordx4 v2, s[16:19], s47 offen lds
    s_add_u32 s46, s42, s53
    s_add_u32 m0, s46, 16384
    s_nop 0
    buffer_load_dwordx4 v3, s[20:23], s45 offen offset:0 sc1 lds
    buffer_load_dwordx4 v3, s[20:23], s45 offen offset:1024 sc1 lds
    s_cmp_lt_u32 s39, 2
    s_cbranch_scc0 K2Gp_t_70
    buffer_load_dwordx4 v3, s[20:23], s45 offen offset:2048 sc1 lds
K2Gp_t_70:
    s_add_u32 s42, s42, 34816
    s_cmp_eq_u32 s42, 139264
    s_cselect_b32 s42, 0, s42
    s_add_u32 s44, s44, 128
    s_add_u32 s45, s45, 18432
    s_cmp_eq_u32 s44, 2048
    s_cselect_b32 s44, 0, s44
    s_cselect_b32 s45, 0, s45
    s_waitcnt vmcnt(8)
    s_barrier
    s_lshl_b32 s46, s39, 11
    s_add_u32 s46, s46, s42
    s_add_u32 m0, s46, 0
    s_add_u32 s47, s44, 0
    buffer_load_dwordx4 v2, s[16:19], s47 offen lds
    s_add_u32 m0, s46, 1024
    s_add_u32 s47, s44, 32768
    buffer_load_dwordx4 v2, s[16:19], s47 offen lds
    s_add_u32 s46, s42, s53
    s_add_u32 m0, s46, 16384
    s_nop 0
    buffer_load_dwordx4 v3, s[20:23], s45 offen offset:0 sc1 lds
    buffer_load_dwordx4 v3, s[20:23], s45 offen offset:1024 sc1 lds
    s_cmp_lt_u32 s39, 2
    s_cbranch_scc0 K2Gp_t_71
    buffer_load_dwordx4 v3, s[20:23], s45 offen offset:2048 sc1 lds
K2Gp_t_71:
    s_add_u32 s42, s42, 34816
    s_cmp_eq_u32 s42, 139264
    s_cselect_b32 s42, 0, s42
    s_add_u32 s44, s44, 128
    s_add_u32 s45, s45, 18432
    s_cmp_eq_u32 s44, 2048
    s_cselect_b32 s44, 0, s44
    s_cselect_b32 s45, 0, s45
    s_waitcnt vmcnt(8)
    s_barrier
    s_lshl_b32 s46, s39, 11
    s_add_u32 s46, s46, s42
    s_add_u32 m0, s46, 0
    s_add_u32 s47, s44, 0
    buffer_load_dwordx4 v2, s[16:19], s47 offen lds
    s_add_u32 m0, s46, 1024
    s_add_u32 s47, s44, 32768
    buffer_load_dwordx4 v2, s[16:19], s47 offen lds
    s_add_u32 s46, s42, s53
    s_add_u32 m0, s46, 16384
    s_nop 0
    buffer_load_dwordx4 v3, s[20:23], s45 offen offset:0 sc1 lds
    buffer_load_dwordx4 v3, s[20:23], s45 offen offset:1024 sc1 lds
    s_cmp_lt_u32 s39, 2
    s_cbranch_scc0 K2Gp_t_72
    buffer_load_dwordx4 v3, s[20:23], s45 offen offset:2048 sc1 lds
K2Gp_t_72:
    s_add_u32 s42, s42, 34816
    s_cmp_eq_u32 s42, 139264
    s_cselect_b32 s42, 0, s42
    s_add_u32 s44, s44, 128
    s_add_u32 s45, s45, 18432
    s_cmp_eq_u32 s44, 2048
    s_cselect_b32 s44, 0, s44
    s_cselect_b32 s45, 0, s45
    s_waitcnt vmcnt(8)
    s_barrier
    s_cmp_eq_u32 s36, 0
    s_cselect_b32 s48, 12, 0
    s_lshl_b32 s44, s48, 7
    s_mul_i32 s45, s48, 18432
    s_lshl_b32 s46, s39, 11
    s_add_u32 s46, s46, s42
    s_add_u32 m0, s46, 0
    s_add_u32 s47, s44, 0
    buffer_load_dwordx4 v2, s[16:19], s47 offen lds
    s_add_u32 m0, s46, 1024
    s_add_u32 s47, s44, 32768
    buffer_load_dwordx4 v2, s[16:19], s47 offen lds
    s_add_u32 s46, s42, s53
    s_add_u32 m0, s46, 16384
    s_nop 0
    buffer_load_dwordx4 v3, s[20:23], s45 offen offset:0 sc1 lds
    buffer_load_dwordx4 v3, s[20:23], s45 offen offset:1024 sc1 lds
    s_cmp_lt_u32 s39, 2
    s_cbranch_scc0 K2Gp_t_73
    buffer_load_dwordx4 v3, s[20:23], s45 offen offset:2048 sc1 lds
K2Gp_t_73:
    s_add_u32 s42, s42, 34816
    s_cmp_eq_u32 s42, 139264
    s_cselect_b32 s42, 0, s42
    s_add_u32 s44, s44, 128
    s_add_u32 s45, s45, 18432
    s_cmp_eq_u32 s44, 2048
    s_cselect_b32 s44, 0, s44
    s_cselect_b32 s45, 0, s45
    s_waitcnt vmcnt(8)
    s_barrier
    s_lshl_b32 s46, s39, 11
    s_add_u32 s46, s46, s42
    s_add_u32 m0, s46, 0
    s_add_u32 s47, s44, 0
    buffer_load_dwordx4 v2, s[16:19], s47 offen lds
    s_add_u32 m0, s46, 1024
    s_add_u32 s47, s44, 32768
    buffer_load_dwordx4 v2, s[16:19], s47 offen lds
    s_add_u32 s46, s42, s53
    s_add_u32 m0, s46, 16384
    s_nop 0
    buffer_load_dwordx4 v3, s[20:23], s45 offen offset:0 sc1 lds
    buffer_load_dwordx4 v3, s[20:23], s45 offen offset:1024 sc1 lds
    s_cmp_lt_u32 s39, 2
    s_cbranch_scc0 K2Gp_t_74
    buffer_load_dwordx4 v3, s[20:23], s45 offen offset:2048 sc1 lds
K2Gp_t_74:
    s_add_u32 s42, s42, 34816
    s_cmp_eq_u32 s42, 139264
    s_cselect_b32 s42, 0, s42
    s_add_u32 s44, s44, 128
    s_add_u32 s45, s45, 18432
    s_cmp_eq_u32 s44, 2048
    s_cselect_b32 s44, 0, s44
    s_cselect_b32 s45, 0, s45
    s_waitcnt vmcnt(8)
    s_barrier
    s_lshl_b32 s46, s39, 11
    s_add_u32 s46, s46, s42
    s_add_u32 m0, s46, 0
    s_add_u32 s47, s44, 0
    buffer_load_dwordx4 v2, s[16:19], s47 offen lds
    s_add_u32 m0, s46, 1024
    s_add_u32 s47, s44, 32768
    buffer_load_dwordx4 v2, s[16:19], s47 offen lds
    s_add_u32 s46, s42, s53
    s_add_u32 m0, s46, 16384
    s_nop 0
    buffer_load_dwordx4 v3, s[20:23], s45 offen offset:0 sc1 lds
    buffer_load_dwordx4 v3, s[20:23], s45 offen offset:1024 sc1 lds
    s_cmp_lt_u32 s39, 2
    s_cbranch_scc0 K2Gp_t_75
    buffer_load_dwordx4 v3, s[20:23], s45 offen offset:2048 sc1 lds
K2Gp_t_75:
    s_add_u32 s42, s42, 34816
    s_cmp_eq_u32 s42, 139264
    s_cselect_b32 s42, 0, s42
    s_add_u32 s44, s44, 128
    s_add_u32 s45, s45, 18432
    s_cmp_eq_u32 s44, 2048
    s_cselect_b32 s44, 0, s44
    s_cselect_b32 s45, 0, s45
    s_waitcnt vmcnt(8)
    s_barrier
    s_lshl_b32 s46, s39, 11
    s_add_u32 s46, s46, s42
    s_add_u32 m0, s46, 0
    s_add_u32 s47, s44, 0
    buffer_load_dwordx4 v2, s[16:19], s47 offen lds
    s_add_u32 m0, s46, 1024
    s_add_u32 s47, s44, 32768
    buffer_load_dwordx4 v2, s[16:19], s47 offen lds
    s_add_u32 s46, s42, s53
    s_add_u32 m0, s46, 16384
    s_nop 0
    buffer_load_dwordx4 v3, s[20:23], s45 offen offset:0 sc1 lds
    buffer_load_dwordx4 v3, s[20:23], s45 offen offset:1024 sc1 lds
    s_cmp_lt_u32 s39, 2
    s_cbranch_scc0 K2Gp_t_76
    buffer_load_dwordx4 v3, s[20:23], s45 offen offset:2048 sc1 lds
K2Gp_t_76:
    s_add_u32 s42, s42, 34816
    s_cmp_eq_u32 s42, 139264
    s_cselect_b32 s42, 0, s42
    s_add_u32 s44, s44, 128
    s_add_u32 s45, s45, 18432
    s_cmp_eq_u32 s44, 2048
    s_cselect_b32 s44, 0, s44
    s_cselect_b32 s45, 0, s45
    s_waitcnt vmcnt(8)
    s_barrier
    s_cmp_eq_u32 s36, 0
    s_cselect_b32 s48, 8, 4
    s_lshl_b32 s44, s48, 7
    s_mul_i32 s45, s48, 18432
    s_lshl_b32 s46, s39, 11
    s_add_u32 s46, s46, s42
    s_add_u32 m0, s46, 0
    s_add_u32 s47, s44, 0
    buffer_load_dwordx4 v2, s[16:19], s47 offen lds
    s_add_u32 m0, s46, 1024
    s_add_u32 s47, s44, 32768
    buffer_load_dwordx4 v2, s[16:19], s47 offen lds
    s_add_u32 s46, s42, s53
    s_add_u32 m0, s46, 16384
    s_nop 0
    buffer_load_dwordx4 v3, s[20:23], s45 offen offset:0 sc1 lds
    buffer_load_dwordx4 v3, s[20:23], s45 offen offset:1024 sc1 lds
    s_cmp_lt_u32 s39, 2
    s_cbranch_scc0 K2Gp_t_77
    buffer_load_dwordx4 v3, s[20:23], s45 offen offset:2048 sc1 lds
K2Gp_t_77:
    s_add_u32 s42, s42, 34816
    s_cmp_eq_u32 s42, 139264
    s_cselect_b32 s42, 0, s42
    s_add_u32 s44, s44, 128
    s_add_u32 s45, s45, 18432
    s_cmp_eq_u32 s44, 2048
    s_cselect_b32 s44, 0, s44
    s_cselect_b32 s45, 0, s45
    s_waitcnt vmcnt(8)
    s_barrier
    s_lshl_b32 s46, s39, 11
    s_add_u32 s46, s46, s42
    s_add_u32 m0, s46, 0
    s_add_u32 s47, s44, 0
    buffer_load_dwordx4 v2, s[16:19], s47 offen lds
    s_add_u32 m0, s46, 1024
    s_add_u32 s47, s44, 32768
    buffer_load_dwordx4 v2, s[16:19], s47 offen lds
    s_add_u32 s46, s42, s53
    s_add_u32 m0, s46, 16384
    s_nop 0
    buffer_load_dwordx4 v3, s[20:23], s45 offen offset:0 sc1 lds
    buffer_load_dwordx4 v3, s[20:23], s45 offen offset:1024 sc1 lds
    s_cmp_lt_u32 s39, 2
    s_cbranch_scc0 K2Gp_t_78
    buffer_load_dwordx4 v3, s[20:23], s45 offen offset:2048 sc1 lds
K2Gp_t_78:
    s_add_u32 s42, s42, 34816
    s_cmp_eq_u32 s42, 139264
    s_cselect_b32 s42, 0, s42
    s_add_u32 s44, s44, 128
    s_add_u32 s45, s45, 18432
    s_cmp_eq_u32 s44, 2048
    s_cselect_b32 s44, 0, s44
    s_cselect_b32 s45, 0, s45
    s_waitcnt vmcnt(8)
    s_barrier
    s_lshl_b32 s46, s39, 11
    s_add_u32 s46, s46, s42
    s_add_u32 m0, s46, 0
    s_add_u32 s47, s44, 0
    buffer_load_dwordx4 v2, s[16:19], s47 offen lds
    s_add_u32 m0, s46, 1024
    s_add_u32 s47, s44, 32768
    buffer_load_dwordx4 v2, s[16:19], s47 offen lds
    s_add_u32 s46, s42, s53
    s_add_u32 m0, s46, 16384
    s_nop 0
    buffer_load_dwordx4 v3, s[20:23], s45 offen offset:0 sc1 lds
    buffer_load_dwordx4 v3, s[20:23], s45 offen offset:1024 sc1 lds
    s_cmp_lt_u32 s39, 2
    s_cbranch_scc0 K2Gp_t_79
    buffer_load_dwordx4 v3, s[20:23], s45 offen offset:2048 sc1 lds
K2Gp_t_79:
    s_add_u32 s42, s42, 34816
    s_cmp_eq_u32 s42, 139264
    s_cselect_b32 s42, 0, s42
    s_add_u32 s44, s44, 128
    s_add_u32 s45, s45, 18432
    s_cmp_eq_u32 s44, 2048
    s_cselect_b32 s44, 0, s44
    s_cselect_b32 s45, 0, s45
    s_waitcnt vmcnt(8)
    s_barrier
    s_lshl_b32 s46, s39, 11
    s_add_u32 s46, s46, s42
    s_add_u32 m0, s46, 0
    s_add_u32 s47, s44, 0
    buffer_load_dwordx4 v2, s[16:19], s47 offen lds
    s_add_u32 m0, s46, 1024
    s_add_u32 s47, s44, 32768
    buffer_load_dwordx4 v2, s[16:19], s47 offen lds
    s_add_u32 s46, s42, s53
    s_add_u32 m0, s46, 16384
    s_nop 0
    buffer_load_dwordx4 v3, s[20:23], s45 offen offset:0 sc1 lds
    buffer_load_dwordx4 v3, s[20:23], s45 offen offset:1024 sc1 lds
    s_cmp_lt_u32 s39, 2
    s_cbranch_scc0 K2Gp_t_80
    buffer_load_dwordx4 v3, s[20:23], s45 offen offset:2048 sc1 lds
K2Gp_t_80:
    s_add_u32 s42, s42, 34816
    s_cmp_eq_u32 s42, 139264
    s_cselect_b32 s42, 0, s42
    s_add_u32 s44, s44, 128
    s_add_u32 s45, s45, 18432
    s_cmp_eq_u32 s44, 2048
    s_cselect_b32 s44, 0, s44
    s_cselect_b32 s45, 0, s45
    s_waitcnt vmcnt(8)
    s_barrier
    s_waitcnt vmcnt(4)
    s_barrier
    s_waitcnt vmcnt(0)
    s_barrier
    s_barrier
    s_branch K2_end
K2T_entry:
    s_sub_u32 s48, s34, 24
    s_and_b32 s38, s48, 3
    s_lshr_b32 s48, s48, 2
    s_lshr_b32 s49, s33, 1
    s_lshl_b32 s49, s49, 1
    s_add_u32 s37, s49, s48
    s_cmp_ge_u32 s32, 8
    s_cbranch_scc1 K2T_prod
    s_and_b32 s39, s32, 3
    s_lshr_b32 s40, s32, 2
    s_cmp_eq_u32 s39, 3
    s_cbranch_scc1 K2T_xpf
    v_lshrrev_b32 v7, 4, v0
    v_lshlrev_b32 v5, 4, v7
    v_and_b32 v6, 15, v0
    v_and_b32 v8, 7, v0
    v_xor_b32 v8, v8, v7
    v_lshlrev_b32 v8, 4, v8
    v_lshl_add_u32 v8, v6, 7, v8
    s_mul_i32 s48, s39, 6144
    v_add_u32 v112, s48, v8
    v_xor_b32 v113, 64, v112
    s_mul_i32 s48, s40, 3072
    s_add_u32 s48, s48, 18432
    v_lshlrev_b32 v9, 4, v0
    v_add_u32 v114, s48, v9
    v_mov_b32 v16, 0
    v_mov_b32 v17, 0
    v_mov_b32 v18, 0
    v_mov_b32 v19, 0
    v_mov_b32 v20, 0
    v_mov_b32 v21, 0
    v_mov_b32 v22, 0
    v_mov_b32 v23, 0
    v_mov_b32 v24, 0
    v_mov_b32 v25, 0
    v_mov_b32 v26, 0
    v_mov_b32 v27, 0
    v_mov_b32 v28, 0
    v_mov_b32 v29, 0
    v_mov_b32 v30, 0
    v_mov_b32 v31, 0
    v_mov_b32 v32, 0
    v_mov_b32 v33, 0
    v_mov_b32 v34, 0
    v_mov_b32 v35, 0
    v_mov_b32 v36, 0
    v_mov_b32 v37, 0
    v_mov_b32 v38, 0
    v_mov_b32 v39, 0
    v_mov_b32 v40, 0
    v_mov_b32 v41, 0
    v_mov_b32 v42, 0
    v_mov_b32 v43, 0
    v_mov_b32 v44, 0
    v_mov_b32 v45, 0
    v_mov_b32 v46, 0
    v_mov_b32 v47, 0
    v_mov_b32 v48, 0
    v_mov_b32 v49, 0
    v_mov_b32 v50, 0
    v_mov_b32 v51, 0
    s_mul_i32 s48, s38, 320
    s_mul_i32 s49, s40, 192
    s_add_u32 s47, s48, s49
    s_waitcnt lgkmcnt(0)
    s_add_u32 s50, s6, 0x8c0000
    s_addc_u32 s51, s7, 0
    s_mov_b32 s56, s50
    s_mov_b32 s57, s51
    s_mov_b32 s58, 0x500
    s_mov_b32 s59, 0x00020000
    s_cmp_eq_u32 s40, 0
    s_cbranch_scc0 K2Tc_1
K2Tc_0:
    s_mov_b32 s41, 0
    s_mov_b32 s43, 0
    s_barrier
    s_barrier
    ds_read_b128 v[56:59], v112 offset:0
    ds_read_b128 v[60:63], v112 offset:2048
    ds_read_b128 v[64:67], v112 offset:4096
    ds_read_b128 v[68:71], v114 offset:0
    ds_read_b128 v[72:75], v114 offset:1024
    ds_read_b128 v[76:79], v114 offset:2048
    ds_read_b128 v[80:83], v113 offset:0
    ds_read_b128 v[84:87], v113 offset:2048
    ds_read_b128 v[88:91], v113 offset:4096
    ds_read_b128 v[92:95], v114 offset:5120
    ds_read_b128 v[96:99], v114 offset:6144
    ds_read_b128 v[100:103], v114 offset:7168
    s_mov_b32 s48, s43
    s_add_u32 s43, s43, 28672
    s_cmp_eq_u32 s43, 114688
    s_cselect_b32 s43, 0, s43
    s_sub_u32 s48, s43, s48
    s_add_u32 s41, s41, 1
    v_add_u32 v112, s48, v112
    v_add_u32 v113, s48, v113
    v_add_u32 v114, s48, v114
    s_waitcnt lgkmcnt(0)
K2Tc_0L_loop:
    s_barrier
    v_mfma_f32_16x16x32_bf16 v[16:19], v[68:71], v[56:59], v[16:19]
    v_mfma_f32_16x16x32_bf16 v[20:23], v[68:71], v[60:63], v[20:23]
    v_mfma_f32_16x16x32_bf16 v[24:27], v[68:71], v[64:67], v[24:27]
    v_mfma_f32_16x16x32_bf16 v[28:31], v[72:75], v[56:59], v[28:31]
    v_mfma_f32_16x16x32_bf16 v[32:35], v[72:75], v[60:63], v[32:35]
    v_mfma_f32_16x16x32_bf16 v[36:39], v[72:75], v[64:67], v[36:39]
    v_mfma_f32_16x16x32_bf16 v[40:43], v[76:79], v[56:59], v[40:43]
    v_mfma_f32_16x16x32_bf16 v[44:47], v[76:79], v[60:63], v[44:47]
    v_mfma_f32_16x16x32_bf16 v[48:51], v[76:79], v[64:67], v[48:51]
    v_mfma_f32_16x16x32_bf16 v[16:19], v[92:95], v[80:83], v[16:19]
    v_mfma_f32_16x16x32_bf16 v[20:23], v[92:95], v[84:87], v[20:23]
    v_mfma_f32_16x16x32_bf16 v[24:27], v[92:95], v[88:91], v[24:27]
    ds_read_b128 v[56:59], v112 offset:0
    v_mfma_f32_16x16x32_bf16 v[28:31], v[96:99], v[80:83], v[28:31]
    ds_read_b128 v[60:63], v112 offset:2048
    v_mfma_f32_16x16x32_bf16 v[32:35], v[96:99], v[84:87], v[32:35]
    ds_read_b128 v[64:67], v112 offset:4096
    v_mfma_f32_16x16x32_bf16 v[36:39], v[96:99], v[88:91], v[36:39]
    ds_read_b128 v[68:71], v114 offset:0
    v_mfma_f32_16x16x32_bf16 v[40:43], v[100:103], v[80:83], v[40:43]
    ds_read_b128 v[72:75], v114 offset:1024
    v_mfma_f32_16x16x32_bf16 v[44:47], v[100:103], v[84:87], v[44:47]
    ds_read_b128 v[76:79], v114 offset:2048
    v_mfma_f32_16x16x32_bf16 v[48:51], v[100:103], v[88:91], v[48:51]
    ds_read_b128 v[80:83], v113 offset:0
    ds_read_b128 v[84:87], v113 offset:2048
    ds_read_b128 v[88:91], v113 offset:4096
    ds_read_b128 v[92:95], v114 offset:5120
    ds_read_b128 v[96:99], v114 offset:6144
    ds_read_b128 v[100:103], v114 offset:7168
    s_mov_b32 s48, s43
    s_add_u32 s43, s43, 28672
    s_cmp_eq_u32 s43, 114688
    s_cselect_b32 s43, 0, s43
    s_sub_u32 s48, s43, s48
    s_add_u32 s41, s41, 1
    v_add_u32 v112, s48, v112
    v_add_u32 v113, s48, v113
    v_add_u32 v114, s48, v114
    s_cmp_eq_u32 s41, 4
    s_cbranch_scc0 K2Tc_0L_nh0
    buffer_load_dwordx4 v[116:119], v5, s[56:59], s47 offen offset:0 sc1
    buffer_load_dwordx4 v[120:123], v5, s[56:59], s47 offen offset:64 sc1
    buffer_load_dwordx4 v[124:127], v5, s[56:59], s47 offen offset:128 sc1
K2Tc_0L_nh0:
    s_waitcnt lgkmcnt(0)
    s_cmp_lt_u32 s41, 16
    s_cbranch_scc1 K2Tc_0L_loop
    v_mfma_f32_16x16x32_bf16 v[16:19], v[68:71], v[56:59], v[16:19]
    v_mfma_f32_16x16x32_bf16 v[20:23], v[68:71], v[60:63], v[20:23]
    v_mfma_f32_16x16x32_bf16 v[24:27], v[68:71], v[64:67], v[24:27]
    v_mfma_f32_16x16x32_bf16 v[28:31], v[72:75], v[56:59], v[28:31]
    v_mfma_f32_16x16x32_bf16 v[32:35], v[72:75], v[60:63], v[32:35]
    v_mfma_f32_16x16x32_bf16 v[36:39], v[72:75], v[64:67], v[36:39]
    v_mfma_f32_16x16x32_bf16 v[40:43], v[76:79], v[56:59], v[40:43]
    v_mfma_f32_16x16x32_bf16 v[44:47], v[76:79], v[60:63], v[44:47]
    v_mfma_f32_16x16x32_bf16 v[48:51], v[76:79], v[64:67], v[48:51]
    v_mfma_f32_16x16x32_bf16 v[16:19], v[92:95], v[80:83], v[16:19]
    v_mfma_f32_16x16x32_bf16 v[20:23], v[92:95], v[84:87], v[20:23]
    v_mfma_f32_16x16x32_bf16 v[24:27], v[92:95], v[88:91], v[24:27]
    v_mfma_f32_16x16x32_bf16 v[28:31], v[96:99], v[80:83], v[28:31]
    v_mfma_f32_16x16x32_bf16 v[32:35], v[96:99], v[84:87], v[32:35]
    v_mfma_f32_16x16x32_bf16 v[36:39], v[96:99], v[88:91], v[36:39]
    v_mfma_f32_16x16x32_bf16 v[40:43], v[100:103], v[80:83], v[40:43]
    v_mfma_f32_16x16x32_bf16 v[44:47], v[100:103], v[84:87], v[44:47]
    v_mfma_f32_16x16x32_bf16 v[48:51], v[100:103], v[88:91], v[48:51]
    s_barrier
    s_waitcnt vmcnt(0)
    s_cmp_eq_u32 s36, 0
    s_cselect_b32 s48, 1.0, 0
    v_and_b32 v5, 1, v0
    v_lshlrev_b32 v5, 31, v5
    v_xor_b32 v5, s48, v5
    s_mul_i32 s48, s36, 1474560
    s_add_u32 s50, s6, 0x1000000
    s_addc_u32 s51, s7, 0
    s_add_u32 s50, s50, s48
    s_addc_u32 s51, s51, 0
    s_mov_b32 s24, s50
    s_mov_b32 s25, s51
    s_mov_b32 s26, 0x168000
    s_mov_b32 s27, 0x00020000
    s_mul_i32 s48, s37, 144
    s_mul_i32 s49, s39, 48
    s_add_u32 s48, s48, s49
    s_mul_i32 s48, s48, 1280
    s_mul_i32 s49, s38, 320
    s_add_u32 s48, s48, s49
    s_add_u32 s47, s48, 0
    v_mul_u32_u24 v6, 1280, v6
    v_lshl_add_u32 v6, v7, 4, v6
    v_pk_fma_f32 v[16:17], v[116:117], v[4:5], v[16:17] op_sel:[0,1,0] op_sel_hi:[1,1,1]
    v_pk_fma_f32 v[18:19], v[118:119], v[4:5], v[18:19] op_sel:[0,1,0] op_sel_hi:[1,1,1]
    v_pk_fma_f32 v[20:21], v[116:117], v[4:5], v[20:21] op_sel:[0,1,0] op_sel_hi:[1,1,1]
    v_pk_fma_f32 v[22:23], v[118:119], v[4:5], v[22:23] op_sel:[0,1,0] op_sel_hi:[1,1,1]
    v_pk_fma_f32 v[24:25], v[116:117], v[4:5], v[24:25] op_sel:[0,1,0] op_sel_hi:[1,1,1]
    v_pk_fma_f32 v[26:27], v[118:119], v[4:5], v[26:27] op_sel:[0,1,0] op_sel_hi:[1,1,1]
    s_add_u32 s52, s47, 0
    buffer_store_dwordx4 v[16:19], v6, s[24:27], s52 offen offset:0 sc1
    s_add_u32 s52, s47, 20480
    buffer_store_dwordx4 v[20:23], v6, s[24:27], s52 offen offset:0 sc1
    s_add_u32 s52, s47, 40960
    buffer_store_dwordx4 v[24:27], v6, s[24:27], s52 offen offset:0 sc1
    v_pk_fma_f32 v[28:29], v[120:121], v[4:5], v[28:29] op_sel:[0,1,0] op_sel_hi:[1,1,1]
    v_pk_fma_f32 v[30:31], v[122:123], v[4:5], v[30:31] op_sel:[0,1,0] op_sel_hi:[1,1,1]
    v_pk_fma_f32 v[32:33], v[120:121], v[4:5], v[32:33] op_sel:[0,1,0] op_sel_hi:[1,1,1]
    v_pk_fma_f32 v[34:35], v[122:123], v[4:5], v[34:35] op_sel:[0,1,0] op_sel_hi:[1,1,1]
    v_pk_fma_f32 v[36:37], v[120:121], v[4:5], v[36:37] op_sel:[0,1,0] op_sel_hi:[1,1,1]
    v_pk_fma_f32 v[38:39], v[122:123], v[4:5], v[38:39] op_sel:[0,1,0] op_sel_hi:[1,1,1]
    s_add_u32 s52, s47, 0
    buffer_store_dwordx4 v[28:31], v6, s[24:27], s52 offen offset:64 sc1
    s_add_u32 s52, s47, 20480
    buffer_store_dwordx4 v[32:35], v6, s[24:27], s52 offen offset:64 sc1
    s_add_u32 s52, s47, 40960
    buffer_store_dwordx4 v[36:39], v6, s[24:27], s52 offen offset:64 sc1
    v_pk_fma_f32 v[40:41], v[124:125], v[4:5], v[40:41] op_sel:[0,1,0] op_sel_hi:[1,1,1]
    v_pk_fma_f32 v[42:43], v[126:127], v[4:5], v[42:43] op_sel:[0,1,0] op_sel_hi:[1,1,1]
    v_pk_fma_f32 v[44:45], v[124:125], v[4:5], v[44:45] op_sel:[0,1,0] op_sel_hi:[1,1,1]
    v_pk_fma_f32 v[46:47], v[126:127], v[4:5], v[46:47] op_sel:[0,1,0] op_sel_hi:[1,1,1]
    v_pk_fma_f32 v[48:49], v[124:125], v[4:5], v[48:49] op_sel:[0,1,0] op_sel_hi:[1,1,1]
    v_pk_fma_f32 v[50:51], v[126:127], v[4:5], v[50:51] op_sel:[0,1,0] op_sel_hi:[1,1,1]
    s_add_u32 s52, s47, 0
    buffer_store_dwordx4 v[40:43], v6, s[24:27], s52 offen offset:128 sc1
    s_add_u32 s52, s47, 20480
    buffer_store_dwordx4 v[44:47], v6, s[24:27], s52 offen offset:128 sc1
    s_add_u32 s52, s47, 40960
    buffer_store_dwordx4 v[48:51], v6, s[24:27], s52 offen offset:128 sc1
    s_branch K2_end
K2Tc_1:
    s_mov_b32 s41, 0
    s_mov_b32 s43, 0
    s_barrier
    s_barrier
K2Tc_1L_loop:
    s_setprio 1
    ds_read_b128 v[56:59], v112 offset:0
    ds_read_b128 v[60:63], v112 offset:2048
    ds_read_b128 v[64:67], v112 offset:4096
    ds_read_b128 v[68:71], v114 offset:0
    ds_read_b128 v[72:75], v114 offset:1024
    ds_read_b128 v[80:83], v113 offset:0
    ds_read_b128 v[84:87], v113 offset:2048
    ds_read_b128 v[88:91], v113 offset:4096
    ds_read_b128 v[92:95], v114 offset:5120
    ds_read_b128 v[96:99], v114 offset:6144
    s_setprio 0
    s_mov_b32 s48, s43
    s_add_u32 s43, s43, 28672
    s_cmp_eq_u32 s43, 114688
    s_cselect_b32 s43, 0, s43
    s_sub_u32 s48, s43, s48
    s_add_u32 s41, s41, 1
    v_add_u32 v112, s48, v112
    v_add_u32 v113, s48, v113
    v_add_u32 v114, s48, v114
    s_cmp_eq_u32 s41, 4
    s_cbranch_scc0 K2Tc_1L_nh0
    buffer_load_dwordx4 v[116:119], v5, s[56:59], s47 offen offset:0 sc1
    buffer_load_dwordx4 v[120:123], v5, s[56:59], s47 offen offset:64 sc1
K2Tc_1L_nh0:
    s_waitcnt lgkmcnt(5)
    v_mfma_f32_16x16x32_bf16 v[16:19], v[68:71], v[56:59], v[16:19]
    v_mfma_f32_16x16x32_bf16 v[20:23], v[68:71], v[60:63], v[20:23]
    v_mfma_f32_16x16x32_bf16 v[24:27], v[68:71], v[64:67], v[24:27]
    v_mfma_f32_16x16x32_bf16 v[28:31], v[72:75], v[56:59], v[28:31]
    v_mfma_f32_16x16x32_bf16 v[32:35], v[72:75], v[60:63], v[32:35]
    v_mfma_f32_16x16x32_bf16 v[36:39], v[72:75], v[64:67], v[36:39]
    s_waitcnt lgkmcnt(0)
    v_mfma_f32_16x16x32_bf16 v[16:19], v[92:95], v[80:83], v[16:19]
    v_mfma_f32_16x16x32_bf16 v[20:23], v[92:95], v[84:87], v[20:23]
    v_mfma_f32_16x16x32_bf16 v[24:27], v[92:95], v[88:91], v[24:27]
    v_mfma_f32_16x16x32_bf16 v[28:31], v[96:99], v[80:83], v[28:31]
    v_mfma_f32_16x16x32_bf16 v[32:35], v[96:99], v[84:87], v[32:35]
    v_mfma_f32_16x16x32_bf16 v[36:39], v[96:99], v[88:91], v[36:39]
    s_cmp_lt_u32 s41, 16
    s_cbranch_scc0 K2Tc_1L_done
    s_barrier
    s_branch K2Tc_1L_loop
K2Tc_1L_done:
    s_barrier
    s_waitcnt vmcnt(0)
    s_cmp_eq_u32 s36, 0
    s_cselect_b32 s48, 1.0, 0
    v_and_b32 v5, 1, v0
    v_lshlrev_b32 v5, 31, v5
    v_xor_b32 v5, s48, v5
    s_mul_i32 s48, s36, 1474560
    s_add_u32 s50, s6, 0x1000000
    s_addc_u32 s51, s7, 0
    s_add_u32 s50, s50, s48
    s_addc_u32 s51, s51, 0
    s_mov_b32 s24, s50
    s_mov_b32 s25, s51
    s_mov_b32 s26, 0x168000
    s_mov_b32 s27, 0x00020000
    s_mul_i32 s48, s37, 144
    s_mul_i32 s49, s39, 48
    s_add_u32 s48, s48, s49
    s_mul_i32 s48, s48, 1280
    s_mul_i32 s49, s38, 320
    s_add_u32 s48, s48, s49
    s_add_u32 s47, s48, 192
    v_mul_u32_u24 v6, 1280, v6
    v_lshl_add_u32 v6, v7, 4, v6
    v_pk_fma_f32 v[16:17], v[116:117], v[4:5], v[16:17] op_sel:[0,1,0] op_sel_hi:[1,1,1]
    v_pk_fma_f32 v[18:19], v[118:119], v[4:5], v[18:19] op_sel:[0,1,0] op_sel_hi:[1,1,1]
    v_pk_fma_f32 v[20:21], v[116:117], v[4:5], v[20:21] op_sel:[0,1,0] op_sel_hi:[1,1,1]
    v_pk_fma_f32 v[22:23], v[118:119], v[4:5], v[22:23] op_sel:[0,1,0] op_sel_hi:[1,1,1]
    v_pk_fma_f32 v[24:25], v[116:117], v[4:5], v[24:25] op_sel:[0,1,0] op_sel_hi:[1,1,1]
    v_pk_fma_f32 v[26:27], v[118:119], v[4:5], v[26:27] op_sel:[0,1,0] op_sel_hi:[1,1,1]
    s_add_u32 s52, s47, 0
    buffer_store_dwordx4 v[16:19], v6, s[24:27], s52 offen offset:0 sc1
    s_add_u32 s52, s47, 20480
    buffer_store_dwordx4 v[20:23], v6, s[24:27], s52 offen offset:0 sc1
    s_add_u32 s52, s47, 40960
    buffer_store_dwordx4 v[24:27], v6, s[24:27], s52 offen offset:0 sc1
    v_pk_fma_f32 v[28:29], v[120:121], v[4:5], v[28:29] op_sel:[0,1,0] op_sel_hi:[1,1,1]
    v_pk_fma_f32 v[30:31], v[122:123], v[4:5], v[30:31] op_sel:[0,1,0] op_sel_hi:[1,1,1]
    v_pk_fma_f32 v[32:33], v[120:121], v[4:5], v[32:33] op_sel:[0,1,0] op_sel_hi:[1,1,1]
    v_pk_fma_f32 v[34:35], v[122:123], v[4:5], v[34:35] op_sel:[0,1,0] op_sel_hi:[1,1,1]
    v_pk_fma_f32 v[36:37], v[120:121], v[4:5], v[36:37] op_sel:[0,1,0] op_sel_hi:[1,1,1]
    v_pk_fma_f32 v[38:39], v[122:123], v[4:5], v[38:39] op_sel:[0,1,0] op_sel_hi:[1,1,1]
    s_add_u32 s52, s47, 0
    buffer_store_dwordx4 v[28:31], v6, s[24:27], s52 offen offset:64 sc1
    s_add_u32 s52, s47, 20480
    buffer_store_dwordx4 v[32:35], v6, s[24:27], s52 offen offset:64 sc1
    s_add_u32 s52, s47, 40960
    buffer_store_dwordx4 v[36:39], v6, s[24:27], s52 offen offset:64 sc1
    s_branch K2_end
K2T_xpf:
    s_barrier
    s_barrier
    s_barrier
    s_barrier
    s_barrier
    s_barrier
    s_barrier
    s_barrier
    s_barrier
    s_barrier
    s_barrier
    s_barrier
    s_barrier
    s_barrier
    s_barrier
    s_barrier
    s_barrier
    s_barrier
    s_branch K2_end
K2T_prod:
    s_sub_u32 s39, s32, 8
    v_lshrrev_b32 v20, 3, v0
    v_and_b32 v22, 7, v0
    v_xor_b32 v22, v22, v20
    v_lshlrev_b32 v22, 4, v22
    v_lshl_add_u32 v2, v20, 12, v22
    s_lshl_b32 s48, s39, 1
    s_sub_u32 s48, s48, 2
    s_add_u32 s49, s39, 2
    s_cmp_lt_u32 s39, 4
    s_cselect_b32 s53, s48, s49
    s_cmp_lt_u32 s39, 2
    s_cselect_b32 s53, s39, s53
    s_lshl_b32 s53, s53, 10
    v_lshlrev_b32 v20, 4, v0
    v_add_u32 v3, s53, v20
    s_mov_b32 s42, 0
    s_mul_i32 s48, s38, 0
    s_and_b32 s49, s37, 1
    s_mul_i32 s49, s49, 0
    s_add_u32 s48, s48, s49
    s_and_b32 s48, s48, 15
    s_lshl_b32 s44, s48, 7
    s_mul_i32 s45, s48, 10240
    s_mul_i32 s48, s36, 655360
    s_mul_i32 s49, s38, 163840
    s_add_u32 s52, s48, s49
    s_mul_i32 s48, s37, 589824
    s_waitcnt lgkmcnt(0)
    s_cmp_eq_u32 s36, 0
    s_cselect_b32 s50, s8, s10
    s_cselect_b32 s51, s9, s11
    s_add_u32 s50, s50, s48
    s_addc_u32 s51, s51, 0
    s_mov_b32 s16, s50
    s_mov_b32 s17, s51
    s_mov_b32 s18, 0x90000
    s_mov_b32 s19, 0x00020000
    s_add_u32 s50, s6, 0x780000
    s_addc_u32 s51, s7, 0
    s_add_u32 s50, s50, s52
    s_addc_u32 s51, s51, 0
    s_mov_b32 s20, s50
    s_mov_b32 s21, s51
    s_mov_b32 s22, 0x28000
    s_mov_b32 s23, 0x00020000
    s_lshl_b32 s46, s39, 10
    s_add_u32 s46, s46, 0
    s_lshl_b32 s48, s39, 15
    s_add_u32 s48, s48, s44
    s_add_u32 m0, s46, 0
    s_add_u32 s47, s48, 0
    buffer_load_dwordx4 v2, s[16:19], s47 offen lds
    s_add_u32 m0, s46, 8192
    s_add_u32 s47, s48, 262144
    buffer_load_dwordx4 v2, s[16:19], s47 offen lds
    s_cmp_lt_u32 s39, 2
    s_cbranch_scc0 K2Tp_w_81
    s_add_u32 m0, s46, 16384
    s_add_u32 s47, s48, 524288
    buffer_load_dwordx4 v2, s[16:19], s47 offen lds
K2Tp_w_81:
    s_add_u32 s44, s44, 128
    s_lshl_b32 s46, s39, 10
    s_add_u32 s46, s46, 28672
    s_lshl_b32 s48, s39, 15
    s_add_u32 s48, s48, s44
    s_add_u32 m0, s46, 0
    s_add_u32 s47, s48, 0
    buffer_load_dwordx4 v2, s[16:19], s47 offen lds
    s_add_u32 m0, s46, 8192
    s_add_u32 s47, s48, 262144
    buffer_load_dwordx4 v2, s[16:19], s47 offen lds
    s_cmp_lt_u32 s39, 2
    s_cbranch_scc0 K2Tp_w_82
    s_add_u32 m0, s46, 16384
    s_add_u32 s47, s48, 524288
    buffer_load_dwordx4 v2, s[16:19], s47 offen lds
K2Tp_w_82:
    s_add_u32 s44, s44, 128
    s_lshl_b32 s46, s39, 10
    s_add_u32 s46, s46, 57344
    s_lshl_b32 s48, s39, 15
    s_add_u32 s48, s48, s44
    s_add_u32 m0, s46, 0
    s_add_u32 s47, s48, 0
    buffer_load_dwordx4 v2, s[16:19], s47 offen lds
    s_add_u32 m0, s46, 8192
    s_add_u32 s47, s48, 262144
    buffer_load_dwordx4 v2, s[16:19], s47 offen lds
    s_cmp_lt_u32 s39, 2
    s_cbranch_scc0 K2Tp_w_83
    s_add_u32 m0, s46, 16384
    s_add_u32 s47, s48, 524288
    buffer_load_dwordx4 v2, s[16:19], s47 offen lds
K2Tp_w_83:
    s_add_u32 s44, s44, 128
    s_lshl_b32 s46, s39, 10
    s_add_u32 s46, s46, 86016
    s_lshl_b32 s48, s39, 15
    s_add_u32 s48, s48, s44
    s_add_u32 m0, s46, 0
    s_add_u32 s47, s48, 0
    buffer_load_dwordx4 v2, s[16:19], s47 offen lds
    s_add_u32 m0, s46, 8192
    s_add_u32 s47, s48, 262144
    buffer_load_dwordx4 v2, s[16:19], s47 offen lds
    s_cmp_lt_u32 s39, 2
    s_cbranch_scc0 K2Tp_w_84
    s_add_u32 m0, s46, 16384
    s_add_u32 s47, s48, 524288
    buffer_load_dwordx4 v2, s[16:19], s47 offen lds
K2Tp_w_84:
    s_add_u32 s44, s44, 128
    s_cmp_eq_u32 s32, 8
    s_cbranch_scc0 K2Tp_np
    s_add_u32 s88, s6, 0x8cc000
    s_addc_u32 s89, s7, 0
    s_mov_b32 s92, s88
    s_mov_b32 s93, s89
    s_mov_b32 s94, 0x2000
    s_mov_b32 s95, 0x00020000
    s_and_b32 s88, s2, 7
    s_lshr_b32 s89, s2, 3
    v_mov_b32 v31, 0x7fffff00
    s_cmp_ge_u32 s89, 24
    s_cbranch_scc1 K2Tp_dp_t
    s_mul_i32 s90, s89, 43
    s_lshr_b32 s90, s90, 8
    s_mul_i32 s90, s90, 6
    s_sub_u32 s90, s89, s90
    s_cmp_ge_u32 s90, 3
    s_cselect_b32 s91, 1, 0
    s_cselect_b32 s89, 3, 0
    s_sub_u32 s90, s90, s89
    s_lshl_b32 s90, s90, 1
    v_lshrrev_b32 v28, 3, v0
    v_lshlrev_b32 v28, 1, v28
    v_add_u32 v28, s91, v28
    v_bfe_u32 v29, v0, 1, 2
    v_mul_u32_u24 v29, 6, v29
    v_and_b32 v30, 1, v0
    v_add_u32 v29, v29, v30
    v_add_u32 v29, s90, v29
    v_lshl_add_u32 v28, v29, 3, v28
    v_cmp_gt_u32 vcc, 32, v0
    s_branch K2Tp_dp_go
K2Tp_dp_t:
    s_sub_u32 s89, s89, 24
    s_and_b32 s89, s89, 3
    s_lshr_b32 s89, s89, 1
    s_add_u32 s89, s89, 24
    s_and_b32 s88, s88, 1
    v_lshrrev_b32 v28, 2, v0
    v_lshlrev_b32 v28, 1, v28
    v_add_u32 v28, s88, v28
    v_and_b32 v29, 3, v0
    v_lshlrev_b32 v29, 1, v29
    v_add_u32 v29, s89, v29
    v_lshl_add_u32 v28, v29, 3, v28
    v_cmp_gt_u32 vcc, 16, v0
K2Tp_dp_go:
    v_lshlrev_b32 v28, 5, v28
    s_nop 1
    v_cndmask_b32 v28, v31, v28, vcc
    v_cndmask_b32_e64 v27, 1, 0, vcc
    s_mov_b32 s90, 0
    buffer_load_dword v25, v28, s[92:95], 0 offen sc1
K2Tp_dp_lp:
    buffer_load_dword v23, v28, s[92:95], 0 offen sc1
    s_waitcnt vmcnt(1)
    v_or_b32 v25, v25, v27
    v_cmp_ne_u32 vcc, 1, v25
    s_nop 1
    s_cmp_eq_u64 vcc, 0
    s_cbranch_scc1 K2Tp_dp_ok
    buffer_load_dword v21, v28, s[92:95], 0 offen sc1
    s_waitcnt vmcnt(1)
    v_or_b32 v23, v23, v27
    v_cmp_ne_u32 vcc, 1, v23
    s_nop 1
    s_cmp_eq_u64 vcc, 0
    s_cbranch_scc1 K2Tp_dp_ok
    buffer_load_dword v25, v28, s[92:95], 0 offen sc1
    s_waitcnt vmcnt(1)
    v_or_b32 v21, v21, v27
    v_cmp_ne_u32 vcc, 1, v21
    s_nop 1
    s_cmp_eq_u64 vcc, 0
    s_cbranch_scc1 K2Tp_dp_ok
    s_add_u32 s90, s90, 1
    s_cmp_lt_u32 s90, 2000
    s_cbranch_scc1 K2Tp_dp_lp
K2Tp_dp_ok:
    s_waitcnt vmcnt(0)
K2Tp_np:
    s_barrier
    s_add_u32 m0, s53, 18432
    s_nop 0
    buffer_load_dwordx4 v3, s[20:23], s45 offen sc1 lds
    s_cmp_lt_u32 s39, 2
    s_cbranch_scc1 K2Tp_e_85
    s_cmp_lt_u32 s39, 4
    s_cbranch_scc0 K2Tp_e_85
    buffer_load_dwordx4 v3, s[20:23], s45 offen offset:1024 sc1 lds
K2Tp_e_85:
    s_add_u32 s45, s45, 10240
    s_add_u32 m0, s53, 47104
    s_nop 0
    buffer_load_dwordx4 v3, s[20:23], s45 offen sc1 lds
    s_cmp_lt_u32 s39, 2
    s_cbranch_scc1 K2Tp_e_86
    s_cmp_lt_u32 s39, 4
    s_cbranch_scc0 K2Tp_e_86
    buffer_load_dwordx4 v3, s[20:23], s45 offen offset:1024 sc1 lds
K2Tp_e_86:
    s_add_u32 s45, s45, 10240
    s_waitcnt vmcnt(1)
    s_barrier
    s_add_u32 m0, s53, 75776
    s_nop 0
    buffer_load_dwordx4 v3, s[20:23], s45 offen sc1 lds
    s_cmp_lt_u32 s39, 2
    s_cbranch_scc1 K2Tp_e_87
    s_cmp_lt_u32 s39, 4
    s_cbranch_scc0 K2Tp_e_87
    buffer_load_dwordx4 v3, s[20:23], s45 offen offset:1024 sc1 lds
K2Tp_e_87:
    s_add_u32 s45, s45, 10240
    s_add_u32 m0, s53, 104448
    s_nop 0
    buffer_load_dwordx4 v3, s[20:23], s45 offen sc1 lds
    s_cmp_lt_u32 s39, 2
    s_cbranch_scc1 K2Tp_e_88
    s_cmp_lt_u32 s39, 4
    s_cbranch_scc0 K2Tp_e_88
    buffer_load_dwordx4 v3, s[20:23], s45 offen offset:1024 sc1 lds
K2Tp_e_88:
    s_add_u32 s45, s45, 10240
    s_waitcnt vmcnt(2)
    s_barrier
    s_lshl_b32 s46, s39, 10
    s_add_u32 s46, s46, s42
    s_lshl_b32 s48, s39, 15
    s_add_u32 s48, s48, s44
    s_add_u32 m0, s46, 0
    s_add_u32 s47, s48, 0
    buffer_load_dwordx4 v2, s[16:19], s47 offen lds
    s_add_u32 m0, s46, 8192
    s_add_u32 s47, s48, 262144
    buffer_load_dwordx4 v2, s[16:19], s47 offen lds
    s_add_u32 s49, s42, s53
    s_add_u32 m0, s49, 18432
    s_nop 0
    buffer_load_dwordx4 v3, s[20:23], s45 offen sc1 lds
    s_cmp_lt_u32 s39, 2
    s_cbranch_scc1 K2Tp_a_89
    s_cmp_lt_u32 s39, 4
    s_cbranch_scc0 K2Tp_b_90
    buffer_load_dwordx4 v3, s[20:23], s45 offen offset:1024 sc1 lds
    s_branch K2Tp_b_90
K2Tp_a_89:
    s_add_u32 m0, s46, 16384
    s_add_u32 s47, s48, 524288
    buffer_load_dwordx4 v2, s[16:19], s47 offen lds
K2Tp_b_90:
    s_add_u32 s42, s42, 28672
    s_cmp_eq_u32 s42, 114688
    s_cselect_b32 s42, 0, s42
    s_add_u32 s44, s44, 128
    s_add_u32 s45, s45, 10240
    s_cmp_eq_u32 s44, 2048
    s_cselect_b32 s44, 0, s44
    s_cselect_b32 s45, 0, s45
    s_waitcnt vmcnt(4)
    s_barrier
    s_lshl_b32 s46, s39, 10
    s_add_u32 s46, s46, s42
    s_lshl_b32 s48, s39, 15
    s_add_u32 s48, s48, s44
    s_add_u32 m0, s46, 0
    s_add_u32 s47, s48, 0
    buffer_load_dwordx4 v2, s[16:19], s47 offen lds
    s_add_u32 m0, s46, 8192
    s_add_u32 s47, s48, 262144
    buffer_load_dwordx4 v2, s[16:19], s47 offen lds
    s_add_u32 s49, s42, s53
    s_add_u32 m0, s49, 18432
    s_nop 0
    buffer_load_dwordx4 v3, s[20:23], s45 offen sc1 lds
    s_cmp_lt_u32 s39, 2
    s_cbranch_scc1 K2Tp_a_91
    s_cmp_lt_u32 s39, 4
    s_cbranch_scc0 K2Tp_b_92
    buffer_load_dwordx4 v3, s[20:23], s45 offen offset:1024 sc1 lds
    s_branch K2Tp_b_92
K2Tp_a_91:
    s_add_u32 m0, s46, 16384
    s_add_u32 s47, s48, 524288
    buffer_load_dwordx4 v2, s[16:19], s47 offen lds
K2Tp_b_92:
    s_add_u32 s42, s42, 28672
    s_cmp_eq_u32 s42, 114688
    s_cselect_b32 s42, 0, s42
    s_add_u32 s44, s44, 128
    s_add_u32 s45, s45, 10240
    s_cmp_eq_u32 s44, 2048
    s_cselect_b32 s44, 0, s44
    s_cselect_b32 s45, 0, s45
    s_waitcnt vmcnt(6)
    s_barrier
    s_lshl_b32 s46, s39, 10
    s_add_u32 s46, s46, s42
    s_lshl_b32 s48, s39, 15
    s_add_u32 s48, s48, s44
    s_add_u32 m0, s46, 0
    s_add_u32 s47, s48, 0
    buffer_load_dwordx4 v2, s[16:19], s47 offen lds
    s_add_u32 m0, s46, 8192
    s_add_u32 s47, s48, 262144
    buffer_load_dwordx4 v2, s[16:19], s47 offen lds
    s_add_u32 s49, s42, s53
    s_add_u32 m0, s49, 18432
    s_nop 0
    buffer_load_dwordx4 v3, s[20:23], s45 offen sc1 lds
    s_cmp_lt_u32 s39, 2
    s_cbranch_scc1 K2Tp_a_93
    s_cmp_lt_u32 s39, 4
    s_cbranch_scc0 K2Tp_b_94
    buffer_load_dwordx4 v3, s[20:23], s45 offen offset:1024 sc1 lds
    s_branch K2Tp_b_94
K2Tp_a_93:
    s_add_u32 m0, s46, 16384
    s_add_u32 s47, s48, 524288
    buffer_load_dwordx4 v2, s[16:19], s47 offen lds
K2Tp_b_94:
    s_add_u32 s42, s42, 28672
    s_cmp_eq_u32 s42, 114688
    s_cselect_b32 s42, 0, s42
    s_add_u32 s44, s44, 128
    s_add_u32 s45, s45, 10240
    s_cmp_eq_u32 s44, 2048
    s_cselect_b32 s44, 0, s44
    s_cselect_b32 s45, 0, s45
    s_mov_b32 s41, 9
K2Tp_loop:
    s_waitcnt vmcnt(6)
    s_barrier
    s_lshl_b32 s46, s39, 10
    s_add_u32 s46, s46, s42
    s_lshl_b32 s48, s39, 15
    s_add_u32 s48, s48, s44
    s_add_u32 m0, s46, 0
    s_add_u32 s47, s48, 0
    buffer_load_dwordx4 v2, s[16:19], s47 offen lds
    s_add_u32 m0, s46, 8192
    s_add_u32 s47, s48, 262144
    buffer_load_dwordx4 v2, s[16:19], s47 offen lds
    s_add_u32 s49, s42, s53
    s_add_u32 m0, s49, 18432
    s_nop 0
    buffer_load_dwordx4 v3, s[20:23], s45 offen sc1 lds
    s_cmp_lt_u32 s39, 2
    s_cbranch_scc1 K2Tp_a_95
    s_cmp_lt_u32 s39, 4
    s_cbranch_scc0 K2Tp_b_96
    buffer_load_dwordx4 v3, s[20:23], s45 offen offset:1024 sc1 lds
    s_branch K2Tp_b_96
K2Tp_a_95:
    s_add_u32 m0, s46, 16384
    s_add_u32 s47, s48, 524288
    buffer_load_dwordx4 v2, s[16:19], s47 offen lds
K2Tp_b_96:
    s_add_u32 s42, s42, 28672
    s_cmp_eq_u32 s42, 114688
    s_cselect_b32 s42, 0, s42
    s_add_u32 s44, s44, 128
    s_add_u32 s45, s45, 10240
    s_cmp_eq_u32 s44, 2048
    s_cselect_b32 s44, 0, s44
    s_cselect_b32 s45, 0, s45
    s_sub_u32 s41, s41, 1
    s_cmp_lg_u32 s41, 0
    s_cbranch_scc1 K2Tp_loop
    s_waitcnt vmcnt(6)
    s_barrier
    s_waitcnt vmcnt(3)
    s_barrier
    s_waitcnt vmcnt(0)
    s_barrier
    s_barrier
    s_branch K2_end
K2_end:
    s_waitcnt vmcnt(0) lgkmcnt(0)
    s_barrier
    s_cmp_eq_u32 s32, 0
    s_cbranch_scc0 K2_fl
    s_add_u32 s88, s6, 0x8ce000
    s_addc_u32 s89, s7, 0
    s_mov_b32 s92, s88
    s_mov_b32 s93, s89
    s_mov_b32 s94, 0x2000
    s_mov_b32 s95, 0x00020000
    s_lshl_b32 s88, s2, 5
    v_mov_b32 v2, 1
    v_mov_b32 v3, 0
    s_mov_b32 exec_lo, 1
    s_mov_b32 exec_hi, 0
    buffer_store_dword v2, v3, s[92:95], s88 offen sc1
    s_mov_b64 exec, -1
K2_fl:
    s_setprio 0
K3_entry:
    s_load_dwordx2 s[4:5], s[0:1], 0
    s_load_dwordx4 s[8:11], s[0:1], 72
    s_load_dwordx2 s[6:7], s[0:1], 96
    s_and_b32 s33, s2, 7
    s_lshr_b32 s34, s2, 3
    s_lshr_b32 s48, s34, 3
    s_lshl_b32 s37, s33, 2
    s_add_u32 s37, s37, s48
    s_and_b32 s38, s34, 7
    s_cmp_ge_u32 s32, 8
    s_cbranch_scc1 K3_prod
    s_and_b32 s39, s32, 3
    s_lshr_b32 s40, s32, 2
    v_and_b32 v6, 15, v0
    v_lshrrev_b32 v7, 4, v0
    s_lshl_b32 s48, s37, 6
    s_lshl_b32 s49, s39, 4
    s_add_u32 s48, s48, s49
    v_add_u32 v8, s48, v6
    s_mul_i32 s48, s38, 80
    s_mul_i32 s49, s40, 48
    s_add_u32 s51, s48, s49
    v_lshlrev_b32 v9, 2, v7
    v_add_u32 v9, s51, v9
    v_mul_u32_u24 v10, 1280, v8
    v_lshl_add_u32 v10, v9, 1, v10
    s_mul_i32 s48, s39, 3072
    v_lshlrev_b32 v12, 3, v0
    v_add_u32 v93, s48, v12
    v_lshrrev_b32 v12, 2, v6
    v_lshl_add_u32 v12, v7, 2, v12
    v_mul_u32_u24 v12, 160, v12
    v_and_b32 v13, 3, v6
    v_lshl_add_u32 v12, v13, 3, v12
    s_mul_i32 s48, s40, 96
    s_add_u32 s48, s48, 24576
    v_add_u32 v92, s48, v12
    v_mov_b32 v16, 0
    v_mov_b32 v17, 0
    v_mov_b32 v18, 0
    v_mov_b32 v19, 0
    v_mov_b32 v20, 0
    v_mov_b32 v21, 0
    v_mov_b32 v22, 0
    v_mov_b32 v23, 0
    v_mov_b32 v24, 0
    v_mov_b32 v25, 0
    v_mov_b32 v26, 0
    v_mov_b32 v27, 0
    s_waitcnt lgkmcnt(0)
    s_cmp_eq_u32 s40, 0
    s_cbranch_scc0 K3c_1
K3c_0:
    s_mov_b32 s41, 0
    s_mov_b32 s43, 0
    s_barrier
    s_barrier
    ds_read_b64 v[32:33], v93 offset:0
    ds_read_b64 v[34:35], v93 offset:512
    ds_read_b64 v[36:37], v93 offset:12288
    ds_read_b64 v[38:39], v93 offset:12800
    ds_read_b64_tr_b16 v[40:41], v92 offset:0
    ds_read_b64_tr_b16 v[42:43], v92 offset:2560
    ds_read_b64_tr_b16 v[44:45], v92 offset:32
    ds_read_b64_tr_b16 v[46:47], v92 offset:2592
    ds_read_b64_tr_b16 v[48:49], v92 offset:64
    ds_read_b64_tr_b16 v[50:51], v92 offset:2624
    ds_read_b64 v[52:53], v93 offset:1024
    ds_read_b64 v[54:55], v93 offset:1536
    ds_read_b64 v[56:57], v93 offset:13312
    ds_read_b64 v[58:59], v93 offset:13824
    ds_read_b64_tr_b16 v[60:61], v92 offset:5120
    ds_read_b64_tr_b16 v[62:63], v92 offset:7680
    ds_read_b64_tr_b16 v[64:65], v92 offset:5152
    ds_read_b64_tr_b16 v[66:67], v92 offset:7712
    ds_read_b64_tr_b16 v[68:69], v92 offset:5184
    ds_read_b64_tr_b16 v[70:71], v92 offset:7744
    ds_read_b64 v[72:73], v93 offset:2048
    ds_read_b64 v[74:75], v93 offset:2560
    ds_read_b64 v[76:77], v93 offset:14336
    ds_read_b64 v[78:79], v93 offset:14848
    ds_read_b64_tr_b16 v[80:81], v92 offset:10240
    ds_read_b64_tr_b16 v[82:83], v92 offset:12800
    ds_read_b64_tr_b16 v[84:85], v92 offset:10272
    ds_read_b64_tr_b16 v[86:87], v92 offset:12832
    ds_read_b64_tr_b16 v[88:89], v92 offset:10304
    ds_read_b64_tr_b16 v[90:91], v92 offset:12864
    s_mov_b32 s48, s43
    s_add_u32 s43, s43, 39936
    s_cmp_eq_u32 s43, 159744
    s_cselect_b32 s43, 0, s43
    s_sub_u32 s48, s43, s48
    s_add_u32 s41, s41, 1
    v_add_u32 v92, s48, v92
    v_add_u32 v93, s48, v93
    s_waitcnt lgkmcnt(0)
K3c_0L_loop:
    s_barrier
    v_mfma_f32_16x16x32_bf16 v[16:19], v[40:43], v[32:35], v[16:19]
    v_mfma_f32_16x16x32_bf16 v[20:23], v[44:47], v[32:35], v[20:23]
    v_mfma_f32_16x16x32_bf16 v[24:27], v[48:51], v[32:35], v[24:27]
    v_mfma_f32_16x16x32_bf16 v[16:19], v[40:43], v[36:39], v[16:19]
    v_mfma_f32_16x16x32_bf16 v[20:23], v[44:47], v[36:39], v[20:23]
    v_mfma_f32_16x16x32_bf16 v[24:27], v[48:51], v[36:39], v[24:27]
    ds_read_b64 v[32:33], v93 offset:0
    ds_read_b64 v[34:35], v93 offset:512
    v_mfma_f32_16x16x32_bf16 v[16:19], v[60:63], v[52:55], v[16:19]
    ds_read_b64 v[36:37], v93 offset:12288
    ds_read_b64 v[38:39], v93 offset:12800
    v_mfma_f32_16x16x32_bf16 v[20:23], v[64:67], v[52:55], v[20:23]
    ds_read_b64_tr_b16 v[40:41], v92 offset:0
    ds_read_b64_tr_b16 v[42:43], v92 offset:2560
    v_mfma_f32_16x16x32_bf16 v[24:27], v[68:71], v[52:55], v[24:27]
    ds_read_b64_tr_b16 v[44:45], v92 offset:32
    ds_read_b64_tr_b16 v[46:47], v92 offset:2592
    v_mfma_f32_16x16x32_bf16 v[16:19], v[60:63], v[56:59], v[16:19]
    ds_read_b64_tr_b16 v[48:49], v92 offset:64
    ds_read_b64_tr_b16 v[50:51], v92 offset:2624
    v_mfma_f32_16x16x32_bf16 v[20:23], v[64:67], v[56:59], v[20:23]
    v_mfma_f32_16x16x32_bf16 v[24:27], v[68:71], v[56:59], v[24:27]
    ds_read_b64 v[52:53], v93 offset:1024
    ds_read_b64 v[54:55], v93 offset:1536
    v_mfma_f32_16x16x32_bf16 v[16:19], v[80:83], v[72:75], v[16:19]
    ds_read_b64 v[56:57], v93 offset:13312
    ds_read_b64 v[58:59], v93 offset:13824
    v_mfma_f32_16x16x32_bf16 v[20:23], v[84:87], v[72:75], v[20:23]
    ds_read_b64_tr_b16 v[60:61], v92 offset:5120
    ds_read_b64_tr_b16 v[62:63], v92 offset:7680
    v_mfma_f32_16x16x32_bf16 v[24:27], v[88:91], v[72:75], v[24:27]
    ds_read_b64_tr_b16 v[64:65], v92 offset:5152
    ds_read_b64_tr_b16 v[66:67], v92 offset:7712
    v_mfma_f32_16x16x32_bf16 v[16:19], v[80:83], v[76:79], v[16:19]
    ds_read_b64_tr_b16 v[68:69], v92 offset:5184
    ds_read_b64_tr_b16 v[70:71], v92 offset:7744
    v_mfma_f32_16x16x32_bf16 v[20:23], v[84:87], v[76:79], v[20:23]
    v_mfma_f32_16x16x32_bf16 v[24:27], v[88:91], v[76:79], v[24:27]
    ds_read_b64 v[72:73], v93 offset:2048
    ds_read_b64 v[74:75], v93 offset:2560
    ds_read_b64 v[76:77], v93 offset:14336
    ds_read_b64 v[78:79], v93 offset:14848
    ds_read_b64_tr_b16 v[80:81], v92 offset:10240
    ds_read_b64_tr_b16 v[82:83], v92 offset:12800
    ds_read_b64_tr_b16 v[84:85], v92 offset:10272
    ds_read_b64_tr_b16 v[86:87], v92 offset:12832
    ds_read_b64_tr_b16 v[88:89], v92 offset:10304
    ds_read_b64_tr_b16 v[90:91], v92 offset:12864
    s_mov_b32 s48, s43
    s_add_u32 s43, s43, 39936
    s_cmp_eq_u32 s43, 159744
    s_cselect_b32 s43, 0, s43
    s_sub_u32 s48, s43, s48
    s_add_u32 s41, s41, 1
    v_add_u32 v92, s48, v92
    v_add_u32 v93, s48, v93
    s_waitcnt lgkmcnt(0)
    s_cmp_lt_u32 s41, 9
    s_cbranch_scc1 K3c_0L_loop
    v_mfma_f32_16x16x32_bf16 v[16:19], v[40:43], v[32:35], v[16:19]
    v_mfma_f32_16x16x32_bf16 v[20:23], v[44:47], v[32:35], v[20:23]
    v_mfma_f32_16x16x32_bf16 v[24:27], v[48:51], v[32:35], v[24:27]
    v_mfma_f32_16x16x32_bf16 v[16:19], v[40:43], v[36:39], v[16:19]
    v_mfma_f32_16x16x32_bf16 v[20:23], v[44:47], v[36:39], v[20:23]
    v_mfma_f32_16x16x32_bf16 v[24:27], v[48:51], v[36:39], v[24:27]
    v_mfma_f32_16x16x32_bf16 v[16:19], v[60:63], v[52:55], v[16:19]
    v_mfma_f32_16x16x32_bf16 v[20:23], v[64:67], v[52:55], v[20:23]
    v_mfma_f32_16x16x32_bf16 v[24:27], v[68:71], v[52:55], v[24:27]
    v_mfma_f32_16x16x32_bf16 v[16:19], v[60:63], v[56:59], v[16:19]
    v_mfma_f32_16x16x32_bf16 v[20:23], v[64:67], v[56:59], v[20:23]
    v_mfma_f32_16x16x32_bf16 v[24:27], v[68:71], v[56:59], v[24:27]
    v_mfma_f32_16x16x32_bf16 v[16:19], v[80:83], v[72:75], v[16:19]
    v_mfma_f32_16x16x32_bf16 v[20:23], v[84:87], v[72:75], v[20:23]
    v_mfma_f32_16x16x32_bf16 v[24:27], v[88:91], v[72:75], v[24:27]
    v_mfma_f32_16x16x32_bf16 v[16:19], v[80:83], v[76:79], v[16:19]
    v_mfma_f32_16x16x32_bf16 v[20:23], v[84:87], v[76:79], v[20:23]
    v_mfma_f32_16x16x32_bf16 v[24:27], v[88:91], v[76:79], v[24:27]
    s_barrier
    s_lshl_b32 s48, s39, 4
    v_add_u32 v11, s48, v6
    v_mul_u32_u24 v12, 320, v11
    v_mul_u32_u24 v13, 160, v11
    v_lshlrev_b32 v14, 2, v7
    v_add_u32 v14, 0, v14
    v_lshl_add_u32 v13, v14, 1, v13
    v_add_u32 v13, 60416, v13
    s_cmp_lt_u32 s38, 4
    s_cbranch_scc1 K3c_0_rdir
    v_sub_u32 v14, 44, v14
    v_lshl_add_u32 v12, v14, 2, v12
    v_add_u32 v12, 39936, v12
    ds_read_b128 v[96:99], v12 offset:128
    ds_read_b128 v[108:111], v12 offset:40064
    ds_read_b128 v[100:103], v12 offset:64
    ds_read_b128 v[112:115], v12 offset:40000
    ds_read_b128 v[104:107], v12 offset:0
    ds_read_b128 v[116:119], v12 offset:39936
    s_branch K3c_0_rdone
K3c_0_rdir:
    v_lshl_add_u32 v12, v14, 2, v12
    v_add_u32 v12, 39936, v12
    ds_read_b128 v[96:99], v12 offset:0
    ds_read_b128 v[108:111], v12 offset:39936
    ds_read_b128 v[100:103], v12 offset:64
    ds_read_b128 v[112:115], v12 offset:40000
    ds_read_b128 v[104:107], v12 offset:128
    ds_read_b128 v[116:119], v12 offset:40064
K3c_0_rdone:
    ds_read_b64 v[120:121], v13 offset:0
    ds_read_b64 v[122:123], v13 offset:32
    ds_read_b64 v[124:125], v13 offset:64
    s_mov_b32 s24, s10
    s_mov_b32 s25, s11
    s_mov_b32 s26, 0x280000
    s_mov_b32 s27, 0x00020000
    s_waitcnt lgkmcnt(0)
    s_cmp_lt_u32 s37, 16
    s_cselect_b32 s48, 1, 0
    s_cmp_lt_u32 s38, 4
    s_cselect_b32 s49, 1, 0
    s_cmp_eq_u32 s48, s49
    s_cselect_b32 s48, -1.0, 1.0
    v_mov_b32 v2, s48
    v_mov_b32 v3, s48
    v_pk_fma_f32 v[96:97], v[108:109], v[2:3], v[96:97]
    v_pk_fma_f32 v[98:99], v[110:111], v[2:3], v[98:99]
    v_pk_fma_f32 v[100:101], v[112:113], v[2:3], v[100:101]
    v_pk_fma_f32 v[102:103], v[114:115], v[2:3], v[102:103]
    v_pk_fma_f32 v[104:105], v[116:117], v[2:3], v[104:105]
    v_pk_fma_f32 v[106:107], v[118:119], v[2:3], v[106:107]
    s_cmp_eq_u32 s38, 0
    s_cbranch_scc0 K3_noz
    v_cmp_gt_u32 vcc, 16, v0
    v_mov_b32 v4, 0
    s_nop 0
    v_cndmask_b32 v96, v96, v4, vcc
K3_noz:
    v_lshlrev_b32 v8, 3, v7
    v_sub_u32 v11, v10, v8
    v_and_b32 v8, 1, v7
    v_lshl_add_u32 v11, v8, 5, v11
    v_lshrrev_b32 v8, 1, v7
    v_lshl_add_u32 v11, v8, 4, v11
    s_cmp_lt_u32 s38, 4
    s_cbranch_scc0 K3c_0_epm
    v_add_f32 v16, v16, v96
    v_add_f32 v17, v17, v97
    v_add_f32 v18, v18, v98
    v_add_f32 v19, v19, v99
    v_lshlrev_b32 v4, 16, v120
    v_and_b32 v5, 0xffff0000, v120
    v_pk_add_f32 v[16:17], v[16:17], v[4:5]
    v_lshlrev_b32 v4, 16, v121
    v_and_b32 v5, 0xffff0000, v121
    v_pk_add_f32 v[18:19], v[18:19], v[4:5]
    v_cvt_pk_bf16_f32 v12, v16, v17
    v_cvt_pk_bf16_f32 v13, v18, v19
    v_add_f32 v20, v20, v100
    v_add_f32 v21, v21, v101
    v_add_f32 v22, v22, v102
    v_add_f32 v23, v23, v103
    v_lshlrev_b32 v4, 16, v122
    v_and_b32 v5, 0xffff0000, v122
    v_pk_add_f32 v[20:21], v[20:21], v[4:5]
    v_lshlrev_b32 v4, 16, v123
    v_and_b32 v5, 0xffff0000, v123
    v_pk_add_f32 v[22:23], v[22:23], v[4:5]
    v_cvt_pk_bf16_f32 v14, v20, v21
    v_cvt_pk_bf16_f32 v15, v22, v23
    s_nop 1
    v_permlane16_swap_b32 v12, v14
    v_permlane16_swap_b32 v13, v15
    buffer_store_dwordx4 v[12:15], v11, s[24:27], 0 offen
    v_add_f32 v24, v24, v104
    v_add_f32 v25, v25, v105
    v_add_f32 v26, v26, v106
    v_add_f32 v27, v27, v107
    v_lshlrev_b32 v4, 16, v124
    v_and_b32 v5, 0xffff0000, v124
    v_pk_add_f32 v[24:25], v[24:25], v[4:5]
    v_lshlrev_b32 v4, 16, v125
    v_and_b32 v5, 0xffff0000, v125
    v_pk_add_f32 v[26:27], v[26:27], v[4:5]
    v_cvt_pk_bf16_f32 v2, v24, v25
    v_cvt_pk_bf16_f32 v3, v26, v27
    buffer_store_dwordx2 v[2:3], v10, s[24:27], 0 offen offset:64
    s_branch K3_end
K3c_0_epm:
    v_add_f32 v16, v16, v99
    v_add_f32 v17, v17, v98
    v_add_f32 v18, v18, v97
    v_add_f32 v19, v19, v96
    v_lshlrev_b32 v4, 16, v120
    v_and_b32 v5, 0xffff0000, v120
    v_pk_add_f32 v[16:17], v[16:17], v[4:5]
    v_lshlrev_b32 v4, 16, v121
    v_and_b32 v5, 0xffff0000, v121
    v_pk_add_f32 v[18:19], v[18:19], v[4:5]
    v_cvt_pk_bf16_f32 v12, v16, v17
    v_cvt_pk_bf16_f32 v13, v18, v19
    v_add_f32 v20, v20, v103
    v_add_f32 v21, v21, v102
    v_add_f32 v22, v22, v101
    v_add_f32 v23, v23, v100
    v_lshlrev_b32 v4, 16, v122
    v_and_b32 v5, 0xffff0000, v122
    v_pk_add_f32 v[20:21], v[20:21], v[4:5]
    v_lshlrev_b32 v4, 16, v123
    v_and_b32 v5, 0xffff0000, v123
    v_pk_add_f32 v[22:23], v[22:23], v[4:5]
    v_cvt_pk_bf16_f32 v14, v20, v21
    v_cvt_pk_bf16_f32 v15, v22, v23
    s_nop 1
    v_permlane16_swap_b32 v12, v14
    v_permlane16_swap_b32 v13, v15
    buffer_store_dwordx4 v[12:15], v11, s[24:27], 0 offen
    v_add_f32 v24, v24, v107
    v_add_f32 v25, v25, v106
    v_add_f32 v26, v26, v105
    v_add_f32 v27, v27, v104
    v_lshlrev_b32 v4, 16, v124
    v_and_b32 v5, 0xffff0000, v124
    v_pk_add_f32 v[24:25], v[24:25], v[4:5]
    v_lshlrev_b32 v4, 16, v125
    v_and_b32 v5, 0xffff0000, v125
    v_pk_add_f32 v[26:27], v[26:27], v[4:5]
    v_cvt_pk_bf16_f32 v2, v24, v25
    v_cvt_pk_bf16_f32 v3, v26, v27
    buffer_store_dwordx2 v[2:3], v10, s[24:27], 0 offen offset:64
    s_branch K3_end
K3c_1:
    s_mov_b32 s41, 0
    s_mov_b32 s43, 0
    s_barrier
    s_barrier
K3c_1L_loop:
    s_setprio 1
    ds_read_b64 v[32:33], v93 offset:0
    ds_read_b64 v[34:35], v93 offset:512
    ds_read_b64 v[36:37], v93 offset:12288
    ds_read_b64 v[38:39], v93 offset:12800
    ds_read_b64_tr_b16 v[40:41], v92 offset:0
    ds_read_b64_tr_b16 v[42:43], v92 offset:2560
    ds_read_b64_tr_b16 v[44:45], v92 offset:32
    ds_read_b64_tr_b16 v[46:47], v92 offset:2592
    ds_read_b64 v[52:53], v93 offset:1024
    ds_read_b64 v[54:55], v93 offset:1536
    ds_read_b64 v[56:57], v93 offset:13312
    ds_read_b64 v[58:59], v93 offset:13824
    ds_read_b64_tr_b16 v[60:61], v92 offset:5120
    ds_read_b64_tr_b16 v[62:63], v92 offset:7680
    ds_read_b64_tr_b16 v[64:65], v92 offset:5152
    ds_read_b64_tr_b16 v[66:67], v92 offset:7712
    ds_read_b64 v[72:73], v93 offset:2048
    ds_read_b64 v[74:75], v93 offset:2560
    ds_read_b64 v[76:77], v93 offset:14336
    ds_read_b64 v[78:79], v93 offset:14848
    ds_read_b64_tr_b16 v[80:81], v92 offset:10240
    ds_read_b64_tr_b16 v[82:83], v92 offset:12800
    ds_read_b64_tr_b16 v[84:85], v92 offset:10272
    ds_read_b64_tr_b16 v[86:87], v92 offset:12832
    s_setprio 0
    s_mov_b32 s48, s43
    s_add_u32 s43, s43, 39936
    s_cmp_eq_u32 s43, 159744
    s_cselect_b32 s43, 0, s43
    s_sub_u32 s48, s43, s48
    s_add_u32 s41, s41, 1
    v_add_u32 v92, s48, v92
    v_add_u32 v93, s48, v93
    s_waitcnt lgkmcnt(14)
    v_mfma_f32_16x16x32_bf16 v[16:19], v[40:43], v[32:35], v[16:19]
    v_mfma_f32_16x16x32_bf16 v[20:23], v[44:47], v[32:35], v[20:23]
    v_mfma_f32_16x16x32_bf16 v[16:19], v[40:43], v[36:39], v[16:19]
    v_mfma_f32_16x16x32_bf16 v[20:23], v[44:47], v[36:39], v[20:23]
    s_waitcnt lgkmcnt(8)
    v_mfma_f32_16x16x32_bf16 v[16:19], v[60:63], v[52:55], v[16:19]
    v_mfma_f32_16x16x32_bf16 v[20:23], v[64:67], v[52:55], v[20:23]
    v_mfma_f32_16x16x32_bf16 v[16:19], v[60:63], v[56:59], v[16:19]
    v_mfma_f32_16x16x32_bf16 v[20:23], v[64:67], v[56:59], v[20:23]
    s_waitcnt lgkmcnt(0)
    v_mfma_f32_16x16x32_bf16 v[16:19], v[80:83], v[72:75], v[16:19]
    v_mfma_f32_16x16x32_bf16 v[20:23], v[84:87], v[72:75], v[20:23]
    v_mfma_f32_16x16x32_bf16 v[16:19], v[80:83], v[76:79], v[16:19]
    v_mfma_f32_16x16x32_bf16 v[20:23], v[84:87], v[76:79], v[20:23]
    s_cmp_lt_u32 s41, 9
    s_cbranch_scc0 K3c_1L_done
    s_barrier
    s_branch K3c_1L_loop
K3c_1L_done:
    s_barrier
    s_lshl_b32 s48, s39, 4
    v_add_u32 v11, s48, v6
    v_mul_u32_u24 v12, 320, v11
    v_mul_u32_u24 v13, 160, v11
    v_lshlrev_b32 v14, 2, v7
    v_add_u32 v14, 48, v14
    v_lshl_add_u32 v13, v14, 1, v13
    v_add_u32 v13, 60416, v13
    s_cmp_lt_u32 s38, 4
    s_cbranch_scc1 K3c_1_rdir
    v_sub_u32 v14, 44, v14
    v_lshl_add_u32 v12, v14, 2, v12
    v_add_u32 v12, 39936, v12
    ds_read_b128 v[96:99], v12 offset:128
    ds_read_b128 v[108:111], v12 offset:40064
    ds_read_b128 v[100:103], v12 offset:64
    ds_read_b128 v[112:115], v12 offset:40000
    s_branch K3c_1_rdone
K3c_1_rdir:
    v_lshl_add_u32 v12, v14, 2, v12
    v_add_u32 v12, 39936, v12
    ds_read_b128 v[96:99], v12 offset:0
    ds_read_b128 v[108:111], v12 offset:39936
    ds_read_b128 v[100:103], v12 offset:64
    ds_read_b128 v[112:115], v12 offset:40000
K3c_1_rdone:
    ds_read_b64 v[120:121], v13 offset:0
    ds_read_b64 v[122:123], v13 offset:32
    s_mov_b32 s24, s10
    s_mov_b32 s25, s11
    s_mov_b32 s26, 0x280000
    s_mov_b32 s27, 0x00020000
    s_waitcnt lgkmcnt(0)
    s_cmp_lt_u32 s37, 16
    s_cselect_b32 s48, 1, 0
    s_cmp_lt_u32 s38, 4
    s_cselect_b32 s49, 1, 0
    s_cmp_eq_u32 s48, s49
    s_cselect_b32 s48, -1.0, 1.0
    v_mov_b32 v2, s48
    v_mov_b32 v3, s48
    v_pk_fma_f32 v[96:97], v[108:109], v[2:3], v[96:97]
    v_pk_fma_f32 v[98:99], v[110:111], v[2:3], v[98:99]
    v_pk_fma_f32 v[100:101], v[112:113], v[2:3], v[100:101]
    v_pk_fma_f32 v[102:103], v[114:115], v[2:3], v[102:103]
    v_lshlrev_b32 v8, 3, v7
    v_sub_u32 v11, v10, v8
    v_and_b32 v8, 1, v7
    v_lshl_add_u32 v11, v8, 5, v11
    v_lshrrev_b32 v8, 1, v7
    v_lshl_add_u32 v11, v8, 4, v11
    s_cmp_lt_u32 s38, 4
    s_cbranch_scc0 K3c_1_epm
    v_add_f32 v16, v16, v96
    v_add_f32 v17, v17, v97
    v_add_f32 v18, v18, v98
    v_add_f32 v19, v19, v99
    v_lshlrev_b32 v4, 16, v120
    v_and_b32 v5, 0xffff0000, v120
    v_pk_add_f32 v[16:17], v[16:17], v[4:5]
    v_lshlrev_b32 v4, 16, v121
    v_and_b32 v5, 0xffff0000, v121
    v_pk_add_f32 v[18:19], v[18:19], v[4:5]
    v_cvt_pk_bf16_f32 v12, v16, v17
    v_cvt_pk_bf16_f32 v13, v18, v19
    v_add_f32 v20, v20, v100
    v_add_f32 v21, v21, v101
    v_add_f32 v22, v22, v102
    v_add_f32 v23, v23, v103
    v_lshlrev_b32 v4, 16, v122
    v_and_b32 v5, 0xffff0000, v122
    v_pk_add_f32 v[20:21], v[20:21], v[4:5]
    v_lshlrev_b32 v4, 16, v123
    v_and_b32 v5, 0xffff0000, v123
    v_pk_add_f32 v[22:23], v[22:23], v[4:5]
    v_cvt_pk_bf16_f32 v14, v20, v21
    v_cvt_pk_bf16_f32 v15, v22, v23
    s_nop 1
    v_permlane16_swap_b32 v12, v14
    v_permlane16_swap_b32 v13, v15
    buffer_store_dwordx4 v[12:15], v11, s[24:27], 0 offen
    s_branch K3_end
K3c_1_epm:
    v_add_f32 v16, v16, v99
    v_add_f32 v17, v17, v98
    v_add_f32 v18, v18, v97
    v_add_f32 v19, v19, v96
    v_lshlrev_b32 v4, 16, v120
    v_and_b32 v5, 0xffff0000, v120
    v_pk_add_f32 v[16:17], v[16:17], v[4:5]
    v_lshlrev_b32 v4, 16, v121
    v_and_b32 v5, 0xffff0000, v121
    v_pk_add_f32 v[18:19], v[18:19], v[4:5]
    v_cvt_pk_bf16_f32 v12, v16, v17
    v_cvt_pk_bf16_f32 v13, v18, v19
    v_add_f32 v20, v20, v103
    v_add_f32 v21, v21, v102
    v_add_f32 v22, v22, v101
    v_add_f32 v23, v23, v100
    v_lshlrev_b32 v4, 16, v122
    v_and_b32 v5, 0xffff0000, v122
    v_pk_add_f32 v[20:21], v[20:21], v[4:5]
    v_lshlrev_b32 v4, 16, v123
    v_and_b32 v5, 0xffff0000, v123
    v_pk_add_f32 v[22:23], v[22:23], v[4:5]
    v_cvt_pk_bf16_f32 v14, v20, v21
    v_cvt_pk_bf16_f32 v15, v22, v23
    s_nop 1
    v_permlane16_swap_b32 v12, v14
    v_permlane16_swap_b32 v13, v15
    buffer_store_dwordx4 v[12:15], v11, s[24:27], 0 offen
    s_branch K3_end
K3_prod:
    s_sub_u32 s39, s32, 8
    s_and_b32 s49, s39, 3
    s_lshr_b32 s50, s39, 2
    s_lshl_b32 s48, s37, 2
    s_add_u32 s48, s48, s49
    s_mul_i32 s44, s48, 27648
    s_mul_i32 s48, s50, 3538944
    s_add_u32 s44, s44, s48
    s_mul_i32 s49, s49, 3072
    s_mul_i32 s50, s50, 12288
    s_add_u32 s53, s49, s50
    v_lshlrev_b32 v2, 4, v0
    s_lshl_b32 s48, s39, 6
    s_add_u32 s48, s48, 0
    v_add_u32 v20, s48, v0
    v_mul_u32_u24 v21, 6554, v20
    v_lshrrev_b32 v21, 16, v21
    v_mul_u32_u24 v22, 10, v21
    v_sub_u32 v22, v20, v22
    v_mul_u32_u24 v21, 1280, v21
    v_lshl_add_u32 v3, v22, 4, v21
    s_lshl_b32 s48, s39, 6
    s_add_u32 s48, s48, 512
    v_add_u32 v20, s48, v0
    v_mul_u32_u24 v21, 6554, v20
    v_lshrrev_b32 v21, 16, v21
    v_mul_u32_u24 v22, 10, v21
    v_sub_u32 v22, v20, v22
    v_mul_u32_u24 v21, 1280, v21
    v_lshl_add_u32 v4, v22, 4, v21
    s_mul_i32 s48, s38, 80
    s_sub_u32 s49, s48, 1
    s_sub_u32 s50, 560, s48
    s_cmp_lt_u32 s38, 4
    s_cselect_b32 s48, s49, s50
    s_lshl_b32 s48, s48, 2
    s_add_u32 s52, s48, 64
    s_lshl_b32 s51, s37, 6
    s_lshl_b32 s48, s39, 6
    s_add_u32 s48, s48, 0
    v_add_u32 v20, s48, v0
    v_mul_u32_u24 v21, 3277, v20
    v_lshrrev_b32 v21, 16, v21
    v_mul_u32_u24 v22, 20, v21
    v_sub_u32 v22, v20, v22
    v_add_u32 v21, s51, v21
    s_cmp_lt_u32 s37, 16
    s_cbranch_scc1 K3p_m_97
    v_sub_u32 v21, 2048, v21
K3p_m_97:
    v_mul_u32_u24 v21, 1280, v21
    v_lshl_add_u32 v21, v22, 4, v21
    v_add_u32 v6, s52, v21
    s_lshl_b32 s48, s39, 6
    s_add_u32 s48, s48, 512
    v_add_u32 v20, s48, v0
    v_mul_u32_u24 v21, 3277, v20
    v_lshrrev_b32 v21, 16, v21
    v_mul_u32_u24 v22, 20, v21
    v_sub_u32 v22, v20, v22
    v_add_u32 v21, s51, v21
    s_cmp_lt_u32 s37, 16
    s_cbranch_scc1 K3p_m_98
    v_sub_u32 v21, 2048, v21
K3p_m_98:
    v_mul_u32_u24 v21, 1280, v21
    v_lshl_add_u32 v21, v22, 4, v21
    v_add_u32 v7, s52, v21
    s_lshl_b32 s48, s39, 6
    s_add_u32 s48, s48, 1024
    v_add_u32 v20, s48, v0
    v_mul_u32_u24 v21, 3277, v20
    v_lshrrev_b32 v21, 16, v21
    v_mul_u32_u24 v22, 20, v21
    v_sub_u32 v22, v20, v22
    v_add_u32 v21, s51, v21
    s_cmp_lt_u32 s37, 16
    s_cbranch_scc1 K3p_m_99
    v_sub_u32 v21, 2048, v21
K3p_m_99:
    v_mul_u32_u24 v21, 1280, v21
    v_lshl_add_u32 v21, v22, 4, v21
    v_add_u32 v8, s52, v21
    s_cmp_lt_u32 s39, 4
    s_cbranch_scc1 K3p_d_100
    v_mov_b32 v8, 0x7fffff00
K3p_d_100:
    s_sub_u32 s48, s39, 4
    s_lshl_b32 s48, s48, 1
    s_add_u32 s49, s39, 8
    s_cmp_lt_u32 s39, 4
    s_cselect_b32 s35, s49, s48
    s_add_u32 s48, s35, 0
    s_lshl_b32 s48, s48, 6
    v_add_u32 v20, s48, v0
    v_mul_u32_u24 v21, 6554, v20
    v_lshrrev_b32 v21, 16, v21
    v_mul_u32_u24 v22, 10, v21
    v_sub_u32 v22, v20, v22
    v_add_u32 v21, s51, v21
    v_mul_u32_u24 v21, 1280, v21
    v_lshl_add_u32 v21, v22, 4, v21
    s_mul_i32 s48, s38, 160
    v_add_u32 v9, s48, v21
    s_add_u32 s48, s35, 1
    s_lshl_b32 s48, s48, 6
    v_add_u32 v20, s48, v0
    v_mul_u32_u24 v21, 6554, v20
    v_lshrrev_b32 v21, 16, v21
    v_mul_u32_u24 v22, 10, v21
    v_sub_u32 v22, v20, v22
    v_add_u32 v21, s51, v21
    v_mul_u32_u24 v21, 1280, v21
    v_lshl_add_u32 v21, v22, 4, v21
    s_mul_i32 s48, s38, 160
    v_add_u32 v10, s48, v21
    s_mov_b32 s42, 0
    s_mov_b32 s36, s33
    s_mul_i32 s45, s33, 122880
    s_mul_i32 s50, s33, 3072
    s_add_u32 s44, s44, s50
    s_mul_i32 s50, s38, 160
    s_sub_u32 s51, 1105920, s50
    s_waitcnt lgkmcnt(0)
    s_add_u32 s48, s6, 0x900000
    s_addc_u32 s49, s7, 0
    s_mov_b32 s16, s48
    s_mov_b32 s17, s49
    s_mov_b32 s18, 0x6c0000
    s_mov_b32 s19, 0x00020000
    s_add_u32 s8, s8, s50
    s_addc_u32 s9, s9, 0
    s_mov_b32 s20, s8
    s_mov_b32 s21, s9
    s_mov_b32 s22, s51
    s_mov_b32 s23, 0x00020000
    s_mov_b32 s56, s4
    s_mov_b32 s57, s5
    s_mov_b32 s58, 0x280000
    s_mov_b32 s59, 0x00020000
    s_add_u32 s48, s6, 0xffffc0
    s_addc_u32 s49, s7, 0
    s_mov_b32 s60, s48
    s_mov_b32 s61, s49
    s_mov_b32 s62, 0x2d0040
    s_mov_b32 s63, 0x00020000
    s_mov_b32 s54, s36
    s_lshl_b32 s46, s39, 10
    s_add_u32 s46, s46, 0
    s_add_u32 m0, s46, 24576
    s_nop 0
    buffer_load_dwordx4 v3, s[20:23], s45 offen lds
    s_cmp_lt_u32 s39, 7
    s_cbranch_scc0 K3p_s_101
    s_add_u32 m0, s46, 32768
    s_nop 0
    buffer_load_dwordx4 v4, s[20:23], s45 offen lds
K3p_s_101:
    s_add_u32 s45, s45, 122880
    s_add_u32 s36, s36, 1
    s_cmp_eq_u32 s36, 9
    s_cbranch_scc0 K3p_w_102
    s_mov_b32 s36, 0
    s_mov_b32 s45, 0
K3p_w_102:
    s_lshl_b32 s46, s39, 10
    s_add_u32 s46, s46, 39936
    s_add_u32 m0, s46, 24576
    s_nop 0
    buffer_load_dwordx4 v3, s[20:23], s45 offen lds
    s_cmp_lt_u32 s39, 7
    s_cbranch_scc0 K3p_s_103
    s_add_u32 m0, s46, 32768
    s_nop 0
    buffer_load_dwordx4 v4, s[20:23], s45 offen lds
K3p_s_103:
    s_add_u32 s45, s45, 122880
    s_add_u32 s36, s36, 1
    s_cmp_eq_u32 s36, 9
    s_cbranch_scc0 K3p_w_104
    s_mov_b32 s36, 0
    s_mov_b32 s45, 0
K3p_w_104:
    s_lshl_b32 s46, s39, 10
    s_add_u32 s46, s46, 79872
    s_add_u32 m0, s46, 24576
    s_nop 0
    buffer_load_dwordx4 v3, s[20:23], s45 offen lds
    s_cmp_lt_u32 s39, 7
    s_cbranch_scc0 K3p_s_105
    s_add_u32 m0, s46, 32768
    s_nop 0
    buffer_load_dwordx4 v4, s[20:23], s45 offen lds
K3p_s_105:
    s_add_u32 s45, s45, 122880
    s_add_u32 s36, s36, 1
    s_cmp_eq_u32 s36, 9
    s_cbranch_scc0 K3p_w_106
    s_mov_b32 s36, 0
    s_mov_b32 s45, 0
K3p_w_106:
    s_lshl_b32 s46, s39, 10
    s_add_u32 s46, s46, 119808
    s_add_u32 m0, s46, 24576
    s_nop 0
    buffer_load_dwordx4 v3, s[20:23], s45 offen lds
    s_cmp_lt_u32 s39, 7
    s_cbranch_scc0 K3p_s_107
    s_add_u32 m0, s46, 32768
    s_nop 0
    buffer_load_dwordx4 v4, s[20:23], s45 offen lds
K3p_s_107:
    s_add_u32 s45, s45, 122880
    s_add_u32 s36, s36, 1
    s_cmp_eq_u32 s36, 9
    s_cbranch_scc0 K3p_w_108
    s_mov_b32 s36, 0
    s_mov_b32 s45, 0
K3p_w_108:
    s_cmp_eq_u32 s32, 8
    s_cbranch_scc0 K3p_np
    s_add_u32 s88, s6, 0x8ce000
    s_addc_u32 s89, s7, 0
    s_mov_b32 s92, s88
    s_mov_b32 s93, s89
    s_mov_b32 s94, 0x2000
    s_mov_b32 s95, 0x00020000
    s_and_b32 s88, s2, 7
    s_lshr_b32 s89, s2, 3
    v_mov_b32 v31, 0x7fffff00
    s_lshl_b32 s88, s88, 2
    s_lshr_b32 s89, s89, 3
    s_add_u32 s88, s88, s89
    s_lshr_b32 s88, s88, 1
    s_lshr_b32 s89, s88, 2
    s_lshl_b32 s89, s89, 1
    s_and_b32 s88, s88, 3
    s_mul_i32 s88, s88, 6
    v_and_b32 v28, 1, v0
    v_add_u32 v28, s89, v28
    v_lshrrev_b32 v29, 1, v0
    v_add_u32 v29, s88, v29
    v_lshl_add_u32 v28, v29, 3, v28
    v_cmp_gt_u32 vcc, 12, v0
    v_lshlrev_b32 v28, 5, v28
    s_nop 0
    v_cndmask_b32 v28, v31, v28, vcc
    v_cndmask_b32_e64 v27, 1, 0, vcc
    v_and_b32 v26, 7, v0
    v_lshrrev_b32 v29, 3, v0
    v_add_u32 v29, 24, v29
    v_lshl_add_u32 v26, v29, 3, v26
    v_lshlrev_b32 v26, 5, v26
    s_mov_b32 s90, 0
    buffer_load_dword v25, v28, s[92:95], 0 offen sc1
    buffer_load_dword v24, v26, s[92:95], 0 offen sc1
K3p_dp_lp:
    buffer_load_dword v23, v28, s[92:95], 0 offen sc1
    buffer_load_dword v22, v26, s[92:95], 0 offen sc1
    s_waitcnt vmcnt(2)
    v_or_b32 v25, v25, v27
    v_min_u32 v25, v25, v24
    v_cmp_ne_u32 vcc, 1, v25
    s_nop 1
    s_cmp_eq_u64 vcc, 0
    s_cbranch_scc1 K3p_dp_ok
    buffer_load_dword v21, v28, s[92:95], 0 offen sc1
    buffer_load_dword v20, v26, s[92:95], 0 offen sc1
    s_waitcnt vmcnt(2)
    v_or_b32 v23, v23, v27
    v_min_u32 v23, v23, v22
    v_cmp_ne_u32 vcc, 1, v23
    s_nop 1
    s_cmp_eq_u64 vcc, 0
    s_cbranch_scc1 K3p_dp_ok
    buffer_load_dword v25, v28, s[92:95], 0 offen sc1
    buffer_load_dword v24, v26, s[92:95], 0 offen sc1
    s_waitcnt vmcnt(2)
    v_or_b32 v21, v21, v27
    v_min_u32 v21, v21, v20
    v_cmp_ne_u32 vcc, 1, v21
    s_nop 1
    s_cmp_eq_u64 vcc, 0
    s_cbranch_scc1 K3p_dp_ok
    s_add_u32 s90, s90, 1
    s_cmp_lt_u32 s90, 2000
    s_cbranch_scc1 K3p_dp_lp
K3p_dp_ok:
    s_waitcnt vmcnt(0)
K3p_np:
    s_barrier
    s_add_u32 m0, s53, 0
    s_nop 0
    buffer_load_dwordx4 v2, s[16:19], s44 offen offset:0 sc1 lds
    buffer_load_dwordx4 v2, s[16:19], s44 offen offset:1024 sc1 lds
    buffer_load_dwordx4 v2, s[16:19], s44 offen offset:2048 sc1 lds
    s_add_u32 s44, s44, 3072
    s_add_u32 s54, s54, 1
    s_cmp_eq_u32 s54, 9
    s_cbranch_scc0 K3p_w_109
    s_mov_b32 s54, 0
    s_sub_u32 s44, s44, 27648
K3p_w_109:
    s_add_u32 m0, s53, 39936
    s_nop 0
    buffer_load_dwordx4 v2, s[16:19], s44 offen offset:0 sc1 lds
    buffer_load_dwordx4 v2, s[16:19], s44 offen offset:1024 sc1 lds
    buffer_load_dwordx4 v2, s[16:19], s44 offen offset:2048 sc1 lds
    s_add_u32 s44, s44, 3072
    s_add_u32 s54, s54, 1
    s_cmp_eq_u32 s54, 9
    s_cbranch_scc0 K3p_w_110
    s_mov_b32 s54, 0
    s_sub_u32 s44, s44, 27648
K3p_w_110:
    s_waitcnt vmcnt(3)
    s_barrier
    s_add_u32 m0, s53, 79872
    s_nop 0
    buffer_load_dwordx4 v2, s[16:19], s44 offen offset:0 sc1 lds
    buffer_load_dwordx4 v2, s[16:19], s44 offen offset:1024 sc1 lds
    buffer_load_dwordx4 v2, s[16:19], s44 offen offset:2048 sc1 lds
    s_add_u32 s44, s44, 3072
    s_add_u32 s54, s54, 1
    s_cmp_eq_u32 s54, 9
    s_cbranch_scc0 K3p_w_111
    s_mov_b32 s54, 0
    s_sub_u32 s44, s44, 27648
K3p_w_111:
    s_add_u32 m0, s53, 119808
    s_nop 0
    buffer_load_dwordx4 v2, s[16:19], s44 offen offset:0 sc1 lds
    buffer_load_dwordx4 v2, s[16:19], s44 offen offset:1024 sc1 lds
    buffer_load_dwordx4 v2, s[16:19], s44 offen offset:2048 sc1 lds
    s_add_u32 s44, s44, 3072
    s_add_u32 s54, s54, 1
    s_cmp_eq_u32 s54, 9
    s_cbranch_scc0 K3p_w_112
    s_mov_b32 s54, 0
    s_sub_u32 s44, s44, 27648
K3p_w_112:
    s_mov_b32 s42, 0
    s_waitcnt vmcnt(6)
    s_barrier
    s_add_u32 m0, s42, s53
    s_nop 0
    buffer_load_dwordx4 v2, s[16:19], s44 offen offset:0 sc1 lds
    buffer_load_dwordx4 v2, s[16:19], s44 offen offset:1024 sc1 lds
    buffer_load_dwordx4 v2, s[16:19], s44 offen offset:2048 sc1 lds
    s_lshl_b32 s46, s39, 10
    s_add_u32 s46, s46, s42
    s_add_u32 m0, s46, 24576
    s_nop 0
    buffer_load_dwordx4 v3, s[20:23], s45 offen lds
    s_cmp_lt_u32 s39, 7
    s_cbranch_scc0 K3p_s_113
    s_add_u32 m0, s46, 32768
    s_nop 0
    buffer_load_dwordx4 v4, s[20:23], s45 offen lds
K3p_s_113:
    s_add_u32 s42, s42, 39936
    s_cmp_eq_u32 s42, 159744
    s_cselect_b32 s42, 0, s42
    s_add_u32 s45, s45, 122880
    s_add_u32 s44, s44, 3072
    s_add_u32 s36, s36, 1
    s_cmp_eq_u32 s36, 9
    s_cbranch_scc0 K3p_w_114
    s_mov_b32 s36, 0
    s_mov_b32 s45, 0
    s_sub_u32 s44, s44, 27648
K3p_w_114:
    s_waitcnt vmcnt(7)
    s_barrier
    s_add_u32 m0, s42, s53
    s_nop 0
    buffer_load_dwordx4 v2, s[16:19], s44 offen offset:0 sc1 lds
    buffer_load_dwordx4 v2, s[16:19], s44 offen offset:1024 sc1 lds
    buffer_load_dwordx4 v2, s[16:19], s44 offen offset:2048 sc1 lds
    s_lshl_b32 s46, s39, 10
    s_add_u32 s46, s46, s42
    s_add_u32 m0, s46, 24576
    s_nop 0
    buffer_load_dwordx4 v3, s[20:23], s45 offen lds
    s_cmp_lt_u32 s39, 7
    s_cbranch_scc0 K3p_s_115
    s_add_u32 m0, s46, 32768
    s_nop 0
    buffer_load_dwordx4 v4, s[20:23], s45 offen lds
K3p_s_115:
    s_add_u32 s42, s42, 39936
    s_cmp_eq_u32 s42, 159744
    s_cselect_b32 s42, 0, s42
    s_add_u32 s45, s45, 122880
    s_add_u32 s44, s44, 3072
    s_add_u32 s36, s36, 1
    s_cmp_eq_u32 s36, 9
    s_cbranch_scc0 K3p_w_116
    s_mov_b32 s36, 0
    s_mov_b32 s45, 0
    s_sub_u32 s44, s44, 27648
K3p_w_116:
    s_waitcnt vmcnt(8)
    s_barrier
    s_add_u32 m0, s42, s53
    s_nop 0
    buffer_load_dwordx4 v2, s[16:19], s44 offen offset:0 sc1 lds
    buffer_load_dwordx4 v2, s[16:19], s44 offen offset:1024 sc1 lds
    buffer_load_dwordx4 v2, s[16:19], s44 offen offset:2048 sc1 lds
    s_lshl_b32 s46, s39, 10
    s_add_u32 s46, s46, s42
    s_add_u32 m0, s46, 24576
    s_nop 0
    buffer_load_dwordx4 v3, s[20:23], s45 offen lds
    s_cmp_lt_u32 s39, 7
    s_cbranch_scc0 K3p_s_117
    s_add_u32 m0, s46, 32768
    s_nop 0
    buffer_load_dwordx4 v4, s[20:23], s45 offen lds
K3p_s_117:
    s_add_u32 s42, s42, 39936
    s_cmp_eq_u32 s42, 159744
    s_cselect_b32 s42, 0, s42
    s_add_u32 s45, s45, 122880
    s_add_u32 s44, s44, 3072
    s_add_u32 s36, s36, 1
    s_cmp_eq_u32 s36, 9
    s_cbranch_scc0 K3p_w_118
    s_mov_b32 s36, 0
    s_mov_b32 s45, 0
    s_sub_u32 s44, s44, 27648
K3p_w_118:
    s_mov_b32 s41, 4
K3p_loop:
    s_waitcnt vmcnt(8)
    s_barrier
    s_add_u32 m0, s42, s53
    s_nop 0
    buffer_load_dwordx4 v2, s[16:19], s44 offen offset:0 sc1 lds
    buffer_load_dwordx4 v2, s[16:19], s44 offen offset:1024 sc1 lds
    buffer_load_dwordx4 v2, s[16:19], s44 offen offset:2048 sc1 lds
    s_lshl_b32 s46, s39, 10
    s_add_u32 s46, s46, s42
    s_add_u32 m0, s46, 24576
    s_nop 0
    buffer_load_dwordx4 v3, s[20:23], s45 offen lds
    s_cmp_lt_u32 s39, 7
    s_cbranch_scc0 K3p_s_119
    s_add_u32 m0, s46, 32768
    s_nop 0
    buffer_load_dwordx4 v4, s[20:23], s45 offen lds
K3p_s_119:
    s_add_u32 s42, s42, 39936
    s_cmp_eq_u32 s42, 159744
    s_cselect_b32 s42, 0, s42
    s_add_u32 s45, s45, 122880
    s_add_u32 s44, s44, 3072
    s_add_u32 s36, s36, 1
    s_cmp_eq_u32 s36, 9
    s_cbranch_scc0 K3p_w_120
    s_mov_b32 s36, 0
    s_mov_b32 s45, 0
    s_sub_u32 s44, s44, 27648
K3p_w_120:
    s_add_u32 s41, s41, 1
    s_cmp_lt_u32 s41, 6
    s_cbranch_scc1 K3p_loop
    s_waitcnt vmcnt(8)
    s_barrier
    s_lshl_b32 s46, s39, 10
    s_add_u32 m0, s46, 39936
    s_nop 0
    buffer_load_dwordx4 v6, s[60:63], 0 offen sc1 lds
    s_add_u32 m0, s46, 48128
    s_nop 0
    buffer_load_dwordx4 v7, s[60:63], 0 offen sc1 lds
    s_cmp_lt_u32 s39, 4
    s_cbranch_scc0 K3p_t4_121
    s_add_u32 m0, s46, 56320
    s_nop 0
    buffer_load_dwordx4 v8, s[60:63], 0 offen sc1 lds
    s_lshl_b32 s48, s35, 10
    s_add_u32 s48, s48, 60416
    s_cmp_lt_u32 s39, 2
    s_cselect_b32 s48, s48, 72704
    s_cbranch_scc1 K3p_tx_123
    v_mov_b32 v9, 0x7fffff00
K3p_tx_123:
    s_mov_b32 m0, s48
    s_nop 0
    buffer_load_dwordx4 v9, s[56:59], 0 offen lds
    s_branch K3p_td_122
K3p_t4_121:
    s_lshl_b32 s48, s35, 10
    s_add_u32 m0, s48, 60416
    s_nop 0
    buffer_load_dwordx4 v9, s[56:59], 0 offen lds
    s_add_u32 m0, s48, 61440
    s_nop 0
    buffer_load_dwordx4 v10, s[56:59], 0 offen lds
K3p_td_122:
    s_waitcnt vmcnt(8)
    s_barrier
    s_mov_b32 s47, 1474560
    s_add_u32 m0, s46, 79872
    s_nop 0
    buffer_load_dwordx4 v6, s[60:63], s47 offen sc1 lds
    s_add_u32 m0, s46, 88064
    s_nop 0
    buffer_load_dwordx4 v7, s[60:63], s47 offen sc1 lds
    s_add_u32 m0, s46, 96256
    s_nop 0
    buffer_load_dwordx4 v8, s[60:63], s47 offen sc1 lds
    s_waitcnt vmcnt(7)
    s_barrier
    s_waitcnt vmcnt(0)
    s_barrier
K3_end:
K3_exit:
    s_endpgm
KEND:
.section .rodata,"a"
.p2align 6
.amdhsa_kernel parallel_sum__spectral_fnet__mixer_gmlp__prompt_kernel
  .amdhsa_next_free_vgpr 128
  .amdhsa_next_free_sgpr 100
  .amdhsa_accum_offset 128
  .amdhsa_group_segment_fixed_size 0
  .amdhsa_kernarg_size 104
  .amdhsa_user_sgpr_count 2
  .amdhsa_user_sgpr_kernarg_segment_ptr 1
  .amdhsa_system_sgpr_workgroup_id_x 1
  .amdhsa_float_denorm_mode_32 3
.end_amdhsa_kernel
```
